```python
import torch

def _softmax(x, axis=-1):
    return torch.softmax(x, dim=axis)
def _gelu(x):
    return torch.nn.functional.gelu(x, approximate="tanh")
def _silu(x):
    return torch.nn.functional.silu(x)
def _sigmoid(x):
    return torch.sigmoid(x)
def _layernorm(x, axis=-1, eps=1e-5):
    m = x.mean(dim=axis, keepdim=True)
    v = x.var(dim=axis, keepdim=True, unbiased=False)
    return (x - m) / torch.sqrt(v + eps)
def _scatter_add(tgt, idx, src, axis=0):
    return tgt.clone().index_add_(axis, idx, src)
def _segment_sum(src, seg, n):
    out = torch.zeros((n,) + src.shape[1:], dtype=src.dtype)
    return out.index_add_(0, seg, src)
def _pad(x, pw):
    flat = tuple(v for pair in reversed(pw) for v in pair)
    return torch.nn.functional.pad(x, flat)

kernel_name = 'interleave_layers__softmax_full_mha__dense_activation_silu__prompt'

def setup_inputs():

    _w = (lambda a: (lambda t: t.to(torch.bfloat16) if t.is_floating_point() else t)(torch.as_tensor(a)))
    def _A_setup():
        B, S, D = 1, 2048, 448
        return {
            "x": _w((lambda *s: torch.randn(*s, dtype=torch.bfloat16) * 0.05)(B, S, D)),
            "wqkv": _w((lambda *s: torch.randn(*s, dtype=torch.bfloat16) * 0.05)(D, 3 * D)),
            "wo": _w((lambda *s: torch.randn(*s, dtype=torch.bfloat16) * 0.05)(D, D)),
        }
    _A_in = _A_setup()

    def _B_setup():
        B, S, D, F = 1, 2048, 448, 1792
        return {
            "x": _w((lambda *s: torch.randn(*s, dtype=torch.bfloat16) * 0.05)(B, S, D)),
            "w1": _w((lambda *s: torch.randn(*s, dtype=torch.bfloat16) * 1.6)(D, F) * (D ** -0.5)),
            "w2": _w((lambda *s: torch.randn(*s, dtype=torch.bfloat16) * 0.2)(F, D) * (F ** -0.5)),
        }
    _B_in = _B_setup()

    return {
        "A_x": _A_in["x"],
        "A_wqkv": _A_in["wqkv"],
        "A_wo": _A_in["wo"],
        "B_x": _B_in["x"],
        "B_w1": _B_in["w1"],
        "B_w2": _B_in["w2"],
    }

def reference(A_x, A_wqkv, A_wo, B_x, B_w1, B_w2):
    def _A_ref(x, wqkv, wo):
        B, S, D = x.shape
        H = 16; Dh = D // H
        qkv = (lambda x, *d: x.permute(*d))((x @ wqkv).reshape(B, S, 3, H, Dh), 2, 0, 3, 1, 4)
        q, k, v = qkv[0], qkv[1], qkv[2]
        scale = Dh ** -0.5
        scores = torch.einsum("bhqd,bhkd->bhqk", q, k) * scale
        p = _softmax(scores, axis=-1)
        o = torch.einsum("bhqk,bhkd->bhqd", p, v)
        return (lambda x, *d: x.permute(*d))(o, 0, 2, 1, 3).reshape(B, S, D) @ wo

    def _B_ref(x, w1, w2):
        h = torch.einsum("bsd,df->bsf", x, w1)
        h = _silu(h)
        out = torch.einsum("bsf,fd->bsd", h, w2)
        return out

    x = A_x
    x = x + _A_ref(_layernorm(x, axis=-1), A_wqkv, A_wo)
    x = x + _B_ref(_layernorm(x, axis=-1), B_w1, B_w2)
    x = x + _A_ref(_layernorm(x, axis=-1), A_wqkv, A_wo)
    x = x + _B_ref(_layernorm(x, axis=-1), B_w1, B_w2)
    return x
```

```asm
; @launch kernel=prep_kernel grid=(256,1,1) block=(256,1,1) lds=29696
; @launch kernel=main_kernel grid=(256,1,1) block=(256,1,1) lds=163840
.amdgcn_target "amdgcn-amd-amdhsa--gfx950"
.text
.globl prep_kernel
.p2align 8
.type prep_kernel,@function
prep_kernel:
  s_cmp_ge_u32 s2, 256
  s_cbranch_scc1 Lprep2_end
  s_load_dwordx2 s[4:5], s[0:1], 64
  s_load_dwordx4 s[40:43], s[0:1], 0
  s_load_dwordx2 s[44:45], s[0:1], 16
  s_load_dwordx2 s[46:47], s[0:1], 32
  s_load_dwordx2 s[48:49], s[0:1], 40
  v_and_b32 v1, 63, v0
  v_lshrrev_b32 v6, 6, v0
  v_and_b32 v2, 31, v1
  v_lshrrev_b32 v3, 5, v1
  v_readfirstlane_b32 s16, v6
  v_lshlrev_b32 v4, 4, v1
  s_waitcnt lgkmcnt(0)
  s_mov_b32 s8, s4
  s_and_b32 s9, s5, 0xffff
  s_mov_b32 s10, 0x10000000
  s_mov_b32 s11, 0x20000
  s_mul_i32 s50, s16, 7168
  v_bfe_u32 v6, v1, 2, 2
  v_lshl_add_u32 v6, v3, 2, v6
  v_lshlrev_b32 v6, 6, v6
  v_bfe_u32 v7, v1, 4, 1
  v_lshl_add_u32 v6, v7, 5, v6
  v_and_b32 v7, 3, v1
  v_lshl_add_u32 v6, v7, 3, v6
  v_add_u32 v12, s50, v6
  s_sub_u32 s34, s2, 192
  s_cmp_ge_u32 s2, 240
  s_cbranch_scc0 Lp_task
  s_cmp_ge_u32 s2, 250
  s_cbranch_scc1 Lp_nz
  s_sub_u32 s50, s2, 240
  s_lshl_b32 s50, s50, 12
  s_add_u32 s50, s50, 0xd10000
  v_lshlrev_b32 v8, 4, v0
  v_mov_b32 v12, 0
  v_mov_b32 v13, 0
  v_mov_b32 v14, 0
  v_mov_b32 v15, 0
  buffer_store_dwordx4 v[12:15], v8, s[8:11], s50 offen
Lp_nz:
  s_cmp_lt_u32 s2, 248
  s_cbranch_scc1 Lp_ncw
  s_getpc_b64 s[50:51]
Lp_pc:
  s_add_u32 s50, s50, main_kernel-Lp_pc
  s_addc_u32 s51, s51, 0
  v_lshlrev_b32 v8, 7, v0
  v_min_u32 v9, Lmain_codeend-main_kernel-4, v8
  global_load_dword v10, v9, s[50:51]
  v_add_u32 v8, 32768, v8
  v_min_u32 v9, Lmain_codeend-main_kernel-4, v8
  global_load_dword v10, v9, s[50:51]
  v_add_u32 v8, 32768, v8
Lp_ncw:
  s_branch Lp_flag
Lp_task:
  s_cmp_ge_u32 s2, 168
  s_cbranch_scc1 Lp_b
  s_cmp_ge_u32 s2, 112
  s_cbranch_scc1 Lp_w1
  s_cmp_ge_u32 s2, 48
  s_cbranch_scc1 Lp_x
  s_mul_i32 s25, s2, 43
  s_lshr_b32 s25, s25, 7
  s_mul_i32 s26, s25, 3
  s_sub_u32 s26, s2, s26
  s_mul_i32 s27, s26, 896
  s_mul_i32 s28, s25, 56
  s_add_u32 s27, s27, s28
  s_movk_i32 s29, 2688
  s_movk_i32 s30, 27
  s_cmp_eq_u32 s26, 0
  s_cselect_b32 s31, 0x3e8b97f6, 1.0
  s_mul_i32 s32, s25, 86016
  s_lshl_b32 s33, s26, 10
  s_add_u32 s32, s32, s33
  s_movk_i32 s33, 3072
  s_mov_b32 s34, s2
  s_mov_b32 s20, s42
  s_and_b32 s21, s43, 0xffff
  s_mov_b32 s22, 0x126000
  s_mov_b32 s23, 0x20000
  s_branch Lp_a
Lp_w1:
  s_sub_u32 s25, s2, 112
  s_lshl_b32 s27, s25, 6
  s_movk_i32 s29, 3584
  s_movk_i32 s30, 31
  s_mov_b32 s31, 1.0
  s_lshr_b32 s32, s25, 2
  s_mul_i32 s32, s32, 114688
  s_and_b32 s33, s25, 3
  s_mul_i32 s33, s33, 28672
  s_add_u32 s32, s32, s33
  s_add_u32 s32, s32, 0x1c0000
  s_movk_i32 s33, 1024
  s_add_u32 s34, s25, 128
  s_mov_b32 s20, s46
  s_and_b32 s21, s47, 0xffff
  s_mov_b32 s22, 0x188000
  s_mov_b32 s23, 0x20000
Lp_a:
  v_lshrrev_b32 v14, 2, v1
  v_mul_lo_u32 v14, v14, s29
  v_and_b32 v7, 3, v1
  v_lshl_add_u32 v14, v7, 4, v14
  s_mul_i32 s35, s16, 112
  s_mul_i32 s35, s35, s29
  s_add_u32 s35, s35, s27
  s_lshl_b32 s36, s29, 4
  s_add_u32 s51, s50, 0
  s_mov_b32 m0, s51
  s_nop 0
  buffer_load_dwordx4 v14, s[20:23], s35 offen lds
  s_add_u32 s51, s50, 1024
  s_mov_b32 m0, s51
  s_add_u32 s35, s35, s36
  s_nop 0
  buffer_load_dwordx4 v14, s[20:23], s35 offen lds
  s_add_u32 s51, s50, 2048
  s_mov_b32 m0, s51
  s_add_u32 s35, s35, s36
  s_nop 0
  buffer_load_dwordx4 v14, s[20:23], s35 offen lds
  s_add_u32 s51, s50, 3072
  s_mov_b32 m0, s51
  s_add_u32 s35, s35, s36
  s_nop 0
  buffer_load_dwordx4 v14, s[20:23], s35 offen lds
  s_add_u32 s51, s50, 4096
  s_mov_b32 m0, s51
  s_add_u32 s35, s35, s36
  s_nop 0
  buffer_load_dwordx4 v14, s[20:23], s35 offen lds
  s_add_u32 s51, s50, 5120
  s_mov_b32 m0, s51
  s_add_u32 s35, s35, s36
  s_nop 0
  buffer_load_dwordx4 v14, s[20:23], s35 offen lds
  s_add_u32 s51, s50, 6144
  s_mov_b32 m0, s51
  s_add_u32 s35, s35, s36
  s_nop 0
  buffer_load_dwordx4 v14, s[20:23], s35 offen lds
  s_waitcnt vmcnt(0)
  ds_read_b64_tr_b16 v[16:17], v12 offset:0
  ds_read_b64_tr_b16 v[18:19], v12 offset:512
  ds_read_b64_tr_b16 v[20:21], v12 offset:1024
  ds_read_b64_tr_b16 v[22:23], v12 offset:1536
  ds_read_b64_tr_b16 v[24:25], v12 offset:2048
  ds_read_b64_tr_b16 v[26:27], v12 offset:2560
  ds_read_b64_tr_b16 v[28:29], v12 offset:3072
  ds_read_b64_tr_b16 v[30:31], v12 offset:3584
  ds_read_b64_tr_b16 v[32:33], v12 offset:4096
  ds_read_b64_tr_b16 v[34:35], v12 offset:4608
  ds_read_b64_tr_b16 v[36:37], v12 offset:5120
  ds_read_b64_tr_b16 v[38:39], v12 offset:5632
  ds_read_b64_tr_b16 v[40:41], v12 offset:6144
  ds_read_b64_tr_b16 v[42:43], v12 offset:6656
  v_mov_b32 v8, s31
  v_cmp_ge_u32 vcc, s30, v2
  v_mov_b32 v9, 0
  v_mov_b32 v10, 0x3f803f80
  v_cndmask_b32 v8, 0, v8, vcc
  s_waitcnt lgkmcnt(0)
  v_dot2_f32_bf16 v9, v16, v10, v9
  v_dot2_f32_bf16 v9, v17, v10, v9
  v_dot2_f32_bf16 v9, v18, v10, v9
  v_dot2_f32_bf16 v9, v19, v10, v9
  v_dot2_f32_bf16 v9, v20, v10, v9
  v_dot2_f32_bf16 v9, v21, v10, v9
  v_dot2_f32_bf16 v9, v22, v10, v9
  v_dot2_f32_bf16 v9, v23, v10, v9
  v_dot2_f32_bf16 v9, v24, v10, v9
  v_dot2_f32_bf16 v9, v25, v10, v9
  v_dot2_f32_bf16 v9, v26, v10, v9
  v_dot2_f32_bf16 v9, v27, v10, v9
  v_dot2_f32_bf16 v9, v28, v10, v9
  v_dot2_f32_bf16 v9, v29, v10, v9
  v_dot2_f32_bf16 v9, v30, v10, v9
  v_dot2_f32_bf16 v9, v31, v10, v9
  v_dot2_f32_bf16 v9, v32, v10, v9
  v_dot2_f32_bf16 v9, v33, v10, v9
  v_dot2_f32_bf16 v9, v34, v10, v9
  v_dot2_f32_bf16 v9, v35, v10, v9
  v_dot2_f32_bf16 v9, v36, v10, v9
  v_dot2_f32_bf16 v9, v37, v10, v9
  v_dot2_f32_bf16 v9, v38, v10, v9
  v_dot2_f32_bf16 v9, v39, v10, v9
  v_dot2_f32_bf16 v9, v40, v10, v9
  v_dot2_f32_bf16 v9, v41, v10, v9
  v_dot2_f32_bf16 v9, v42, v10, v9
  v_dot2_f32_bf16 v9, v43, v10, v9
  s_nop 2
  v_mov_b32 v11, v9
  s_nop 1
  v_permlane32_swap_b32 v9, v11
  s_nop 1
  v_add_f32 v9, v9, v11
  s_lshl_b32 s37, s16, 7
  s_add_u32 s37, s37, 28672
  v_lshl_add_u32 v11, v2, 2, s37
  ds_write_b32 v11, v9
  s_waitcnt lgkmcnt(0)
  s_barrier
  v_lshlrev_b32 v11, 2, v2
  ds_read_b32 v48, v11 offset:28672
  ds_read_b32 v49, v11 offset:28800
  ds_read_b32 v50, v11 offset:28928
  ds_read_b32 v51, v11 offset:29056
  s_mul_i32 s37, s16, 7
  s_mul_i32 s37, s37, s33
  s_add_u32 s32, s32, s37
  s_waitcnt lgkmcnt(0)
  v_add_f32 v48, v48, v49
  v_add_f32 v50, v50, v51
  v_add_f32 v48, v48, v50
  v_mul_f32 v48, 0xbb124925, v48
  v_mul_f32 v48, v48, v8
  v_lshlrev_b32 v50, 16, v16
  v_and_b32 v51, 0xffff0000, v16
  v_pk_fma_f32 v[50:51], v[50:51], v[8:9], v[48:49] op_sel_hi:[1,0,0]
  v_cvt_pk_bf16_f32 v16, v50, v51
  v_lshlrev_b32 v50, 16, v17
  v_and_b32 v51, 0xffff0000, v17
  v_pk_fma_f32 v[50:51], v[50:51], v[8:9], v[48:49] op_sel_hi:[1,0,0]
  v_cvt_pk_bf16_f32 v17, v50, v51
  v_lshlrev_b32 v50, 16, v18
  v_and_b32 v51, 0xffff0000, v18
  v_pk_fma_f32 v[50:51], v[50:51], v[8:9], v[48:49] op_sel_hi:[1,0,0]
  v_cvt_pk_bf16_f32 v18, v50, v51
  v_lshlrev_b32 v50, 16, v19
  v_and_b32 v51, 0xffff0000, v19
  v_pk_fma_f32 v[50:51], v[50:51], v[8:9], v[48:49] op_sel_hi:[1,0,0]
  v_cvt_pk_bf16_f32 v19, v50, v51
  buffer_store_dwordx4 v[16:19], v4, s[8:11], s32 offen sc1
  s_add_u32 s32, s32, s33
  v_lshlrev_b32 v50, 16, v20
  v_and_b32 v51, 0xffff0000, v20
  v_pk_fma_f32 v[50:51], v[50:51], v[8:9], v[48:49] op_sel_hi:[1,0,0]
  v_cvt_pk_bf16_f32 v20, v50, v51
  v_lshlrev_b32 v50, 16, v21
  v_and_b32 v51, 0xffff0000, v21
  v_pk_fma_f32 v[50:51], v[50:51], v[8:9], v[48:49] op_sel_hi:[1,0,0]
  v_cvt_pk_bf16_f32 v21, v50, v51
  v_lshlrev_b32 v50, 16, v22
  v_and_b32 v51, 0xffff0000, v22
  v_pk_fma_f32 v[50:51], v[50:51], v[8:9], v[48:49] op_sel_hi:[1,0,0]
  v_cvt_pk_bf16_f32 v22, v50, v51
  v_lshlrev_b32 v50, 16, v23
  v_and_b32 v51, 0xffff0000, v23
  v_pk_fma_f32 v[50:51], v[50:51], v[8:9], v[48:49] op_sel_hi:[1,0,0]
  v_cvt_pk_bf16_f32 v23, v50, v51
  buffer_store_dwordx4 v[20:23], v4, s[8:11], s32 offen sc1
  s_add_u32 s32, s32, s33
  v_lshlrev_b32 v50, 16, v24
  v_and_b32 v51, 0xffff0000, v24
  v_pk_fma_f32 v[50:51], v[50:51], v[8:9], v[48:49] op_sel_hi:[1,0,0]
  v_cvt_pk_bf16_f32 v24, v50, v51
  v_lshlrev_b32 v50, 16, v25
  v_and_b32 v51, 0xffff0000, v25
  v_pk_fma_f32 v[50:51], v[50:51], v[8:9], v[48:49] op_sel_hi:[1,0,0]
  v_cvt_pk_bf16_f32 v25, v50, v51
  v_lshlrev_b32 v50, 16, v26
  v_and_b32 v51, 0xffff0000, v26
  v_pk_fma_f32 v[50:51], v[50:51], v[8:9], v[48:49] op_sel_hi:[1,0,0]
  v_cvt_pk_bf16_f32 v26, v50, v51
  v_lshlrev_b32 v50, 16, v27
  v_and_b32 v51, 0xffff0000, v27
  v_pk_fma_f32 v[50:51], v[50:51], v[8:9], v[48:49] op_sel_hi:[1,0,0]
  v_cvt_pk_bf16_f32 v27, v50, v51
  buffer_store_dwordx4 v[24:27], v4, s[8:11], s32 offen sc1
  s_add_u32 s32, s32, s33
  v_lshlrev_b32 v50, 16, v28
  v_and_b32 v51, 0xffff0000, v28
  v_pk_fma_f32 v[50:51], v[50:51], v[8:9], v[48:49] op_sel_hi:[1,0,0]
  v_cvt_pk_bf16_f32 v28, v50, v51
  v_lshlrev_b32 v50, 16, v29
  v_and_b32 v51, 0xffff0000, v29
  v_pk_fma_f32 v[50:51], v[50:51], v[8:9], v[48:49] op_sel_hi:[1,0,0]
  v_cvt_pk_bf16_f32 v29, v50, v51
  v_lshlrev_b32 v50, 16, v30
  v_and_b32 v51, 0xffff0000, v30
  v_pk_fma_f32 v[50:51], v[50:51], v[8:9], v[48:49] op_sel_hi:[1,0,0]
  v_cvt_pk_bf16_f32 v30, v50, v51
  v_lshlrev_b32 v50, 16, v31
  v_and_b32 v51, 0xffff0000, v31
  v_pk_fma_f32 v[50:51], v[50:51], v[8:9], v[48:49] op_sel_hi:[1,0,0]
  v_cvt_pk_bf16_f32 v31, v50, v51
  buffer_store_dwordx4 v[28:31], v4, s[8:11], s32 offen sc1
  s_add_u32 s32, s32, s33
  v_lshlrev_b32 v50, 16, v32
  v_and_b32 v51, 0xffff0000, v32
  v_pk_fma_f32 v[50:51], v[50:51], v[8:9], v[48:49] op_sel_hi:[1,0,0]
  v_cvt_pk_bf16_f32 v32, v50, v51
  v_lshlrev_b32 v50, 16, v33
  v_and_b32 v51, 0xffff0000, v33
  v_pk_fma_f32 v[50:51], v[50:51], v[8:9], v[48:49] op_sel_hi:[1,0,0]
  v_cvt_pk_bf16_f32 v33, v50, v51
  v_lshlrev_b32 v50, 16, v34
  v_and_b32 v51, 0xffff0000, v34
  v_pk_fma_f32 v[50:51], v[50:51], v[8:9], v[48:49] op_sel_hi:[1,0,0]
  v_cvt_pk_bf16_f32 v34, v50, v51
  v_lshlrev_b32 v50, 16, v35
  v_and_b32 v51, 0xffff0000, v35
  v_pk_fma_f32 v[50:51], v[50:51], v[8:9], v[48:49] op_sel_hi:[1,0,0]
  v_cvt_pk_bf16_f32 v35, v50, v51
  buffer_store_dwordx4 v[32:35], v4, s[8:11], s32 offen sc1
  s_add_u32 s32, s32, s33
  v_lshlrev_b32 v50, 16, v36
  v_and_b32 v51, 0xffff0000, v36
  v_pk_fma_f32 v[50:51], v[50:51], v[8:9], v[48:49] op_sel_hi:[1,0,0]
  v_cvt_pk_bf16_f32 v36, v50, v51
  v_lshlrev_b32 v50, 16, v37
  v_and_b32 v51, 0xffff0000, v37
  v_pk_fma_f32 v[50:51], v[50:51], v[8:9], v[48:49] op_sel_hi:[1,0,0]
  v_cvt_pk_bf16_f32 v37, v50, v51
  v_lshlrev_b32 v50, 16, v38
  v_and_b32 v51, 0xffff0000, v38
  v_pk_fma_f32 v[50:51], v[50:51], v[8:9], v[48:49] op_sel_hi:[1,0,0]
  v_cvt_pk_bf16_f32 v38, v50, v51
  v_lshlrev_b32 v50, 16, v39
  v_and_b32 v51, 0xffff0000, v39
  v_pk_fma_f32 v[50:51], v[50:51], v[8:9], v[48:49] op_sel_hi:[1,0,0]
  v_cvt_pk_bf16_f32 v39, v50, v51
  buffer_store_dwordx4 v[36:39], v4, s[8:11], s32 offen sc1
  s_add_u32 s32, s32, s33
  v_lshlrev_b32 v50, 16, v40
  v_and_b32 v51, 0xffff0000, v40
  v_pk_fma_f32 v[50:51], v[50:51], v[8:9], v[48:49] op_sel_hi:[1,0,0]
  v_cvt_pk_bf16_f32 v40, v50, v51
  v_lshlrev_b32 v50, 16, v41
  v_and_b32 v51, 0xffff0000, v41
  v_pk_fma_f32 v[50:51], v[50:51], v[8:9], v[48:49] op_sel_hi:[1,0,0]
  v_cvt_pk_bf16_f32 v41, v50, v51
  v_lshlrev_b32 v50, 16, v42
  v_and_b32 v51, 0xffff0000, v42
  v_pk_fma_f32 v[50:51], v[50:51], v[8:9], v[48:49] op_sel_hi:[1,0,0]
  v_cvt_pk_bf16_f32 v42, v50, v51
  v_lshlrev_b32 v50, 16, v43
  v_and_b32 v51, 0xffff0000, v43
  v_pk_fma_f32 v[50:51], v[50:51], v[8:9], v[48:49] op_sel_hi:[1,0,0]
  v_cvt_pk_bf16_f32 v43, v50, v51
  buffer_store_dwordx4 v[40:43], v4, s[8:11], s32 offen sc1
  s_add_u32 s32, s32, s33
  s_branch Lp_flag
Lp_b:
  s_sub_u32 s25, s2, 168
  s_add_u32 s34, s25, 184
  s_lshl_b32 s25, s25, 2
  s_add_u32 s25, s25, s16
  v_lshrrev_b32 v14, 2, v1
  v_mul_u32_u24 v14, 896, v14
  v_and_b32 v7, 3, v1
  v_lshl_add_u32 v14, v7, 4, v14
  s_cmp_ge_u32 s25, 64
  s_cbranch_scc1 Lp_w2
  s_mov_b32 s20, s44
  s_and_b32 s21, s45, 0xffff
  s_mov_b32 s22, 0x62000
  s_mov_b32 s23, 0x20000
  s_mul_i32 s26, s25, 7
  s_add_u32 s51, s50, 0
  s_mov_b32 m0, s51
  s_add_u32 s27, s26, 0
  s_lshr_b32 s28, s27, 5
  s_and_b32 s29, s27, 31
  s_lshr_b32 s30, s29, 1
  s_mul_i32 s30, s30, 28
  s_and_b32 s31, s29, 1
  s_lshl_b32 s31, s31, 4
  s_add_u32 s30, s30, s31
  s_mul_i32 s30, s30, 896
  s_lshl_b32 s28, s28, 6
  s_add_u32 s30, s30, s28
  s_nop 0
  buffer_load_dwordx4 v14, s[20:23], s30 offen lds
  s_add_u32 s51, s50, 1024
  s_mov_b32 m0, s51
  s_add_u32 s27, s26, 1
  s_lshr_b32 s28, s27, 5
  s_and_b32 s29, s27, 31
  s_lshr_b32 s30, s29, 1
  s_mul_i32 s30, s30, 28
  s_and_b32 s31, s29, 1
  s_lshl_b32 s31, s31, 4
  s_add_u32 s30, s30, s31
  s_mul_i32 s30, s30, 896
  s_lshl_b32 s28, s28, 6
  s_add_u32 s30, s30, s28
  s_nop 0
  buffer_load_dwordx4 v14, s[20:23], s30 offen lds
  s_add_u32 s51, s50, 2048
  s_mov_b32 m0, s51
  s_add_u32 s27, s26, 2
  s_lshr_b32 s28, s27, 5
  s_and_b32 s29, s27, 31
  s_lshr_b32 s30, s29, 1
  s_mul_i32 s30, s30, 28
  s_and_b32 s31, s29, 1
  s_lshl_b32 s31, s31, 4
  s_add_u32 s30, s30, s31
  s_mul_i32 s30, s30, 896
  s_lshl_b32 s28, s28, 6
  s_add_u32 s30, s30, s28
  s_nop 0
  buffer_load_dwordx4 v14, s[20:23], s30 offen lds
  s_add_u32 s51, s50, 3072
  s_mov_b32 m0, s51
  s_add_u32 s27, s26, 3
  s_lshr_b32 s28, s27, 5
  s_and_b32 s29, s27, 31
  s_lshr_b32 s30, s29, 1
  s_mul_i32 s30, s30, 28
  s_and_b32 s31, s29, 1
  s_lshl_b32 s31, s31, 4
  s_add_u32 s30, s30, s31
  s_mul_i32 s30, s30, 896
  s_lshl_b32 s28, s28, 6
  s_add_u32 s30, s30, s28
  s_nop 0
  buffer_load_dwordx4 v14, s[20:23], s30 offen lds
  s_add_u32 s51, s50, 4096
  s_mov_b32 m0, s51
  s_add_u32 s27, s26, 4
  s_lshr_b32 s28, s27, 5
  s_and_b32 s29, s27, 31
  s_lshr_b32 s30, s29, 1
  s_mul_i32 s30, s30, 28
  s_and_b32 s31, s29, 1
  s_lshl_b32 s31, s31, 4
  s_add_u32 s30, s30, s31
  s_mul_i32 s30, s30, 896
  s_lshl_b32 s28, s28, 6
  s_add_u32 s30, s30, s28
  s_nop 0
  buffer_load_dwordx4 v14, s[20:23], s30 offen lds
  s_add_u32 s51, s50, 5120
  s_mov_b32 m0, s51
  s_add_u32 s27, s26, 5
  s_lshr_b32 s28, s27, 5
  s_and_b32 s29, s27, 31
  s_lshr_b32 s30, s29, 1
  s_mul_i32 s30, s30, 28
  s_and_b32 s31, s29, 1
  s_lshl_b32 s31, s31, 4
  s_add_u32 s30, s30, s31
  s_mul_i32 s30, s30, 896
  s_lshl_b32 s28, s28, 6
  s_add_u32 s30, s30, s28
  s_nop 0
  buffer_load_dwordx4 v14, s[20:23], s30 offen lds
  s_add_u32 s51, s50, 6144
  s_mov_b32 m0, s51
  s_add_u32 s27, s26, 6
  s_lshr_b32 s28, s27, 5
  s_and_b32 s29, s27, 31
  s_lshr_b32 s30, s29, 1
  s_mul_i32 s30, s30, 28
  s_and_b32 s31, s29, 1
  s_lshl_b32 s31, s31, 4
  s_add_u32 s30, s30, s31
  s_mul_i32 s30, s30, 896
  s_lshl_b32 s28, s28, 6
  s_add_u32 s30, s30, s28
  s_nop 0
  buffer_load_dwordx4 v14, s[20:23], s30 offen lds
  s_waitcnt vmcnt(0)
  ds_read_b64_tr_b16 v[16:17], v12 offset:0
  ds_read_b64_tr_b16 v[18:19], v12 offset:512
  ds_read_b64_tr_b16 v[20:21], v12 offset:1024
  ds_read_b64_tr_b16 v[22:23], v12 offset:1536
  ds_read_b64_tr_b16 v[24:25], v12 offset:2048
  ds_read_b64_tr_b16 v[26:27], v12 offset:2560
  ds_read_b64_tr_b16 v[28:29], v12 offset:3072
  ds_read_b64_tr_b16 v[30:31], v12 offset:3584
  ds_read_b64_tr_b16 v[32:33], v12 offset:4096
  ds_read_b64_tr_b16 v[34:35], v12 offset:4608
  ds_read_b64_tr_b16 v[36:37], v12 offset:5120
  ds_read_b64_tr_b16 v[38:39], v12 offset:5632
  ds_read_b64_tr_b16 v[40:41], v12 offset:6144
  ds_read_b64_tr_b16 v[42:43], v12 offset:6656
  s_lshl_b32 s32, s26, 10
  s_add_u32 s32, s32, 0x150000
  v_mov_b32 v10, 0
  s_mov_b32 s38, 0
  s_waitcnt lgkmcnt(0)
  s_add_u32 s27, s26, 0
  s_bitcmp1_b32 s27, 0
  s_cselect_b32 s39, -1, 0
  v_cndmask_b32 v18, v18, v10, s[38:39]
  v_cndmask_b32 v19, v19, v10, s[38:39]
  buffer_store_dwordx4 v[16:19], v4, s[8:11], s32 offen sc1
  s_add_u32 s32, s32, 1024
  s_add_u32 s27, s26, 1
  s_bitcmp1_b32 s27, 0
  s_cselect_b32 s39, -1, 0
  v_cndmask_b32 v22, v22, v10, s[38:39]
  v_cndmask_b32 v23, v23, v10, s[38:39]
  buffer_store_dwordx4 v[20:23], v4, s[8:11], s32 offen sc1
  s_add_u32 s32, s32, 1024
  s_add_u32 s27, s26, 2
  s_bitcmp1_b32 s27, 0
  s_cselect_b32 s39, -1, 0
  v_cndmask_b32 v26, v26, v10, s[38:39]
  v_cndmask_b32 v27, v27, v10, s[38:39]
  buffer_store_dwordx4 v[24:27], v4, s[8:11], s32 offen sc1
  s_add_u32 s32, s32, 1024
  s_add_u32 s27, s26, 3
  s_bitcmp1_b32 s27, 0
  s_cselect_b32 s39, -1, 0
  v_cndmask_b32 v30, v30, v10, s[38:39]
  v_cndmask_b32 v31, v31, v10, s[38:39]
  buffer_store_dwordx4 v[28:31], v4, s[8:11], s32 offen sc1
  s_add_u32 s32, s32, 1024
  s_add_u32 s27, s26, 4
  s_bitcmp1_b32 s27, 0
  s_cselect_b32 s39, -1, 0
  v_cndmask_b32 v34, v34, v10, s[38:39]
  v_cndmask_b32 v35, v35, v10, s[38:39]
  buffer_store_dwordx4 v[32:35], v4, s[8:11], s32 offen sc1
  s_add_u32 s32, s32, 1024
  s_add_u32 s27, s26, 5
  s_bitcmp1_b32 s27, 0
  s_cselect_b32 s39, -1, 0
  v_cndmask_b32 v38, v38, v10, s[38:39]
  v_cndmask_b32 v39, v39, v10, s[38:39]
  buffer_store_dwordx4 v[36:39], v4, s[8:11], s32 offen sc1
  s_add_u32 s32, s32, 1024
  s_add_u32 s27, s26, 6
  s_bitcmp1_b32 s27, 0
  s_cselect_b32 s39, -1, 0
  v_cndmask_b32 v42, v42, v10, s[38:39]
  v_cndmask_b32 v43, v43, v10, s[38:39]
  buffer_store_dwordx4 v[40:43], v4, s[8:11], s32 offen sc1
  s_add_u32 s32, s32, 1024
  s_branch Lp_flag
Lp_w2:
  s_mov_b32 s20, s48
  s_and_b32 s21, s49, 0xffff
  s_mov_b32 s22, 0x188000
  s_mov_b32 s23, 0x20000
  s_sub_u32 s25, s25, 64
  s_lshr_b32 s28, s25, 4
  s_and_b32 s29, s25, 15
  s_mul_i32 s30, s29, 100352
  s_lshl_b32 s28, s28, 6
  s_add_u32 s30, s30, s28
  s_add_u32 s51, s50, 0
  s_mov_b32 m0, s51
  s_nop 0
  buffer_load_dwordx4 v14, s[20:23], s30 offen lds
  s_add_u32 s51, s50, 1024
  s_mov_b32 m0, s51
  s_add_u32 s30, s30, 14336
  s_nop 0
  buffer_load_dwordx4 v14, s[20:23], s30 offen lds
  s_add_u32 s51, s50, 2048
  s_mov_b32 m0, s51
  s_add_u32 s30, s30, 14336
  s_nop 0
  buffer_load_dwordx4 v14, s[20:23], s30 offen lds
  s_add_u32 s51, s50, 3072
  s_mov_b32 m0, s51
  s_add_u32 s30, s30, 14336
  s_nop 0
  buffer_load_dwordx4 v14, s[20:23], s30 offen lds
  s_add_u32 s51, s50, 4096
  s_mov_b32 m0, s51
  s_add_u32 s30, s30, 14336
  s_nop 0
  buffer_load_dwordx4 v14, s[20:23], s30 offen lds
  s_add_u32 s51, s50, 5120
  s_mov_b32 m0, s51
  s_add_u32 s30, s30, 14336
  s_nop 0
  buffer_load_dwordx4 v14, s[20:23], s30 offen lds
  s_add_u32 s51, s50, 6144
  s_mov_b32 m0, s51
  s_add_u32 s30, s30, 14336
  s_nop 0
  buffer_load_dwordx4 v14, s[20:23], s30 offen lds
  s_waitcnt vmcnt(0)
  ds_read_b64_tr_b16 v[16:17], v12 offset:0
  ds_read_b64_tr_b16 v[18:19], v12 offset:512
  ds_read_b64_tr_b16 v[20:21], v12 offset:1024
  ds_read_b64_tr_b16 v[22:23], v12 offset:1536
  ds_read_b64_tr_b16 v[24:25], v12 offset:2048
  ds_read_b64_tr_b16 v[26:27], v12 offset:2560
  ds_read_b64_tr_b16 v[28:29], v12 offset:3072
  ds_read_b64_tr_b16 v[30:31], v12 offset:3584
  ds_read_b64_tr_b16 v[32:33], v12 offset:4096
  ds_read_b64_tr_b16 v[34:35], v12 offset:4608
  ds_read_b64_tr_b16 v[36:37], v12 offset:5120
  ds_read_b64_tr_b16 v[38:39], v12 offset:5632
  ds_read_b64_tr_b16 v[40:41], v12 offset:6144
  ds_read_b64_tr_b16 v[42:43], v12 offset:6656
  s_mul_i32 s32, s25, 7168
  s_add_u32 s32, s32, 0x348000
  s_waitcnt lgkmcnt(0)
  buffer_store_dwordx4 v[16:19], v4, s[8:11], s32 offen sc1
  s_add_u32 s32, s32, 1024
  buffer_store_dwordx4 v[20:23], v4, s[8:11], s32 offen sc1
  s_add_u32 s32, s32, 1024
  buffer_store_dwordx4 v[24:27], v4, s[8:11], s32 offen sc1
  s_add_u32 s32, s32, 1024
  buffer_store_dwordx4 v[28:31], v4, s[8:11], s32 offen sc1
  s_add_u32 s32, s32, 1024
  buffer_store_dwordx4 v[32:35], v4, s[8:11], s32 offen sc1
  s_add_u32 s32, s32, 1024
  buffer_store_dwordx4 v[36:39], v4, s[8:11], s32 offen sc1
  s_add_u32 s32, s32, 1024
  buffer_store_dwordx4 v[40:43], v4, s[8:11], s32 offen sc1
  s_add_u32 s32, s32, 1024
  s_branch Lp_flag
Lp_x:
  s_sub_u32 s26, s2, 48
  s_add_u32 s34, s26, 64
  s_mov_b32 s20, s40
  s_and_b32 s21, s41, 0xffff
  s_mov_b32 s22, 0x1c0000
  s_mov_b32 s23, 0x20000
  v_mul_u32_u24 v14, 896, v2
  v_lshl_add_u32 v14, v3, 3, v14
  s_mul_i32 s28, s26, 28672
  s_lshl_b32 s29, s16, 8
  s_add_u32 s28, s28, s29
  s_mul_i32 s30, s26, 28
  s_lshl_b32 s31, s16, 3
  s_add_u32 s30, s30, s31
  s_lshl_b32 s30, s30, 10
  s_add_u32 s30, s30, 0x500000
  s_lshl_b32 s31, s16, 16
  s_lshl_b32 s33, s26, 8
  s_add_u32 s31, s31, s33
  s_add_u32 s31, s31, 0xc00000
  v_lshlrev_b32 v13, 3, v2
  buffer_load_dwordx2 v[16:17], v14, s[20:23], s28 offen offset:0
  buffer_load_dwordx2 v[18:19], v14, s[20:23], s28 offen offset:16
  buffer_load_dwordx2 v[20:21], v14, s[20:23], s28 offen offset:32
  buffer_load_dwordx2 v[22:23], v14, s[20:23], s28 offen offset:48
  buffer_load_dwordx2 v[24:25], v14, s[20:23], s28 offen offset:64
  buffer_load_dwordx2 v[26:27], v14, s[20:23], s28 offen offset:80
  buffer_load_dwordx2 v[28:29], v14, s[20:23], s28 offen offset:96
  buffer_load_dwordx2 v[30:31], v14, s[20:23], s28 offen offset:112
  s_cmp_eq_u32 s16, 3
  s_cbranch_scc1 Lp_x1
  buffer_load_dwordx2 v[32:33], v14, s[20:23], s28 offen offset:128
  buffer_load_dwordx2 v[34:35], v14, s[20:23], s28 offen offset:144
  buffer_load_dwordx2 v[36:37], v14, s[20:23], s28 offen offset:160
  buffer_load_dwordx2 v[38:39], v14, s[20:23], s28 offen offset:176
  buffer_load_dwordx2 v[40:41], v14, s[20:23], s28 offen offset:192
  buffer_load_dwordx2 v[42:43], v14, s[20:23], s28 offen offset:208
  buffer_load_dwordx2 v[44:45], v14, s[20:23], s28 offen offset:224
  buffer_load_dwordx2 v[46:47], v14, s[20:23], s28 offen offset:240
Lp_x1:
  s_waitcnt vmcnt(0)
  buffer_store_dwordx4 v[16:19], v4, s[8:11], s30 offen offset:0 sc1
  buffer_store_dwordx4 v[20:23], v4, s[8:11], s30 offen offset:1024 sc1
  buffer_store_dwordx4 v[24:27], v4, s[8:11], s30 offen offset:2048 sc1
  buffer_store_dwordx4 v[28:31], v4, s[8:11], s30 offen offset:3072 sc1
  v_mov_b32 v56, 0
  v_mov_b32 v57, 0
  v_mov_b32 v60, 0x3f803f80
  v_dot2_f32_bf16 v56, v16, v60, v56
  v_dot2_f32_bf16 v57, v16, v16, v57
  v_dot2_f32_bf16 v56, v17, v60, v56
  v_dot2_f32_bf16 v57, v17, v17, v57
  v_dot2_f32_bf16 v56, v18, v60, v56
  v_dot2_f32_bf16 v57, v18, v18, v57
  v_dot2_f32_bf16 v56, v19, v60, v56
  v_dot2_f32_bf16 v57, v19, v19, v57
  v_dot2_f32_bf16 v56, v20, v60, v56
  v_dot2_f32_bf16 v57, v20, v20, v57
  v_dot2_f32_bf16 v56, v21, v60, v56
  v_dot2_f32_bf16 v57, v21, v21, v57
  v_dot2_f32_bf16 v56, v22, v60, v56
  v_dot2_f32_bf16 v57, v22, v22, v57
  v_dot2_f32_bf16 v56, v23, v60, v56
  v_dot2_f32_bf16 v57, v23, v23, v57
  s_nop 2
  v_mov_b32 v58, v56
  v_mov_b32 v59, v57
  s_nop 1
  v_permlane32_swap_b32 v56, v58
  v_permlane32_swap_b32 v57, v59
  s_nop 1
  v_add_f32 v56, v56, v58
  v_add_f32 v57, v57, v59
  s_mov_b32 exec_hi, 0
  buffer_store_dwordx2 v[56:57], v13, s[8:11], s31 offen sc1
  s_mov_b64 exec, -1
  s_add_u32 s31, s31, 16384
  v_mov_b32 v56, 0
  v_mov_b32 v57, 0
  v_mov_b32 v60, 0x3f803f80
  v_dot2_f32_bf16 v56, v24, v60, v56
  v_dot2_f32_bf16 v57, v24, v24, v57
  v_dot2_f32_bf16 v56, v25, v60, v56
  v_dot2_f32_bf16 v57, v25, v25, v57
  v_dot2_f32_bf16 v56, v26, v60, v56
  v_dot2_f32_bf16 v57, v26, v26, v57
  v_dot2_f32_bf16 v56, v27, v60, v56
  v_dot2_f32_bf16 v57, v27, v27, v57
  v_dot2_f32_bf16 v56, v28, v60, v56
  v_dot2_f32_bf16 v57, v28, v28, v57
  v_dot2_f32_bf16 v56, v29, v60, v56
  v_dot2_f32_bf16 v57, v29, v29, v57
  v_dot2_f32_bf16 v56, v30, v60, v56
  v_dot2_f32_bf16 v57, v30, v30, v57
  v_dot2_f32_bf16 v56, v31, v60, v56
  v_dot2_f32_bf16 v57, v31, v31, v57
  s_nop 2
  v_mov_b32 v58, v56
  v_mov_b32 v59, v57
  s_nop 1
  v_permlane32_swap_b32 v56, v58
  v_permlane32_swap_b32 v57, v59
  s_nop 1
  v_add_f32 v56, v56, v58
  v_add_f32 v57, v57, v59
  s_mov_b32 exec_hi, 0
  buffer_store_dwordx2 v[56:57], v13, s[8:11], s31 offen sc1
  s_mov_b64 exec, -1
  s_add_u32 s31, s31, 16384
  s_cmp_eq_u32 s16, 3
  s_cbranch_scc1 Lp_flag
  s_add_u32 s30, s30, 4096
  buffer_store_dwordx4 v[32:35], v4, s[8:11], s30 offen offset:0 sc1
  buffer_store_dwordx4 v[36:39], v4, s[8:11], s30 offen offset:1024 sc1
  buffer_store_dwordx4 v[40:43], v4, s[8:11], s30 offen offset:2048 sc1
  buffer_store_dwordx4 v[44:47], v4, s[8:11], s30 offen offset:3072 sc1
  v_mov_b32 v56, 0
  v_mov_b32 v57, 0
  v_mov_b32 v60, 0x3f803f80
  v_dot2_f32_bf16 v56, v32, v60, v56
  v_dot2_f32_bf16 v57, v32, v32, v57
  v_dot2_f32_bf16 v56, v33, v60, v56
  v_dot2_f32_bf16 v57, v33, v33, v57
  v_dot2_f32_bf16 v56, v34, v60, v56
  v_dot2_f32_bf16 v57, v34, v34, v57
  v_dot2_f32_bf16 v56, v35, v60, v56
  v_dot2_f32_bf16 v57, v35, v35, v57
  v_dot2_f32_bf16 v56, v36, v60, v56
  v_dot2_f32_bf16 v57, v36, v36, v57
  v_dot2_f32_bf16 v56, v37, v60, v56
  v_dot2_f32_bf16 v57, v37, v37, v57
  v_dot2_f32_bf16 v56, v38, v60, v56
  v_dot2_f32_bf16 v57, v38, v38, v57
  v_dot2_f32_bf16 v56, v39, v60, v56
  v_dot2_f32_bf16 v57, v39, v39, v57
  s_nop 2
  v_mov_b32 v58, v56
  v_mov_b32 v59, v57
  s_nop 1
  v_permlane32_swap_b32 v56, v58
  v_permlane32_swap_b32 v57, v59
  s_nop 1
  v_add_f32 v56, v56, v58
  v_add_f32 v57, v57, v59
  s_mov_b32 exec_hi, 0
  buffer_store_dwordx2 v[56:57], v13, s[8:11], s31 offen sc1
  s_mov_b64 exec, -1
  s_add_u32 s31, s31, 16384
  v_mov_b32 v56, 0
  v_mov_b32 v57, 0
  v_mov_b32 v60, 0x3f803f80
  v_dot2_f32_bf16 v56, v40, v60, v56
  v_dot2_f32_bf16 v57, v40, v40, v57
  v_dot2_f32_bf16 v56, v41, v60, v56
  v_dot2_f32_bf16 v57, v41, v41, v57
  v_dot2_f32_bf16 v56, v42, v60, v56
  v_dot2_f32_bf16 v57, v42, v42, v57
  v_dot2_f32_bf16 v56, v43, v60, v56
  v_dot2_f32_bf16 v57, v43, v43, v57
  v_dot2_f32_bf16 v56, v44, v60, v56
  v_dot2_f32_bf16 v57, v44, v44, v57
  v_dot2_f32_bf16 v56, v45, v60, v56
  v_dot2_f32_bf16 v57, v45, v45, v57
  v_dot2_f32_bf16 v56, v46, v60, v56
  v_dot2_f32_bf16 v57, v46, v46, v57
  v_dot2_f32_bf16 v56, v47, v60, v56
  v_dot2_f32_bf16 v57, v47, v47, v57
  s_nop 2
  v_mov_b32 v58, v56
  v_mov_b32 v59, v57
  s_nop 1
  v_permlane32_swap_b32 v56, v58
  v_permlane32_swap_b32 v57, v59
  s_nop 1
  v_add_f32 v56, v56, v58
  v_add_f32 v57, v57, v59
  s_mov_b32 exec_hi, 0
  buffer_store_dwordx2 v[56:57], v13, s[8:11], s31 offen sc1
  s_mov_b64 exec, -1
  s_add_u32 s31, s31, 16384
Lp_flag:
Lprep2_end:
  s_endpgm
.globl main_kernel
.p2align 8
.type main_kernel,@function
main_kernel:
  s_cmp_ge_u32 s2, 256
  s_cbranch_scc1 Lmain_end
  s_load_dwordx2 s[4:5], s[0:1], 64
  s_load_dwordx2 s[6:7], s[0:1], 48
  s_load_dwordx2 s[64:65], s[0:1], 56
  s_load_dwordx4 s[40:43], s[0:1], 0
  s_load_dwordx2 s[44:45], s[0:1], 16
  s_load_dwordx2 s[46:47], s[0:1], 32
  s_load_dwordx2 s[48:49], s[0:1], 40
  v_and_b32 v1, 63, v0
  v_lshrrev_b32 v6, 6, v0
  v_and_b32 v2, 31, v1
  v_lshrrev_b32 v3, 5, v1
  v_readfirstlane_b32 s16, v6
  v_lshlrev_b32 v4, 4, v1
  v_lshlrev_b32 v5, 14, v3
  v_lshl_add_u32 v5, v2, 3, v5
  s_waitcnt lgkmcnt(0)
  s_mov_b32 s8, s4
  s_and_b32 s9, s5, 0xffff
  s_mov_b32 s10, 0x10000000
  s_mov_b32 s11, 0x20000
  s_mov_b32 s12, s6
  s_and_b32 s13, s7, 0xffff
  s_mov_b32 s14, 0x1c0000
  s_mov_b32 s15, 0x20000
  s_mov_b32 s18, 1
  s_mov_b32 s19, 0x1c0000
  s_mov_b32 s3, 0
  s_getreg_b32 s17, hwreg(HW_REG_XCC_ID, 0, 4)
  s_and_b32 s17, s17, 7
  s_movk_i32 s66, 0x100
  s_cmp_lg_u32 s16, 0
  s_cbranch_scc1 Lxt_skip
  s_or_b32 s20, s66, s17
  v_mov_b32 v7, s20
  s_lshl_b32 s20, s2, 2
  s_add_u32 s20, s20, 0xd19000
  v_mov_b32 v8, 0
  s_mov_b64 exec, 1
  buffer_store_dword v7, v8, s[8:11], s20 offen sc1
  s_mov_b64 exec, -1
Lxt_skip:
  s_and_b32 s57, s2, 3
  s_lshl_b32 s57, s57, 2
  s_bfe_u32 s63, s2, 0x20003
  s_add_u32 s57, s57, s63
  s_bfe_u32 s56, s2, 0x10002
  s_lshl_b32 s56, s56, 3
  s_lshr_b32 s63, s2, 5
  s_add_u32 s56, s56, s63
  s_mul_i32 s56, s56, 86016
  s_mul_i32 s57, s16, 21504
  s_add_u32 s56, s56, s57
  s_mov_b32 m0, s57
  s_add_u32 s57, s57, 4096
  buffer_load_dwordx4 v4, s[8:11], s56 offen offset:0 lds
  buffer_load_dwordx4 v4, s[8:11], s56 offen offset:1024 lds
  buffer_load_dwordx4 v4, s[8:11], s56 offen offset:2048 lds
  buffer_load_dwordx4 v4, s[8:11], s56 offen offset:3072 lds
  s_add_u32 s56, s56, 4096
  s_mov_b32 m0, s57
  s_add_u32 s57, s57, 4096
  buffer_load_dwordx4 v4, s[8:11], s56 offen offset:0 lds
  buffer_load_dwordx4 v4, s[8:11], s56 offen offset:1024 lds
  buffer_load_dwordx4 v4, s[8:11], s56 offen offset:2048 lds
  buffer_load_dwordx4 v4, s[8:11], s56 offen offset:3072 lds
  s_add_u32 s56, s56, 4096
  s_mov_b32 m0, s57
  s_add_u32 s57, s57, 4096
  buffer_load_dwordx4 v4, s[8:11], s56 offen offset:0 lds
  buffer_load_dwordx4 v4, s[8:11], s56 offen offset:1024 lds
  buffer_load_dwordx4 v4, s[8:11], s56 offen offset:2048 lds
  buffer_load_dwordx4 v4, s[8:11], s56 offen offset:3072 lds
  s_add_u32 s56, s56, 4096
  s_mov_b32 m0, s57
  s_add_u32 s57, s57, 4096
  buffer_load_dwordx4 v4, s[8:11], s56 offen offset:0 lds
  buffer_load_dwordx4 v4, s[8:11], s56 offen offset:1024 lds
  buffer_load_dwordx4 v4, s[8:11], s56 offen offset:2048 lds
  buffer_load_dwordx4 v4, s[8:11], s56 offen offset:3072 lds
  s_add_u32 s56, s56, 4096
  s_mov_b32 m0, s57
  s_add_u32 s57, s57, 4096
  buffer_load_dwordx4 v4, s[8:11], s56 offen offset:0 lds
  buffer_load_dwordx4 v4, s[8:11], s56 offen offset:1024 lds
  buffer_load_dwordx4 v4, s[8:11], s56 offen offset:2048 lds
  buffer_load_dwordx4 v4, s[8:11], s56 offen offset:3072 lds
  s_add_u32 s56, s56, 4096
  s_mov_b32 m0, s57
  s_add_u32 s57, s57, 4096
  buffer_load_dwordx4 v4, s[8:11], s56 offen offset:0 lds
Lmain_layer:
  s_and_b32 s25, s2, 7
  s_lshl_b32 s25, s25, 1
  s_bfe_u32 s26, s2, 0x10003
  s_add_u32 s25, s25, s26
  s_lshr_b32 s26, s2, 4
  s_cmp_lg_u32 s3, 0
  s_cbranch_scc1 Lq_map1
  s_and_b32 s25, s2, 3
  s_lshl_b32 s25, s25, 2
  s_bfe_u32 s63, s2, 0x20003
  s_add_u32 s25, s25, s63
  s_bfe_u32 s26, s2, 0x10002
  s_lshl_b32 s26, s26, 3
  s_lshr_b32 s63, s2, 5
  s_add_u32 s26, s26, s63
Lq_map1:
  s_lshl_b32 s27, s25, 2
  s_add_u32 s27, s27, s16
  s_lshl_b32 s32, s3, 1
  s_mul_i32 s32, s32, s19
  s_add_u32 s32, s32, 0x500000
  s_mul_i32 s33, s27, 28672
  s_add_u32 s32, s32, s33
  s_mul_i32 s28, s3, 0x80000
  s_add_u32 s28, s28, 0xc00000
  s_lshl_b32 s29, s27, 8
  s_add_u32 s28, s28, s29
  s_cmp_lg_u32 s3, 0
  s_cbranch_scc1 Lq_l1
  buffer_load_dwordx4 a[0:3], v4, s[8:11], s32 offen offset:0 sc1
  buffer_load_dwordx4 a[4:7], v4, s[8:11], s32 offen offset:1024 sc1
  buffer_load_dwordx4 a[8:11], v4, s[8:11], s32 offen offset:2048 sc1
  buffer_load_dwordx4 a[12:15], v4, s[8:11], s32 offen offset:3072 sc1
  s_add_u32 s32, s32, 4096
  buffer_load_dwordx4 a[16:19], v4, s[8:11], s32 offen offset:0 sc1
  buffer_load_dwordx4 a[20:23], v4, s[8:11], s32 offen offset:1024 sc1
  buffer_load_dwordx4 a[24:27], v4, s[8:11], s32 offen offset:2048 sc1
  buffer_load_dwordx4 a[28:31], v4, s[8:11], s32 offen offset:3072 sc1
  s_add_u32 s32, s32, 4096
  s_waitcnt vmcnt(8)
  s_barrier
  s_branch Lq_go1
Lq_l1:
  s_lshl_b32 s30, s25, 7
  s_add_u32 s30, s30, 0xd12000
  s_cmp_lg_u32 s16, 0
  s_cbranch_scc1 Lq_fx_oth
  v_min_u32 v6, 13, v1
  v_lshlrev_b32 v6, 2, v6
  s_mov_b32 s62, 0
Lq_fx_poll:
  buffer_load_dword v7, v6, s[8:11], s30 offen sc1
  s_add_u32 s62, s62, 1
  s_cmp_gt_u32 s62, 300000
  s_cbranch_scc1 Lq_fx_to
  s_waitcnt vmcnt(0)
  v_cmp_ne_u32 vcc, s66, v7
  s_cbranch_vccnz Lq_fx_poll
Lq_fx_to:
  s_waitcnt vmcnt(0)
  s_branch Lq_fx_go
Lq_fx_oth:
  s_waitcnt vmcnt(0)
Lq_fx_go:
  s_barrier
  buffer_load_dwordx4 a[0:3], v4, s[8:11], s32 offen offset:0 sc1
  buffer_load_dwordx4 a[4:7], v4, s[8:11], s32 offen offset:1024 sc1
  buffer_load_dwordx4 a[8:11], v4, s[8:11], s32 offen offset:2048 sc1
  buffer_load_dwordx4 a[12:15], v4, s[8:11], s32 offen offset:3072 sc1
  s_add_u32 s32, s32, 4096
  buffer_load_dwordx4 a[16:19], v4, s[8:11], s32 offen offset:0 sc1
  buffer_load_dwordx4 a[20:23], v4, s[8:11], s32 offen offset:1024 sc1
  buffer_load_dwordx4 a[24:27], v4, s[8:11], s32 offen offset:2048 sc1
  buffer_load_dwordx4 a[28:31], v4, s[8:11], s32 offen offset:3072 sc1
  s_add_u32 s32, s32, 4096
Lq_go1:
  v_add_u32 v11, 43008, v4
  ds_read_b128 v[64:67], v4 offset:0
  ds_read_b128 v[68:71], v4 offset:1024
  ds_read_b128 v[72:75], v4 offset:3072
  ds_read_b128 v[76:79], v4 offset:4096
  s_waitcnt vmcnt(7)
  s_waitcnt lgkmcnt(2)
  v_mfma_f32_32x32x16_bf16 v[16:31], v[64:67], a[0:3], 0
  v_mfma_f32_32x32x16_bf16 v[32:47], v[68:71], a[0:3], 0
  buffer_load_dwordx4 a[32:35], v4, s[8:11], s32 offen offset:0 sc1
  buffer_load_dwordx4 a[36:39], v4, s[8:11], s32 offen offset:1024 sc1
  ds_read_b128 v[64:67], v4 offset:6144
  ds_read_b128 v[68:71], v4 offset:7168
  s_waitcnt vmcnt(8)
  s_waitcnt lgkmcnt(2)
  v_mfma_f32_32x32x16_bf16 v[16:31], v[72:75], a[4:7], v[16:31]
  v_mfma_f32_32x32x16_bf16 v[32:47], v[76:79], a[4:7], v[32:47]
  buffer_load_dwordx4 a[40:43], v4, s[8:11], s32 offen offset:2048 sc1
  buffer_load_dwordx4 a[44:47], v4, s[8:11], s32 offen offset:3072 sc1
  s_add_u32 s32, s32, 4096
  ds_read_b128 v[72:75], v4 offset:9216
  ds_read_b128 v[76:79], v4 offset:10240
  s_waitcnt vmcnt(9)
  s_waitcnt lgkmcnt(2)
  v_mfma_f32_32x32x16_bf16 v[16:31], v[64:67], a[8:11], v[16:31]
  v_mfma_f32_32x32x16_bf16 v[32:47], v[68:71], a[8:11], v[32:47]
  buffer_load_dwordx4 a[48:51], v4, s[8:11], s32 offen offset:0 sc1
  buffer_load_dwordx4 a[52:55], v4, s[8:11], s32 offen offset:1024 sc1
  ds_read_b128 v[64:67], v4 offset:12288
  ds_read_b128 v[68:71], v4 offset:13312
  s_waitcnt vmcnt(10)
  s_waitcnt lgkmcnt(2)
  v_mfma_f32_32x32x16_bf16 v[16:31], v[72:75], a[12:15], v[16:31]
  v_mfma_f32_32x32x16_bf16 v[32:47], v[76:79], a[12:15], v[32:47]
  buffer_load_dwordx4 a[56:59], v4, s[8:11], s32 offen offset:2048 sc1
  buffer_load_dwordx4 a[60:63], v4, s[8:11], s32 offen offset:3072 sc1
  s_add_u32 s32, s32, 4096
  ds_read_b128 v[72:75], v4 offset:15360
  ds_read_b128 v[76:79], v4 offset:16384
  s_waitcnt vmcnt(11)
  s_waitcnt lgkmcnt(2)
  v_mfma_f32_32x32x16_bf16 v[16:31], v[64:67], a[16:19], v[16:31]
  v_mfma_f32_32x32x16_bf16 v[32:47], v[68:71], a[16:19], v[32:47]
  buffer_load_dwordx4 a[64:67], v4, s[8:11], s32 offen offset:0 sc1
  ds_read_b128 v[64:67], v4 offset:18432
  ds_read_b128 v[68:71], v4 offset:19456
  s_waitcnt vmcnt(11)
  s_waitcnt lgkmcnt(2)
  v_mfma_f32_32x32x16_bf16 v[16:31], v[72:75], a[20:23], v[16:31]
  v_mfma_f32_32x32x16_bf16 v[32:47], v[76:79], a[20:23], v[32:47]
  buffer_load_dwordx4 a[68:71], v4, s[8:11], s32 offen offset:1024 sc1
  ds_read_b128 v[72:75], v4 offset:21504
  ds_read_b128 v[76:79], v4 offset:22528
  s_waitcnt vmcnt(11)
  s_waitcnt lgkmcnt(2)
  v_mfma_f32_32x32x16_bf16 v[16:31], v[64:67], a[24:27], v[16:31]
  v_mfma_f32_32x32x16_bf16 v[32:47], v[68:71], a[24:27], v[32:47]
  buffer_load_dwordx4 a[72:75], v4, s[8:11], s32 offen offset:2048 sc1
  ds_read_b128 v[64:67], v4 offset:24576
  ds_read_b128 v[68:71], v4 offset:25600
  s_waitcnt vmcnt(11)
  s_waitcnt lgkmcnt(2)
  v_mfma_f32_32x32x16_bf16 v[16:31], v[72:75], a[28:31], v[16:31]
  v_mfma_f32_32x32x16_bf16 v[32:47], v[76:79], a[28:31], v[32:47]
  buffer_load_dwordx4 a[76:79], v4, s[8:11], s32 offen offset:3072 sc1
  s_add_u32 s32, s32, 4096
  ds_read_b128 v[72:75], v4 offset:27648
  ds_read_b128 v[76:79], v4 offset:28672
  s_waitcnt vmcnt(11)
  s_waitcnt lgkmcnt(2)
  v_mfma_f32_32x32x16_bf16 v[16:31], v[64:67], a[32:35], v[16:31]
  v_mfma_f32_32x32x16_bf16 v[32:47], v[68:71], a[32:35], v[32:47]
  buffer_load_dwordx4 a[80:83], v4, s[8:11], s32 offen offset:0 sc1
  ds_read_b128 v[64:67], v4 offset:30720
  ds_read_b128 v[68:71], v4 offset:31744
  s_waitcnt vmcnt(11)
  s_waitcnt lgkmcnt(2)
  v_mfma_f32_32x32x16_bf16 v[16:31], v[72:75], a[36:39], v[16:31]
  v_mfma_f32_32x32x16_bf16 v[32:47], v[76:79], a[36:39], v[32:47]
  buffer_load_dwordx4 a[84:87], v4, s[8:11], s32 offen offset:1024 sc1
  ds_read_b128 v[72:75], v4 offset:33792
  ds_read_b128 v[76:79], v4 offset:34816
  s_waitcnt vmcnt(11)
  s_waitcnt lgkmcnt(2)
  v_mfma_f32_32x32x16_bf16 v[16:31], v[64:67], a[40:43], v[16:31]
  v_mfma_f32_32x32x16_bf16 v[32:47], v[68:71], a[40:43], v[32:47]
  buffer_load_dwordx4 a[88:91], v4, s[8:11], s32 offen offset:2048 sc1
  ds_read_b128 v[64:67], v4 offset:36864
  ds_read_b128 v[68:71], v4 offset:37888
  s_waitcnt vmcnt(11)
  s_waitcnt lgkmcnt(2)
  v_mfma_f32_32x32x16_bf16 v[16:31], v[72:75], a[44:47], v[16:31]
  v_mfma_f32_32x32x16_bf16 v[32:47], v[76:79], a[44:47], v[32:47]
  buffer_load_dwordx4 a[92:95], v4, s[8:11], s32 offen offset:3072 sc1
  s_add_u32 s32, s32, 4096
  ds_read_b128 v[72:75], v4 offset:39936
  ds_read_b128 v[76:79], v4 offset:40960
  s_waitcnt vmcnt(11)
  s_waitcnt lgkmcnt(2)
  v_mfma_f32_32x32x16_bf16 v[16:31], v[64:67], a[48:51], v[16:31]
  v_mfma_f32_32x32x16_bf16 v[32:47], v[68:71], a[48:51], v[32:47]
  buffer_load_dwordx4 v[192:195], v4, s[8:11], s32 offen offset:0 sc1
  ds_read_b128 v[64:67], v11 offset:0
  ds_read_b128 v[68:71], v11 offset:1024
  s_waitcnt vmcnt(11)
  s_waitcnt lgkmcnt(2)
  v_mfma_f32_32x32x16_bf16 v[16:31], v[72:75], a[52:55], v[16:31]
  v_mfma_f32_32x32x16_bf16 v[32:47], v[76:79], a[52:55], v[32:47]
  buffer_load_dwordx4 v[196:199], v4, s[8:11], s32 offen offset:1024 sc1
  ds_read_b128 v[72:75], v11 offset:3072
  ds_read_b128 v[76:79], v11 offset:4096
  s_waitcnt vmcnt(11)
  s_waitcnt lgkmcnt(2)
  v_mfma_f32_32x32x16_bf16 v[16:31], v[64:67], a[56:59], v[16:31]
  v_mfma_f32_32x32x16_bf16 v[32:47], v[68:71], a[56:59], v[32:47]
  buffer_load_dwordx4 v[200:203], v4, s[8:11], s32 offen offset:2048 sc1
  ds_read_b128 v[64:67], v11 offset:6144
  ds_read_b128 v[68:71], v11 offset:7168
  s_waitcnt vmcnt(11)
  s_waitcnt lgkmcnt(2)
  v_mfma_f32_32x32x16_bf16 v[16:31], v[72:75], a[60:63], v[16:31]
  v_mfma_f32_32x32x16_bf16 v[32:47], v[76:79], a[60:63], v[32:47]
  buffer_load_dwordx4 v[204:207], v4, s[8:11], s32 offen offset:3072 sc1
  s_add_u32 s32, s32, 4096
  ds_read_b128 v[72:75], v11 offset:9216
  ds_read_b128 v[76:79], v11 offset:10240
  s_waitcnt vmcnt(11)
  s_waitcnt lgkmcnt(2)
  v_mfma_f32_32x32x16_bf16 v[16:31], v[64:67], a[64:67], v[16:31]
  v_mfma_f32_32x32x16_bf16 v[32:47], v[68:71], a[64:67], v[32:47]
  ds_read_b128 v[64:67], v11 offset:12288
  ds_read_b128 v[68:71], v11 offset:13312
  s_waitcnt vmcnt(10)
  s_waitcnt lgkmcnt(2)
  v_mfma_f32_32x32x16_bf16 v[16:31], v[72:75], a[68:71], v[16:31]
  v_mfma_f32_32x32x16_bf16 v[32:47], v[76:79], a[68:71], v[32:47]
  ds_read_b128 v[72:75], v11 offset:15360
  ds_read_b128 v[76:79], v11 offset:16384
  s_waitcnt vmcnt(9)
  s_waitcnt lgkmcnt(2)
  v_mfma_f32_32x32x16_bf16 v[16:31], v[64:67], a[72:75], v[16:31]
  v_mfma_f32_32x32x16_bf16 v[32:47], v[68:71], a[72:75], v[32:47]
  s_mov_b32 s29, s28
  buffer_load_dwordx2 v[96:97], v5, s[8:11], s29 offen sc1
  s_add_u32 s29, s29, 32768
  buffer_load_dwordx2 v[98:99], v5, s[8:11], s29 offen sc1
  s_add_u32 s29, s29, 32768
  buffer_load_dwordx2 v[100:101], v5, s[8:11], s29 offen sc1
  s_add_u32 s29, s29, 32768
  buffer_load_dwordx2 v[102:103], v5, s[8:11], s29 offen sc1
  s_add_u32 s29, s29, 32768
  buffer_load_dwordx2 v[104:105], v5, s[8:11], s29 offen sc1
  s_add_u32 s29, s29, 32768
  buffer_load_dwordx2 v[106:107], v5, s[8:11], s29 offen sc1
  s_add_u32 s29, s29, 32768
  buffer_load_dwordx2 v[108:109], v5, s[8:11], s29 offen sc1
  ds_read_b128 v[64:67], v11 offset:18432
  ds_read_b128 v[68:71], v11 offset:19456
  s_waitcnt vmcnt(15)
  s_waitcnt lgkmcnt(2)
  v_mfma_f32_32x32x16_bf16 v[16:31], v[72:75], a[76:79], v[16:31]
  v_mfma_f32_32x32x16_bf16 v[32:47], v[76:79], a[76:79], v[32:47]
  ds_read_b128 v[72:75], v11 offset:21504
  ds_read_b128 v[76:79], v11 offset:22528
  s_waitcnt vmcnt(14)
  s_waitcnt lgkmcnt(2)
  v_mfma_f32_32x32x16_bf16 v[16:31], v[64:67], a[80:83], v[16:31]
  v_mfma_f32_32x32x16_bf16 v[32:47], v[68:71], a[80:83], v[32:47]
  ds_read_b128 v[64:67], v11 offset:24576
  ds_read_b128 v[68:71], v11 offset:25600
  s_waitcnt vmcnt(13)
  s_waitcnt lgkmcnt(2)
  v_mfma_f32_32x32x16_bf16 v[16:31], v[72:75], a[84:87], v[16:31]
  v_mfma_f32_32x32x16_bf16 v[32:47], v[76:79], a[84:87], v[32:47]
  ds_read_b128 v[72:75], v11 offset:27648
  ds_read_b128 v[76:79], v11 offset:28672
  s_waitcnt vmcnt(12)
  s_waitcnt lgkmcnt(2)
  v_mfma_f32_32x32x16_bf16 v[16:31], v[64:67], a[88:91], v[16:31]
  v_mfma_f32_32x32x16_bf16 v[32:47], v[68:71], a[88:91], v[32:47]
  ds_read_b128 v[64:67], v11 offset:30720
  ds_read_b128 v[68:71], v11 offset:31744
  s_waitcnt vmcnt(11)
  s_waitcnt lgkmcnt(2)
  v_mfma_f32_32x32x16_bf16 v[16:31], v[72:75], a[92:95], v[16:31]
  v_mfma_f32_32x32x16_bf16 v[32:47], v[76:79], a[92:95], v[32:47]
  ds_read_b128 v[72:75], v11 offset:33792
  ds_read_b128 v[76:79], v11 offset:34816
  s_waitcnt vmcnt(10)
  s_waitcnt lgkmcnt(2)
  v_mfma_f32_32x32x16_bf16 v[16:31], v[64:67], v[192:195], v[16:31]
  v_mfma_f32_32x32x16_bf16 v[32:47], v[68:71], v[192:195], v[32:47]
  ds_read_b128 v[64:67], v11 offset:36864
  ds_read_b128 v[68:71], v11 offset:37888
  s_waitcnt vmcnt(9)
  s_waitcnt lgkmcnt(2)
  v_mfma_f32_32x32x16_bf16 v[16:31], v[72:75], v[196:199], v[16:31]
  v_mfma_f32_32x32x16_bf16 v[32:47], v[76:79], v[196:199], v[32:47]
  ds_read_b128 v[72:75], v11 offset:39936
  ds_read_b128 v[76:79], v11 offset:40960
  s_waitcnt vmcnt(8)
  s_waitcnt lgkmcnt(2)
  v_mfma_f32_32x32x16_bf16 v[16:31], v[64:67], v[200:203], v[16:31]
  v_mfma_f32_32x32x16_bf16 v[32:47], v[68:71], v[200:203], v[32:47]
  s_waitcnt vmcnt(7)
  s_waitcnt lgkmcnt(0)
  v_mfma_f32_32x32x16_bf16 v[16:31], v[72:75], v[204:207], v[16:31]
  v_mfma_f32_32x32x16_bf16 v[32:47], v[76:79], v[204:207], v[32:47]
  s_mul_i32 s35, s3, 0x600000
  s_add_u32 s35, s35, 0xe00000
  s_lshl_b32 s36, s26, 6
  s_add_u32 s36, s36, s27
  s_lshl_b32 s37, s36, 11
  s_add_u32 s35, s35, s37
  s_add_u32 s39, s35, 0x200000
  s_add_u32 s59, s35, 0x400000
  s_mul_i32 s38, s3, 0x2000
  s_add_u32 s38, s38, 0xd00000
  s_lshl_b32 s37, s36, 2
  s_add_u32 s38, s38, s37
  s_add_u32 s60, s38, 0x1000
  s_lshl_b32 s34, s16, 7
  s_add_u32 s34, s34, 114688
  ds_read_b128 v[64:67], v4 offset:2048
  ds_read_b128 v[68:71], v4 offset:5120
  ds_read_b128 v[72:75], v4 offset:8192
  ds_read_b128 v[76:79], v4 offset:11264
  s_waitcnt lgkmcnt(3)
  v_mfma_f32_32x32x16_bf16 v[48:63], a[0:3], v[64:67], 0
  ds_read_b128 v[64:67], v4 offset:14336
  s_waitcnt lgkmcnt(3)
  v_mfma_f32_32x32x16_bf16 v[48:63], a[4:7], v[68:71], v[48:63]
  ds_read_b128 v[68:71], v4 offset:17408
  s_waitcnt lgkmcnt(3)
  v_mfma_f32_32x32x16_bf16 v[48:63], a[8:11], v[72:75], v[48:63]
  s_waitcnt vmcnt(0)
  v_add_f32 v96, v96, v98
  v_add_f32 v97, v97, v99
  v_add_f32 v96, v96, v100
  ds_read_b128 v[72:75], v4 offset:20480
  s_waitcnt lgkmcnt(3)
  v_mfma_f32_32x32x16_bf16 v[48:63], a[12:15], v[76:79], v[48:63]
  v_add_f32 v97, v97, v101
  v_add_f32 v96, v96, v102
  v_add_f32 v97, v97, v103
  v_add_f32 v96, v96, v104
  ds_read_b128 v[76:79], v4 offset:23552
  s_waitcnt lgkmcnt(3)
  v_mfma_f32_32x32x16_bf16 v[48:63], a[16:19], v[64:67], v[48:63]
  v_add_f32 v97, v97, v105
  v_add_f32 v96, v96, v106
  v_add_f32 v97, v97, v107
  v_add_f32 v96, v96, v108
  ds_read_b128 v[64:67], v4 offset:26624
  s_waitcnt lgkmcnt(3)
  v_mfma_f32_32x32x16_bf16 v[48:63], a[20:23], v[68:71], v[48:63]
  v_add_f32 v97, v97, v109
  v_mov_b32 v98, v96
  v_mov_b32 v99, v97
  s_nop 1
  ds_read_b128 v[68:71], v4 offset:29696
  s_waitcnt lgkmcnt(3)
  v_mfma_f32_32x32x16_bf16 v[48:63], a[24:27], v[72:75], v[48:63]
  v_permlane32_swap_b32 v96, v98
  v_permlane32_swap_b32 v97, v99
  s_nop 1
  v_add_f32 v96, v96, v98
  ds_read_b128 v[72:75], v4 offset:32768
  s_waitcnt lgkmcnt(3)
  v_mfma_f32_32x32x16_bf16 v[48:63], a[28:31], v[76:79], v[48:63]
  v_add_f32 v97, v97, v99
  v_mul_f32 v96, 0x3b124925, v96
  v_mul_f32 v97, 0x3b124925, v97
  v_fma_f32 v97, -v96, v96, v97
  ds_read_b128 v[76:79], v4 offset:35840
  s_waitcnt lgkmcnt(3)
  v_mfma_f32_32x32x16_bf16 v[48:63], a[32:35], v[64:67], v[48:63]
  v_max_f32 v97, 0, v97
  v_add_f32 v97, 0x3727c5ac, v97
  v_rsq_f32 v90, v97
  s_nop 0
  ds_read_b128 v[64:67], v4 offset:38912
  s_waitcnt lgkmcnt(3)
  v_mfma_f32_32x32x16_bf16 v[48:63], a[36:39], v[68:71], v[48:63]
  v_lshl_add_u32 v8, v2, 2, s34
  ds_write_b32 v8, v90
  v_lshl_add_u32 v9, v3, 4, s34
  v_mul_f32 v16, v16, v90
  ds_read_b128 v[68:71], v4 offset:41984
  s_waitcnt lgkmcnt(3)
  v_mfma_f32_32x32x16_bf16 v[48:63], a[40:43], v[72:75], v[48:63]
  v_mul_f32 v17, v17, v90
  v_mul_f32 v18, v18, v90
  v_mul_f32 v19, v19, v90
  ds_read_b128 v[72:75], v11 offset:2048
  s_waitcnt lgkmcnt(3)
  v_mfma_f32_32x32x16_bf16 v[48:63], a[44:47], v[76:79], v[48:63]
  v_mul_f32 v20, v20, v90
  v_mul_f32 v21, v21, v90
  v_mul_f32 v22, v22, v90
  v_mul_f32 v23, v23, v90
  ds_read_b128 v[76:79], v11 offset:5120
  s_waitcnt lgkmcnt(3)
  v_mfma_f32_32x32x16_bf16 v[48:63], a[48:51], v[64:67], v[48:63]
  v_mul_f32 v24, v24, v90
  v_mul_f32 v25, v25, v90
  v_mul_f32 v26, v26, v90
  v_mul_f32 v27, v27, v90
  ds_read_b128 v[64:67], v11 offset:8192
  s_waitcnt lgkmcnt(3)
  v_mfma_f32_32x32x16_bf16 v[48:63], a[52:55], v[68:71], v[48:63]
  v_mul_f32 v28, v28, v90
  v_mul_f32 v29, v29, v90
  v_mul_f32 v30, v30, v90
  v_mul_f32 v31, v31, v90
  ds_read_b128 v[68:71], v11 offset:11264
  s_waitcnt lgkmcnt(3)
  v_mfma_f32_32x32x16_bf16 v[48:63], a[56:59], v[72:75], v[48:63]
  v_cvt_pk_bf16_f32 v96, v16, v17
  v_cvt_pk_bf16_f32 v97, v18, v19
  v_cvt_pk_bf16_f32 v98, v20, v21
  v_cvt_pk_bf16_f32 v99, v22, v23
  ds_read_b128 v[72:75], v11 offset:14336
  s_waitcnt lgkmcnt(3)
  v_mfma_f32_32x32x16_bf16 v[48:63], a[60:63], v[76:79], v[48:63]
  v_cvt_pk_bf16_f32 v100, v24, v25
  v_cvt_pk_bf16_f32 v101, v26, v27
  v_cvt_pk_bf16_f32 v102, v28, v29
  v_cvt_pk_bf16_f32 v103, v30, v31
  ds_read_b128 v[76:79], v11 offset:17408
  s_waitcnt lgkmcnt(3)
  v_mfma_f32_32x32x16_bf16 v[48:63], a[64:67], v[64:67], v[48:63]
  buffer_store_dwordx4 v[96:99], v4, s[8:11], s35 offen sc1
  buffer_store_dwordx4 v[100:103], v4, s[8:11], s35 offen offset:1024 sc1
  v_mov_b32 v92, 0
  v_dot2_f32_bf16 v92, v96, v96, v92
  ds_read_b128 v[64:67], v11 offset:20480
  s_waitcnt lgkmcnt(3)
  v_mfma_f32_32x32x16_bf16 v[48:63], a[68:71], v[68:71], v[48:63]
  v_dot2_f32_bf16 v92, v97, v97, v92
  v_dot2_f32_bf16 v92, v98, v98, v92
  v_dot2_f32_bf16 v92, v99, v99, v92
  v_dot2_f32_bf16 v92, v100, v100, v92
  ds_read_b128 v[68:71], v11 offset:23552
  s_waitcnt lgkmcnt(3)
  v_mfma_f32_32x32x16_bf16 v[48:63], a[72:75], v[72:75], v[48:63]
  v_dot2_f32_bf16 v92, v101, v101, v92
  v_dot2_f32_bf16 v92, v102, v102, v92
  v_dot2_f32_bf16 v92, v103, v103, v92
  v_mul_f32 v32, v32, v90
  ds_read_b128 v[72:75], v11 offset:26624
  s_waitcnt lgkmcnt(3)
  v_mfma_f32_32x32x16_bf16 v[48:63], a[76:79], v[76:79], v[48:63]
  v_mul_f32 v33, v33, v90
  v_mul_f32 v34, v34, v90
  v_mul_f32 v35, v35, v90
  ds_read_b128 v[76:79], v11 offset:29696
  s_waitcnt lgkmcnt(3)
  v_mfma_f32_32x32x16_bf16 v[48:63], a[80:83], v[64:67], v[48:63]
  v_mul_f32 v36, v36, v90
  v_mul_f32 v37, v37, v90
  v_mul_f32 v38, v38, v90
  v_mul_f32 v39, v39, v90
  ds_read_b128 v[64:67], v11 offset:32768
  s_waitcnt lgkmcnt(3)
  v_mfma_f32_32x32x16_bf16 v[48:63], a[84:87], v[68:71], v[48:63]
  v_mul_f32 v40, v40, v90
  v_mul_f32 v41, v41, v90
  v_mul_f32 v42, v42, v90
  v_mul_f32 v43, v43, v90
  ds_read_b128 v[68:71], v11 offset:35840
  s_waitcnt lgkmcnt(3)
  v_mfma_f32_32x32x16_bf16 v[48:63], a[88:91], v[72:75], v[48:63]
  v_mul_f32 v44, v44, v90
  v_mul_f32 v45, v45, v90
  v_mul_f32 v46, v46, v90
  v_mul_f32 v47, v47, v90
  ds_read_b128 v[72:75], v11 offset:38912
  s_waitcnt lgkmcnt(3)
  v_mfma_f32_32x32x16_bf16 v[48:63], a[92:95], v[76:79], v[48:63]
  v_cvt_pk_bf16_f32 v104, v32, v33
  v_cvt_pk_bf16_f32 v105, v34, v35
  v_cvt_pk_bf16_f32 v106, v36, v37
  v_cvt_pk_bf16_f32 v107, v38, v39
  ds_read_b128 v[76:79], v11 offset:41984
  s_waitcnt lgkmcnt(3)
  v_mfma_f32_32x32x16_bf16 v[48:63], v[192:195], v[64:67], v[48:63]
  v_cvt_pk_bf16_f32 v108, v40, v41
  v_cvt_pk_bf16_f32 v109, v42, v43
  v_cvt_pk_bf16_f32 v110, v44, v45
  v_cvt_pk_bf16_f32 v111, v46, v47
  s_waitcnt lgkmcnt(2)
  v_mfma_f32_32x32x16_bf16 v[48:63], v[196:199], v[68:71], v[48:63]
  buffer_store_dwordx4 v[104:107], v4, s[8:11], s39 offen sc1
  buffer_store_dwordx4 v[108:111], v4, s[8:11], s39 offen offset:1024 sc1
  v_mov_b32 v93, 0
  v_dot2_f32_bf16 v93, v104, v104, v93
  s_waitcnt lgkmcnt(1)
  v_mfma_f32_32x32x16_bf16 v[48:63], v[200:203], v[72:75], v[48:63]
  v_dot2_f32_bf16 v93, v105, v105, v93
  v_dot2_f32_bf16 v93, v106, v106, v93
  v_dot2_f32_bf16 v93, v107, v107, v93
  v_dot2_f32_bf16 v93, v108, v108, v93
  s_waitcnt lgkmcnt(0)
  v_mfma_f32_32x32x16_bf16 v[48:63], v[204:207], v[76:79], v[48:63]
  v_dot2_f32_bf16 v93, v109, v109, v93
  v_dot2_f32_bf16 v93, v110, v110, v93
  v_dot2_f32_bf16 v93, v111, v111, v93
Lq_tailc:
  s_mov_b32 s20, 0xd19000
  buffer_load_dwordx4 v[16:19], v4, s[8:11], s20 offen sc1
  ds_read_b128 v[112:115], v9 offset:0
  ds_read_b128 v[116:119], v9 offset:32
  ds_read_b128 v[120:123], v9 offset:64
  ds_read_b128 v[124:127], v9 offset:96
  v_mov_b32 v94, v92
  v_mov_b32 v95, v93
  s_nop 0
  v_permlane32_swap_b32 v92, v94
  v_permlane32_swap_b32 v93, v95
  s_nop 0
  v_add_f32 v92, v92, v94
  v_add_f32 v93, v93, v95
  s_nop 0
  v_max_f32_dpp v92, v92, v92 row_ror:8 row_mask:0xf bank_mask:0xf
  v_max_f32_dpp v93, v93, v93 row_ror:8 row_mask:0xf bank_mask:0xf
  s_nop 0
  v_max_f32_dpp v92, v92, v92 row_ror:4 row_mask:0xf bank_mask:0xf
  v_max_f32_dpp v93, v93, v93 row_ror:4 row_mask:0xf bank_mask:0xf
  s_nop 0
  v_max_f32_dpp v92, v92, v92 row_ror:2 row_mask:0xf bank_mask:0xf
  v_max_f32_dpp v93, v93, v93 row_ror:2 row_mask:0xf bank_mask:0xf
  s_nop 0
  v_max_f32_dpp v92, v92, v92 row_ror:1 row_mask:0xf bank_mask:0xf
  v_max_f32_dpp v93, v93, v93 row_ror:1 row_mask:0xf bank_mask:0xf
  s_nop 1
  v_readlane_b32 s52, v92, 0
  v_readlane_b32 s53, v92, 16
  v_readlane_b32 s54, v93, 0
  v_readlane_b32 s55, v93, 16
  v_cmp_eq_u32 vcc, 28, v2
  v_mov_b32 v92, 0
  v_mov_b32 v93, 1.0
  v_cndmask_b32 v92, v92, v93, vcc
  v_cmp_le_u32 vcc, 28, v2
  s_max_u32 s52, s52, s53
  s_max_u32 s54, s54, s55
  s_waitcnt lgkmcnt(0)
  v_pk_mul_f32 v[48:49], v[48:49], v[112:113]
  v_pk_mul_f32 v[50:51], v[50:51], v[114:115]
  v_pk_mul_f32 v[52:53], v[52:53], v[116:117]
  v_pk_mul_f32 v[54:55], v[54:55], v[118:119]
  v_pk_mul_f32 v[56:57], v[56:57], v[120:121]
  v_pk_mul_f32 v[58:59], v[58:59], v[122:123]
  v_pk_mul_f32 v[60:61], v[60:61], v[124:125]
  v_pk_mul_f32 v[62:63], v[62:63], v[126:127]
  v_cndmask_b32 v48, v48, v92, vcc
  v_cndmask_b32 v49, v49, v92, vcc
  v_cndmask_b32 v50, v50, v92, vcc
  v_cndmask_b32 v51, v51, v92, vcc
  v_cndmask_b32 v52, v52, v92, vcc
  v_cndmask_b32 v53, v53, v92, vcc
  v_cndmask_b32 v54, v54, v92, vcc
  v_cndmask_b32 v55, v55, v92, vcc
  v_cndmask_b32 v56, v56, v92, vcc
  v_cndmask_b32 v57, v57, v92, vcc
  v_cndmask_b32 v58, v58, v92, vcc
  v_cndmask_b32 v59, v59, v92, vcc
  v_cndmask_b32 v60, v60, v92, vcc
  v_cndmask_b32 v61, v61, v92, vcc
  v_cndmask_b32 v62, v62, v92, vcc
  v_cndmask_b32 v63, v63, v92, vcc
  v_cvt_pk_bf16_f32 v112, v48, v49
  v_cvt_pk_bf16_f32 v113, v50, v51
  v_cvt_pk_bf16_f32 v114, v52, v53
  v_cvt_pk_bf16_f32 v115, v54, v55
  v_cvt_pk_bf16_f32 v116, v56, v57
  v_cvt_pk_bf16_f32 v117, v58, v59
  v_cvt_pk_bf16_f32 v118, v60, v61
  v_cvt_pk_bf16_f32 v119, v62, v63
  buffer_store_dwordx4 v[112:115], v4, s[8:11], s59 offen sc1
  buffer_store_dwordx4 v[116:119], v4, s[8:11], s59 offen offset:1024 sc1
  v_mov_b32 v94, s52
  v_mov_b32 v95, s54
  v_mov_b32 v8, 0
  s_mov_b64 exec, 1
  buffer_store_dword v94, v8, s[8:11], s38 offen sc1
  buffer_store_dword v95, v8, s[8:11], s60 offen sc1
  s_mov_b64 exec, -1
  s_mul_i32 s30, s3, 10240
  s_add_u32 s30, s30, 0xd10000
  s_lshl_b32 s63, s26, 7
  s_add_u32 s30, s30, s63
  s_lshl_b32 s63, s25, 2
  s_add_u32 s30, s30, s63
  s_cmp_lg_u32 s3, 0
  s_cbranch_scc1 Lq_norole
  s_waitcnt vmcnt(4)
  s_mov_b32 s20, 0xd19000
  s_and_b32 s21, s66, -8
  s_mov_b32 s62, 0
Ltr_chk:
  s_mov_b64 s[22:23], 0
  v_and_b32 v20, -8, v16
  v_cmp_ne_u32 vcc, s21, v20
  s_or_b64 s[22:23], s[22:23], vcc
  v_and_b32 v20, -8, v17
  v_cmp_ne_u32 vcc, s21, v20
  s_or_b64 s[22:23], s[22:23], vcc
  v_and_b32 v20, -8, v18
  v_cmp_ne_u32 vcc, s21, v20
  s_or_b64 s[22:23], s[22:23], vcc
  v_and_b32 v20, -8, v19
  v_cmp_ne_u32 vcc, s21, v20
  s_or_b64 s[22:23], s[22:23], vcc
  s_cmp_eq_u64 s[22:23], 0
  s_cbranch_scc1 Ltr_out
  buffer_load_dwordx4 v[16:19], v4, s[8:11], s20 offen sc1
  s_add_u32 s62, s62, 1
  s_cmp_gt_u32 s62, 300000
  s_waitcnt vmcnt(0)
  s_cbranch_scc0 Ltr_chk
Ltr_out:
  s_mov_b32 s20, 0
  v_and_b32 v16, 7, v16
  v_and_b32 v17, 7, v17
  v_and_b32 v18, 7, v18
  v_and_b32 v19, 7, v19
  v_cmp_eq_u32 s[54:55], 0, v16
  v_cmp_eq_u32 s[56:57], 0, v17
  v_cmp_eq_u32 s[58:59], 0, v18
  v_cmp_eq_u32 s[22:23], 0, v19
  s_bcnt1_i32_b64 s60, s[54:55]
  s_bcnt1_i32_b64 s61, s[56:57]
  s_bcnt1_i32_b64 s62, s[58:59]
  s_bcnt1_i32_b64 s63, s[22:23]
  s_add_u32 s60, s60, s61
  s_add_u32 s62, s62, s63
  s_add_u32 s60, s60, s62
  s_xor_b32 s60, s60, 32
  s_or_b32 s20, s20, s60
  v_cmp_eq_u32 s[54:55], 1, v16
  v_cmp_eq_u32 s[56:57], 1, v17
  v_cmp_eq_u32 s[58:59], 1, v18
  v_cmp_eq_u32 s[22:23], 1, v19
  s_bcnt1_i32_b64 s60, s[54:55]
  s_bcnt1_i32_b64 s61, s[56:57]
  s_bcnt1_i32_b64 s62, s[58:59]
  s_bcnt1_i32_b64 s63, s[22:23]
  s_add_u32 s60, s60, s61
  s_add_u32 s62, s62, s63
  s_add_u32 s60, s60, s62
  s_xor_b32 s60, s60, 32
  s_or_b32 s20, s20, s60
  v_cmp_eq_u32 s[54:55], 2, v16
  v_cmp_eq_u32 s[56:57], 2, v17
  v_cmp_eq_u32 s[58:59], 2, v18
  v_cmp_eq_u32 s[22:23], 2, v19
  s_bcnt1_i32_b64 s60, s[54:55]
  s_bcnt1_i32_b64 s61, s[56:57]
  s_bcnt1_i32_b64 s62, s[58:59]
  s_bcnt1_i32_b64 s63, s[22:23]
  s_add_u32 s60, s60, s61
  s_add_u32 s62, s62, s63
  s_add_u32 s60, s60, s62
  s_xor_b32 s60, s60, 32
  s_or_b32 s20, s20, s60
  v_cmp_eq_u32 s[54:55], 3, v16
  v_cmp_eq_u32 s[56:57], 3, v17
  v_cmp_eq_u32 s[58:59], 3, v18
  v_cmp_eq_u32 s[22:23], 3, v19
  s_bcnt1_i32_b64 s60, s[54:55]
  s_bcnt1_i32_b64 s61, s[56:57]
  s_bcnt1_i32_b64 s62, s[58:59]
  s_bcnt1_i32_b64 s63, s[22:23]
  s_add_u32 s60, s60, s61
  s_add_u32 s62, s62, s63
  s_add_u32 s60, s60, s62
  s_xor_b32 s60, s60, 32
  s_or_b32 s20, s20, s60
  v_cmp_eq_u32 s[54:55], 4, v16
  v_cmp_eq_u32 s[56:57], 4, v17
  v_cmp_eq_u32 s[58:59], 4, v18
  v_cmp_eq_u32 s[22:23], 4, v19
  s_bcnt1_i32_b64 s60, s[54:55]
  s_bcnt1_i32_b64 s61, s[56:57]
  s_bcnt1_i32_b64 s62, s[58:59]
  s_bcnt1_i32_b64 s63, s[22:23]
  s_add_u32 s60, s60, s61
  s_add_u32 s62, s62, s63
  s_add_u32 s60, s60, s62
  s_xor_b32 s60, s60, 32
  s_or_b32 s20, s20, s60
  v_cmp_eq_u32 s[54:55], 5, v16
  v_cmp_eq_u32 s[56:57], 5, v17
  v_cmp_eq_u32 s[58:59], 5, v18
  v_cmp_eq_u32 s[22:23], 5, v19
  s_bcnt1_i32_b64 s60, s[54:55]
  s_bcnt1_i32_b64 s61, s[56:57]
  s_bcnt1_i32_b64 s62, s[58:59]
  s_bcnt1_i32_b64 s63, s[22:23]
  s_add_u32 s60, s60, s61
  s_add_u32 s62, s62, s63
  s_add_u32 s60, s60, s62
  s_xor_b32 s60, s60, 32
  s_or_b32 s20, s20, s60
  v_cmp_eq_u32 s[54:55], 6, v16
  v_cmp_eq_u32 s[56:57], 6, v17
  v_cmp_eq_u32 s[58:59], 6, v18
  v_cmp_eq_u32 s[22:23], 6, v19
  s_bcnt1_i32_b64 s60, s[54:55]
  s_bcnt1_i32_b64 s61, s[56:57]
  s_bcnt1_i32_b64 s62, s[58:59]
  s_bcnt1_i32_b64 s63, s[22:23]
  s_add_u32 s60, s60, s61
  s_add_u32 s62, s62, s63
  s_add_u32 s60, s60, s62
  s_xor_b32 s60, s60, 32
  s_or_b32 s20, s20, s60
  v_cmp_eq_u32 s[54:55], 7, v16
  v_cmp_eq_u32 s[56:57], 7, v17
  v_cmp_eq_u32 s[58:59], 7, v18
  v_cmp_eq_u32 s[22:23], 7, v19
  s_bcnt1_i32_b64 s60, s[54:55]
  s_bcnt1_i32_b64 s61, s[56:57]
  s_bcnt1_i32_b64 s62, s[58:59]
  s_bcnt1_i32_b64 s63, s[22:23]
  s_add_u32 s60, s60, s61
  s_add_u32 s62, s62, s63
  s_add_u32 s60, s60, s62
  s_xor_b32 s60, s60, 32
  s_or_b32 s20, s20, s60
  s_mov_b32 s21, 0
  v_lshlrev_b32 v20, 2, v1
  v_add_u32 v21, 0, v20
  v_cmp_eq_u32 s[22:23], s17, v16
  v_cmp_gt_u32 vcc, s2, v21
  s_and_b64 vcc, vcc, s[22:23]
  s_bcnt1_i32_b64 s60, vcc
  s_add_u32 s21, s21, s60
  v_add_u32 v21, 1, v20
  v_cmp_eq_u32 s[22:23], s17, v17
  v_cmp_gt_u32 vcc, s2, v21
  s_and_b64 vcc, vcc, s[22:23]
  s_bcnt1_i32_b64 s60, vcc
  s_add_u32 s21, s21, s60
  v_add_u32 v21, 2, v20
  v_cmp_eq_u32 s[22:23], s17, v18
  v_cmp_gt_u32 vcc, s2, v21
  s_and_b64 vcc, vcc, s[22:23]
  s_bcnt1_i32_b64 s60, vcc
  s_add_u32 s21, s21, s60
  v_add_u32 v21, 3, v20
  v_cmp_eq_u32 s[22:23], s17, v19
  v_cmp_gt_u32 vcc, s2, v21
  s_and_b64 vcc, vcc, s[22:23]
  s_bcnt1_i32_b64 s60, vcc
  s_add_u32 s21, s21, s60
  s_lshl_b32 s21, s21, 3
  s_or_b32 s21, s21, s17
  s_cmp_eq_u32 s20, 0
  s_cselect_b32 s52, s21, s2
  s_cselect_b32 s53, 0, 1
  s_mov_b32 s2, s52
  s_mov_b32 s18, s53
  s_cmp_eq_u32 s18, 0
  s_cselect_b32 s19, 0x0, 0x1c0000
  v_mov_b32 v6, 0
  v_mov_b32 v7, s66
  s_cmp_lg_u32 s16, 0
  s_waitcnt vmcnt(0)
  s_barrier
  s_cbranch_scc1 Lq_fq0_nf
  s_mov_b64 exec, 1
  buffer_store_dword v7, v6, s[8:11], s30 offen sc1
  s_mov_b64 exec, -1
Lq_fq0_nf:
  s_branch Lq_tail
Lq_norole:
  v_mov_b32 v6, 0
  v_mov_b32 v7, s66
  s_cmp_lg_u32 s16, 0
  s_waitcnt vmcnt(0)
  s_barrier
  s_cbranch_scc1 Lq_fq_nf
  s_mov_b64 exec, 1
  buffer_store_dword v7, v6, s[8:11], s30 offen sc1
  s_mov_b64 exec, -1
Lq_fq_nf:
Lq_tail:
  s_cmp_lg_u32 s3, 0
  s_cbranch_scc1 Lmain_attn1
  s_and_b32 s25, s2, 7
  s_lshl_b32 s25, s25, 1
  s_bfe_u32 s26, s2, 0x10003
  s_add_u32 s25, s25, s26
  s_lshr_b32 s26, s2, 4
  s_lshr_b32 s46, s2, 4
  s_min_u32 s46, s46, 13
  s_mul_i32 s46, s46, 114688
  s_mul_i32 s47, s16, 28672
  s_add_u32 s46, s46, s47
  s_add_u32 s46, s46, 0x1c0000
  s_lshr_b32 s54, s2, 5
  s_min_u32 s54, s54, 6
  s_lshr_b32 s55, s16, 1
  s_xor_b32 s55, s55, 0
  s_lshl_b32 s63, s54, 1
  s_add_u32 s55, s55, s63
  s_lshl_b32 s63, s55, 15
  s_lshl_b32 s61, s16, 13
  s_add_u32 s63, s63, s61
  s_add_u32 s40, s63, 0x150000
  s_mul_i32 s55, s55, 114688
  s_mul_i32 s63, s16, 28672
  s_add_u32 s55, s55, s63
  s_add_u32 s52, s55, 0x348000
  s_lshr_b32 s55, s16, 1
  s_xor_b32 s55, s55, 1
  s_lshl_b32 s63, s54, 1
  s_add_u32 s55, s55, s63
  s_lshl_b32 s63, s55, 15
  s_lshl_b32 s61, s16, 13
  s_add_u32 s63, s63, s61
  s_add_u32 s41, s63, 0x150000
  s_mul_i32 s55, s55, 114688
  s_mul_i32 s63, s16, 28672
  s_add_u32 s55, s55, s63
  s_add_u32 s53, s55, 0x348000
  s_mul_i32 s27, s3, 0x2000
  s_add_u32 s27, s27, 0xd00000
  s_lshl_b32 s28, s25, 8
  s_add_u32 s27, s27, s28
  s_lshl_b32 s28, s26, 4
  s_add_u32 s28, s28, s27
  s_add_u32 s27, s27, 0x1000
  s_mul_i32 s29, s3, 0x600000
  s_add_u32 s29, s29, 0xe00000
  s_lshl_b32 s30, s25, 17
  s_add_u32 s29, s29, s30
  s_lshl_b32 s31, s16, 15
  s_add_u32 s31, s31, s29
  s_add_u32 s32, s31, 0x400000
  s_add_u32 s31, s31, 0x200000
  s_xor_b32 s33, s16, 0
  s_lshl_b32 s37, s26, 2
  s_add_u32 s33, s33, s37
  s_lshl_b32 s33, s33, 11
  s_add_u32 s33, s33, s29
  s_xor_b32 s34, s16, 1
  s_lshl_b32 s37, s26, 2
  s_add_u32 s34, s34, s37
  s_lshl_b32 s34, s34, 11
  s_add_u32 s34, s34, s29
  s_xor_b32 s35, s16, 2
  s_lshl_b32 s37, s26, 2
  s_add_u32 s35, s35, s37
  s_lshl_b32 s35, s35, 11
  s_add_u32 s35, s35, s29
  s_xor_b32 s36, s16, 3
  s_lshl_b32 s37, s26, 2
  s_add_u32 s36, s36, s37
  s_lshl_b32 s36, s36, 11
  s_add_u32 s36, s36, s29
  s_xor_b32 s60, s16, 1
  s_mul_i32 s60, s60, 12288
  s_add_u32 s60, s60, 114688
  v_add_u32 v9, s60, v4
  s_xor_b32 s60, s16, 2
  s_mul_i32 s60, s60, 12288
  s_add_u32 s60, s60, 118784
  v_add_u32 v10, s60, v4
  s_xor_b32 s60, s16, 3
  s_mul_i32 s60, s60, 12288
  s_add_u32 s60, s60, 122880
  v_add_u32 v11, s60, v4
  s_mul_i32 s60, s16, 12288
  s_add_u32 s60, s60, 114688
  v_add_u32 v12, s60, v4
  s_mul_i32 s30, s3, 10240
  s_add_u32 s30, s30, 0xd10000
  s_lshl_b32 s63, s25, 7
  s_add_u32 s30, s30, s63
  s_cmp_lg_u32 s16, 0
  s_cbranch_scc1 La_woth
  v_min_u32 v6, 15, v1
  v_lshlrev_b32 v6, 2, v6
  v_lshlrev_b32 v7, 3, v1
  s_mov_b32 s49, 0xd18200
  s_mov_b32 s62, 0
La_wpoll:
  buffer_load_dword v13, v6, s[8:11], s30 offen sc1
  s_add_u32 s62, s62, 1
  s_cmp_gt_u32 s62, 300000
  s_cbranch_scc1 La_woth
  s_waitcnt vmcnt(0)
  v_cmp_ne_u32 vcc, s66, v13
  s_cbranch_vccnz La_wpoll
La_woth:
  s_waitcnt vmcnt(0)
  s_barrier
  v_lshlrev_b32 v14, 2, v1
  v_and_b32 v15, 12, v14
  buffer_load_dwordx4 a[0:3], v4, s[8:11], s33 offen sc1
  buffer_load_dwordx4 a[4:7], v4, s[8:11], s33 offen offset:1024 sc1
  buffer_load_dwordx4 a[32:35], v4, s[8:11], s31 offen offset:0 sc1
  buffer_load_dwordx4 a[36:39], v4, s[8:11], s31 offen offset:1024 sc1
  buffer_load_dword v6, v14, s[8:11], s27 offen sc1
  buffer_load_dword v7, v15, s[8:11], s28 offen sc1
  buffer_load_dwordx4 a[8:11], v4, s[8:11], s34 offen sc1
  buffer_load_dwordx4 a[12:15], v4, s[8:11], s34 offen offset:1024 sc1
  buffer_load_dwordx4 a[40:43], v4, s[8:11], s32 offen offset:0 sc1
  buffer_load_dwordx4 a[44:47], v4, s[8:11], s32 offen offset:1024 sc1
  s_waitcnt vmcnt(4)
  s_nop 0
  v_max_f32_dpp v6, v6, v6 row_ror:8 row_mask:0xf bank_mask:0xf
  v_max_f32_dpp v7, v7, v7 row_ror:8 row_mask:0xf bank_mask:0xf
  s_nop 0
  v_max_f32_dpp v6, v6, v6 row_ror:4 row_mask:0xf bank_mask:0xf
  v_max_f32_dpp v7, v7, v7 row_ror:4 row_mask:0xf bank_mask:0xf
  s_nop 0
  v_max_f32_dpp v6, v6, v6 row_ror:2 row_mask:0xf bank_mask:0xf
  v_max_f32_dpp v7, v7, v7 row_ror:2 row_mask:0xf bank_mask:0xf
  s_nop 0
  v_max_f32_dpp v6, v6, v6 row_ror:1 row_mask:0xf bank_mask:0xf
  v_max_f32_dpp v7, v7, v7 row_ror:1 row_mask:0xf bank_mask:0xf
  s_nop 1
  v_readlane_b32 s42, v6, 0
  v_readlane_b32 s43, v6, 16
  v_readlane_b32 s44, v6, 32
  v_readlane_b32 s45, v6, 48
  v_readlane_b32 s48, v7, 0
  v_mfma_f32_32x32x16_bf16 v[16:31], a[32:35], a[0:3], 0
  v_mfma_f32_32x32x16_bf16 v[16:31], a[36:39], a[4:7], v[16:31]
  s_max_u32 s42, s42, s43
  s_max_u32 s44, s44, s45
  s_max_u32 s42, s42, s44
  v_mov_b32 v6, s42
  v_mul_f32 v6, s48, v6
  v_mov_b32 v7, 0x45800000
  v_cmp_le_f32 vcc, v6, v7
  s_nop 4
  s_cbranch_vccz La_slow
  s_nop 2
  s_waitcnt vmcnt(2)
  v_mfma_f32_32x32x16_bf16 v[32:47], a[32:35], a[8:11], 0
  buffer_load_dwordx4 a[16:19], v4, s[8:11], s35 offen sc1
  buffer_load_dwordx4 a[20:23], v4, s[8:11], s35 offen offset:1024 sc1
  v_exp_f32 v16, v16
  v_exp_f32 v17, v17
  v_exp_f32 v18, v18
  v_exp_f32 v19, v19
  v_exp_f32 v20, v20
  v_exp_f32 v21, v21
  v_exp_f32 v22, v22
  v_exp_f32 v23, v23
  v_cvt_pk_bf16_f32 v48, v16, v17
  v_cvt_pk_bf16_f32 v49, v18, v19
  v_mfma_f32_32x32x16_bf16 v[32:47], a[36:39], a[12:15], v[32:47]
  buffer_load_dwordx4 a[24:27], v4, s[8:11], s36 offen sc1
  buffer_load_dwordx4 a[28:31], v4, s[8:11], s36 offen offset:1024 sc1
  v_exp_f32 v24, v24
  v_exp_f32 v25, v25
  v_exp_f32 v26, v26
  v_exp_f32 v27, v27
  v_cvt_pk_bf16_f32 v50, v20, v21
  v_cvt_pk_bf16_f32 v51, v22, v23
  v_exp_f32 v28, v28
  v_exp_f32 v29, v29
  v_exp_f32 v30, v30
  v_exp_f32 v31, v31
  v_cvt_pk_bf16_f32 v52, v24, v25
  v_cvt_pk_bf16_f32 v53, v26, v27
  v_cvt_pk_bf16_f32 v54, v28, v29
  v_cvt_pk_bf16_f32 v55, v30, v31
  s_waitcnt vmcnt(2)
  s_waitcnt vmcnt(4)
  v_mfma_f32_32x32x16_bf16 v[16:31], a[32:35], a[16:19], 0
  buffer_load_dwordx4 a[48:51], v4, s[8:11], s31 offen offset:2048 sc1
  buffer_load_dwordx4 a[52:55], v4, s[8:11], s31 offen offset:3072 sc1
  buffer_load_dwordx4 a[56:59], v4, s[8:11], s32 offen offset:2048 sc1
  buffer_load_dwordx4 a[60:63], v4, s[8:11], s32 offen offset:3072 sc1
  s_add_u32 s31, s31, 4096
  s_add_u32 s32, s32, 4096
  v_exp_f32 v32, v32
  v_exp_f32 v33, v33
  v_exp_f32 v34, v34
  v_exp_f32 v35, v35
  v_mfma_f32_32x32x16_bf16 v[64:79], a[40:43], v[48:51], 0
  v_exp_f32 v36, v36
  v_exp_f32 v37, v37
  v_exp_f32 v38, v38
  v_exp_f32 v39, v39
  v_cvt_pk_bf16_f32 v56, v32, v33
  v_cvt_pk_bf16_f32 v57, v34, v35
  v_mfma_f32_32x32x16_bf16 v[16:31], a[36:39], a[20:23], v[16:31]
  buffer_load_dwordx4 a[64:67], v4, s[8:11], s31 offen offset:0 sc1
  buffer_load_dwordx4 a[68:71], v4, s[8:11], s31 offen offset:1024 sc1
  buffer_load_dwordx4 a[72:75], v4, s[8:11], s32 offen offset:0 sc1
  buffer_load_dwordx4 a[76:79], v4, s[8:11], s32 offen offset:1024 sc1
  v_exp_f32 v40, v40
  v_exp_f32 v41, v41
  v_exp_f32 v42, v42
  v_exp_f32 v43, v43
  v_cvt_pk_bf16_f32 v58, v36, v37
  v_cvt_pk_bf16_f32 v59, v38, v39
  v_mfma_f32_32x32x16_bf16 v[64:79], a[44:47], v[52:55], v[64:79]
  v_exp_f32 v44, v44
  v_exp_f32 v45, v45
  v_exp_f32 v46, v46
  v_exp_f32 v47, v47
  v_cvt_pk_bf16_f32 v60, v40, v41
  v_cvt_pk_bf16_f32 v61, v42, v43
  v_cvt_pk_bf16_f32 v62, v44, v45
  v_cvt_pk_bf16_f32 v63, v46, v47
  s_waitcnt vmcnt(8)
  v_mfma_f32_32x32x16_bf16 v[32:47], a[32:35], a[24:27], 0
  v_exp_f32 v16, v16
  v_exp_f32 v17, v17
  v_exp_f32 v18, v18
  v_exp_f32 v19, v19
  v_mfma_f32_32x32x16_bf16 v[80:95], a[40:43], v[56:59], 0
  v_exp_f32 v20, v20
  v_exp_f32 v21, v21
  v_exp_f32 v22, v22
  v_exp_f32 v23, v23
  v_cvt_pk_bf16_f32 v48, v16, v17
  v_cvt_pk_bf16_f32 v49, v18, v19
  v_mfma_f32_32x32x16_bf16 v[32:47], a[36:39], a[28:31], v[32:47]
  v_exp_f32 v24, v24
  v_exp_f32 v25, v25
  v_exp_f32 v26, v26
  v_exp_f32 v27, v27
  v_cvt_pk_bf16_f32 v50, v20, v21
  v_cvt_pk_bf16_f32 v51, v22, v23
  v_mfma_f32_32x32x16_bf16 v[80:95], a[44:47], v[60:63], v[80:95]
  buffer_load_dwordx4 a[80:83], v4, s[8:11], s31 offen offset:2048 sc1
  buffer_load_dwordx4 a[84:87], v4, s[8:11], s31 offen offset:3072 sc1
  buffer_load_dwordx4 a[88:91], v4, s[8:11], s32 offen offset:2048 sc1
  buffer_load_dwordx4 a[92:95], v4, s[8:11], s32 offen offset:3072 sc1
  s_add_u32 s31, s31, 4096
  s_add_u32 s32, s32, 4096
  v_exp_f32 v28, v28
  v_exp_f32 v29, v29
  v_exp_f32 v30, v30
  v_exp_f32 v31, v31
  v_cvt_pk_bf16_f32 v52, v24, v25
  v_cvt_pk_bf16_f32 v53, v26, v27
  v_cvt_pk_bf16_f32 v54, v28, v29
  v_cvt_pk_bf16_f32 v55, v30, v31
  s_waitcnt vmcnt(10)
  v_mfma_f32_32x32x16_bf16 v[16:31], a[48:51], a[0:3], 0
  v_exp_f32 v32, v32
  v_exp_f32 v33, v33
  v_exp_f32 v34, v34
  v_exp_f32 v35, v35
  v_mfma_f32_32x32x16_bf16 v[96:111], a[40:43], v[48:51], 0
  v_exp_f32 v36, v36
  v_exp_f32 v37, v37
  v_exp_f32 v38, v38
  v_exp_f32 v39, v39
  v_cvt_pk_bf16_f32 v56, v32, v33
  v_cvt_pk_bf16_f32 v57, v34, v35
  v_mfma_f32_32x32x16_bf16 v[16:31], a[52:55], a[4:7], v[16:31]
  v_exp_f32 v40, v40
  v_exp_f32 v41, v41
  v_exp_f32 v42, v42
  v_exp_f32 v43, v43
  v_cvt_pk_bf16_f32 v58, v36, v37
  v_cvt_pk_bf16_f32 v59, v38, v39
  v_mfma_f32_32x32x16_bf16 v[96:111], a[44:47], v[52:55], v[96:111]
  buffer_load_dwordx4 a[96:99], v4, s[8:11], s52 offen offset:0
  v_exp_f32 v44, v44
  v_exp_f32 v45, v45
  v_exp_f32 v46, v46
  v_exp_f32 v47, v47
  v_cvt_pk_bf16_f32 v60, v40, v41
  v_cvt_pk_bf16_f32 v61, v42, v43
  v_cvt_pk_bf16_f32 v62, v44, v45
  v_cvt_pk_bf16_f32 v63, v46, v47
  v_mfma_f32_32x32x16_bf16 v[32:47], a[48:51], a[8:11], 0
  v_exp_f32 v16, v16
  v_exp_f32 v17, v17
  v_exp_f32 v18, v18
  v_exp_f32 v19, v19
  v_mfma_f32_32x32x16_bf16 v[112:127], a[40:43], v[56:59], 0
  s_mov_b32 m0, s47
  s_add_u32 s47, s47, 4096
  buffer_load_dwordx4 v4, s[8:11], s46 offen offset:0 lds
  v_exp_f32 v20, v20
  v_exp_f32 v21, v21
  v_exp_f32 v22, v22
  v_exp_f32 v23, v23
  v_cvt_pk_bf16_f32 v48, v16, v17
  v_cvt_pk_bf16_f32 v49, v18, v19
  v_mfma_f32_32x32x16_bf16 v[32:47], a[52:55], a[12:15], v[32:47]
  v_exp_f32 v24, v24
  v_exp_f32 v25, v25
  v_exp_f32 v26, v26
  v_exp_f32 v27, v27
  v_cvt_pk_bf16_f32 v50, v20, v21
  v_cvt_pk_bf16_f32 v51, v22, v23
  v_mfma_f32_32x32x16_bf16 v[112:127], a[44:47], v[60:63], v[112:127]
  buffer_load_dwordx4 a[32:35], v4, s[8:11], s31 offen offset:0 sc1
  buffer_load_dwordx4 a[36:39], v4, s[8:11], s31 offen offset:1024 sc1
  buffer_load_dwordx4 a[40:43], v4, s[8:11], s32 offen offset:0 sc1
  buffer_load_dwordx4 a[44:47], v4, s[8:11], s32 offen offset:1024 sc1
  v_exp_f32 v28, v28
  v_exp_f32 v29, v29
  v_exp_f32 v30, v30
  v_exp_f32 v31, v31
  v_cvt_pk_bf16_f32 v52, v24, v25
  v_cvt_pk_bf16_f32 v53, v26, v27
  v_cvt_pk_bf16_f32 v54, v28, v29
  v_cvt_pk_bf16_f32 v55, v30, v31
  s_waitcnt vmcnt(14)
  v_mfma_f32_32x32x16_bf16 v[16:31], a[48:51], a[16:19], 0
  v_exp_f32 v32, v32
  v_exp_f32 v33, v33
  v_exp_f32 v34, v34
  v_exp_f32 v35, v35
  v_mfma_f32_32x32x16_bf16 v[64:79], a[56:59], v[48:51], v[64:79]
  buffer_load_dwordx4 a[100:103], v4, s[8:11], s53 offen offset:0
  buffer_load_dwordx4 v[192:195], v4, s[8:11], s40 offen offset:0
  v_exp_f32 v36, v36
  v_exp_f32 v37, v37
  v_exp_f32 v38, v38
  v_exp_f32 v39, v39
  v_cvt_pk_bf16_f32 v56, v32, v33
  v_cvt_pk_bf16_f32 v57, v34, v35
  v_mfma_f32_32x32x16_bf16 v[16:31], a[52:55], a[20:23], v[16:31]
  v_exp_f32 v40, v40
  v_exp_f32 v41, v41
  v_exp_f32 v42, v42
  v_exp_f32 v43, v43
  v_cvt_pk_bf16_f32 v58, v36, v37
  v_cvt_pk_bf16_f32 v59, v38, v39
  v_mfma_f32_32x32x16_bf16 v[64:79], a[60:63], v[52:55], v[64:79]
  buffer_load_dwordx4 a[104:107], v4, s[8:11], s52 offen offset:1024
  v_exp_f32 v44, v44
  v_exp_f32 v45, v45
  v_exp_f32 v46, v46
  v_exp_f32 v47, v47
  v_cvt_pk_bf16_f32 v60, v40, v41
  v_cvt_pk_bf16_f32 v61, v42, v43
  v_cvt_pk_bf16_f32 v62, v44, v45
  v_cvt_pk_bf16_f32 v63, v46, v47
  v_mfma_f32_32x32x16_bf16 v[32:47], a[48:51], a[24:27], 0
  v_exp_f32 v16, v16
  v_exp_f32 v17, v17
  v_exp_f32 v18, v18
  v_exp_f32 v19, v19
  v_mfma_f32_32x32x16_bf16 v[80:95], a[56:59], v[56:59], v[80:95]
  buffer_load_dwordx4 v4, s[8:11], s46 offen offset:1024 lds
  v_exp_f32 v20, v20
  v_exp_f32 v21, v21
  v_exp_f32 v22, v22
  v_exp_f32 v23, v23
  v_cvt_pk_bf16_f32 v48, v16, v17
  v_cvt_pk_bf16_f32 v49, v18, v19
  v_mfma_f32_32x32x16_bf16 v[32:47], a[52:55], a[28:31], v[32:47]
  v_exp_f32 v24, v24
  v_exp_f32 v25, v25
  v_exp_f32 v26, v26
  v_exp_f32 v27, v27
  v_cvt_pk_bf16_f32 v50, v20, v21
  v_cvt_pk_bf16_f32 v51, v22, v23
  v_mfma_f32_32x32x16_bf16 v[80:95], a[60:63], v[60:63], v[80:95]
  v_exp_f32 v28, v28
  v_exp_f32 v29, v29
  v_exp_f32 v30, v30
  v_exp_f32 v31, v31
  v_cvt_pk_bf16_f32 v52, v24, v25
  v_cvt_pk_bf16_f32 v53, v26, v27
  v_cvt_pk_bf16_f32 v54, v28, v29
  v_cvt_pk_bf16_f32 v55, v30, v31
  s_waitcnt vmcnt(16)
  v_mfma_f32_32x32x16_bf16 v[16:31], a[64:67], a[0:3], 0
  v_exp_f32 v32, v32
  v_exp_f32 v33, v33
  v_exp_f32 v34, v34
  v_exp_f32 v35, v35
  v_mfma_f32_32x32x16_bf16 v[96:111], a[56:59], v[48:51], v[96:111]
  buffer_load_dwordx4 a[108:111], v4, s[8:11], s53 offen offset:1024
  v_exp_f32 v36, v36
  v_exp_f32 v37, v37
  v_exp_f32 v38, v38
  v_exp_f32 v39, v39
  v_cvt_pk_bf16_f32 v56, v32, v33
  v_cvt_pk_bf16_f32 v57, v34, v35
  v_mfma_f32_32x32x16_bf16 v[16:31], a[68:71], a[4:7], v[16:31]
  v_exp_f32 v40, v40
  v_exp_f32 v41, v41
  v_exp_f32 v42, v42
  v_exp_f32 v43, v43
  v_cvt_pk_bf16_f32 v58, v36, v37
  v_cvt_pk_bf16_f32 v59, v38, v39
  v_mfma_f32_32x32x16_bf16 v[96:111], a[60:63], v[52:55], v[96:111]
  buffer_load_dwordx4 a[112:115], v4, s[8:11], s52 offen offset:2048
  v_exp_f32 v44, v44
  v_exp_f32 v45, v45
  v_exp_f32 v46, v46
  v_exp_f32 v47, v47
  v_cvt_pk_bf16_f32 v60, v40, v41
  v_cvt_pk_bf16_f32 v61, v42, v43
  v_cvt_pk_bf16_f32 v62, v44, v45
  v_cvt_pk_bf16_f32 v63, v46, v47
  v_mfma_f32_32x32x16_bf16 v[32:47], a[64:67], a[8:11], 0
  v_exp_f32 v16, v16
  v_exp_f32 v17, v17
  v_exp_f32 v18, v18
  v_exp_f32 v19, v19
  v_mfma_f32_32x32x16_bf16 v[112:127], a[56:59], v[56:59], v[112:127]
  buffer_load_dwordx4 v4, s[8:11], s46 offen offset:2048 lds
  v_exp_f32 v20, v20
  v_exp_f32 v21, v21
  v_exp_f32 v22, v22
  v_exp_f32 v23, v23
  v_cvt_pk_bf16_f32 v48, v16, v17
  v_cvt_pk_bf16_f32 v49, v18, v19
  v_mfma_f32_32x32x16_bf16 v[32:47], a[68:71], a[12:15], v[32:47]
  v_exp_f32 v24, v24
  v_exp_f32 v25, v25
  v_exp_f32 v26, v26
  v_exp_f32 v27, v27
  v_cvt_pk_bf16_f32 v50, v20, v21
  v_cvt_pk_bf16_f32 v51, v22, v23
  v_mfma_f32_32x32x16_bf16 v[112:127], a[60:63], v[60:63], v[112:127]
  buffer_load_dwordx4 a[48:51], v4, s[8:11], s31 offen offset:2048 sc1
  buffer_load_dwordx4 a[52:55], v4, s[8:11], s31 offen offset:3072 sc1
  buffer_load_dwordx4 a[56:59], v4, s[8:11], s32 offen offset:2048 sc1
  buffer_load_dwordx4 a[60:63], v4, s[8:11], s32 offen offset:3072 sc1
  s_add_u32 s31, s31, 4096
  s_add_u32 s32, s32, 4096
  v_exp_f32 v28, v28
  v_exp_f32 v29, v29
  v_exp_f32 v30, v30
  v_exp_f32 v31, v31
  v_cvt_pk_bf16_f32 v52, v24, v25
  v_cvt_pk_bf16_f32 v53, v26, v27
  v_cvt_pk_bf16_f32 v54, v28, v29
  v_cvt_pk_bf16_f32 v55, v30, v31
  s_waitcnt vmcnt(21)
  v_mfma_f32_32x32x16_bf16 v[16:31], a[64:67], a[16:19], 0
  v_exp_f32 v32, v32
  v_exp_f32 v33, v33
  v_exp_f32 v34, v34
  v_exp_f32 v35, v35
  v_mfma_f32_32x32x16_bf16 v[64:79], a[72:75], v[48:51], v[64:79]
  buffer_load_dwordx4 v[224:227], v4, s[8:11], s41 offen offset:0
  buffer_load_dwordx4 a[116:119], v4, s[8:11], s53 offen offset:2048
  v_exp_f32 v36, v36
  v_exp_f32 v37, v37
  v_exp_f32 v38, v38
  v_exp_f32 v39, v39
  v_cvt_pk_bf16_f32 v56, v32, v33
  v_cvt_pk_bf16_f32 v57, v34, v35
  v_mfma_f32_32x32x16_bf16 v[16:31], a[68:71], a[20:23], v[16:31]
  v_exp_f32 v40, v40
  v_exp_f32 v41, v41
  v_exp_f32 v42, v42
  v_exp_f32 v43, v43
  v_cvt_pk_bf16_f32 v58, v36, v37
  v_cvt_pk_bf16_f32 v59, v38, v39
  v_mfma_f32_32x32x16_bf16 v[64:79], a[76:79], v[52:55], v[64:79]
  buffer_load_dwordx4 a[120:123], v4, s[8:11], s52 offen offset:3072
  s_add_u32 s52, s52, 4096
  v_exp_f32 v44, v44
  v_exp_f32 v45, v45
  v_exp_f32 v46, v46
  v_exp_f32 v47, v47
  v_cvt_pk_bf16_f32 v60, v40, v41
  v_cvt_pk_bf16_f32 v61, v42, v43
  v_cvt_pk_bf16_f32 v62, v44, v45
  v_cvt_pk_bf16_f32 v63, v46, v47
  v_mfma_f32_32x32x16_bf16 v[32:47], a[64:67], a[24:27], 0
  v_exp_f32 v16, v16
  v_exp_f32 v17, v17
  v_exp_f32 v18, v18
  v_exp_f32 v19, v19
  v_mfma_f32_32x32x16_bf16 v[80:95], a[72:75], v[56:59], v[80:95]
  v_exp_f32 v20, v20
  v_exp_f32 v21, v21
  v_exp_f32 v22, v22
  v_exp_f32 v23, v23
  v_cvt_pk_bf16_f32 v48, v16, v17
  v_cvt_pk_bf16_f32 v49, v18, v19
  v_mfma_f32_32x32x16_bf16 v[32:47], a[68:71], a[28:31], v[32:47]
  v_exp_f32 v24, v24
  v_exp_f32 v25, v25
  v_exp_f32 v26, v26
  v_exp_f32 v27, v27
  v_cvt_pk_bf16_f32 v50, v20, v21
  v_cvt_pk_bf16_f32 v51, v22, v23
  v_mfma_f32_32x32x16_bf16 v[80:95], a[76:79], v[60:63], v[80:95]
  buffer_load_dwordx4 v4, s[8:11], s46 offen offset:3072 lds
  s_add_u32 s46, s46, 4096
  v_exp_f32 v28, v28
  v_exp_f32 v29, v29
  v_exp_f32 v30, v30
  v_exp_f32 v31, v31
  v_cvt_pk_bf16_f32 v52, v24, v25
  v_cvt_pk_bf16_f32 v53, v26, v27
  v_cvt_pk_bf16_f32 v54, v28, v29
  v_cvt_pk_bf16_f32 v55, v30, v31
  s_waitcnt vmcnt(23)
  v_mfma_f32_32x32x16_bf16 v[16:31], a[80:83], a[0:3], 0
  v_exp_f32 v32, v32
  v_exp_f32 v33, v33
  v_exp_f32 v34, v34
  v_exp_f32 v35, v35
  v_mfma_f32_32x32x16_bf16 v[96:111], a[72:75], v[48:51], v[96:111]
  buffer_load_dwordx4 a[124:127], v4, s[8:11], s53 offen offset:3072
  s_add_u32 s53, s53, 4096
  v_exp_f32 v36, v36
  v_exp_f32 v37, v37
  v_exp_f32 v38, v38
  v_exp_f32 v39, v39
  v_cvt_pk_bf16_f32 v56, v32, v33
  v_cvt_pk_bf16_f32 v57, v34, v35
  v_mfma_f32_32x32x16_bf16 v[16:31], a[84:87], a[4:7], v[16:31]
  v_exp_f32 v40, v40
  v_exp_f32 v41, v41
  v_exp_f32 v42, v42
  v_exp_f32 v43, v43
  v_cvt_pk_bf16_f32 v58, v36, v37
  v_cvt_pk_bf16_f32 v59, v38, v39
  v_mfma_f32_32x32x16_bf16 v[96:111], a[76:79], v[52:55], v[96:111]
  buffer_load_dwordx4 a[128:131], v4, s[8:11], s52 offen offset:0
  v_exp_f32 v44, v44
  v_exp_f32 v45, v45
  v_exp_f32 v46, v46
  v_exp_f32 v47, v47
  v_cvt_pk_bf16_f32 v60, v40, v41
  v_cvt_pk_bf16_f32 v61, v42, v43
  v_cvt_pk_bf16_f32 v62, v44, v45
  v_cvt_pk_bf16_f32 v63, v46, v47
  v_mfma_f32_32x32x16_bf16 v[32:47], a[80:83], a[8:11], 0
  v_exp_f32 v16, v16
  v_exp_f32 v17, v17
  v_exp_f32 v18, v18
  v_exp_f32 v19, v19
  v_mfma_f32_32x32x16_bf16 v[112:127], a[72:75], v[56:59], v[112:127]
  buffer_load_dwordx4 v[196:199], v4, s[8:11], s40 offen offset:1024
  v_exp_f32 v20, v20
  v_exp_f32 v21, v21
  v_exp_f32 v22, v22
  v_exp_f32 v23, v23
  v_cvt_pk_bf16_f32 v48, v16, v17
  v_cvt_pk_bf16_f32 v49, v18, v19
  v_mfma_f32_32x32x16_bf16 v[32:47], a[84:87], a[12:15], v[32:47]
  v_exp_f32 v24, v24
  v_exp_f32 v25, v25
  v_exp_f32 v26, v26
  v_exp_f32 v27, v27
  v_cvt_pk_bf16_f32 v50, v20, v21
  v_cvt_pk_bf16_f32 v51, v22, v23
  v_mfma_f32_32x32x16_bf16 v[112:127], a[76:79], v[60:63], v[112:127]
  buffer_load_dwordx4 a[64:67], v4, s[8:11], s31 offen offset:0 sc1
  buffer_load_dwordx4 a[68:71], v4, s[8:11], s31 offen offset:1024 sc1
  buffer_load_dwordx4 a[72:75], v4, s[8:11], s32 offen offset:0 sc1
  buffer_load_dwordx4 a[76:79], v4, s[8:11], s32 offen offset:1024 sc1
  v_exp_f32 v28, v28
  v_exp_f32 v29, v29
  v_exp_f32 v30, v30
  v_exp_f32 v31, v31
  v_cvt_pk_bf16_f32 v52, v24, v25
  v_cvt_pk_bf16_f32 v53, v26, v27
  v_cvt_pk_bf16_f32 v54, v28, v29
  v_cvt_pk_bf16_f32 v55, v30, v31
  s_waitcnt vmcnt(28)
  v_mfma_f32_32x32x16_bf16 v[16:31], a[80:83], a[16:19], 0
  v_exp_f32 v32, v32
  v_exp_f32 v33, v33
  v_exp_f32 v34, v34
  v_exp_f32 v35, v35
  v_mfma_f32_32x32x16_bf16 v[64:79], a[88:91], v[48:51], v[64:79]
  s_mov_b32 m0, s47
  s_add_u32 s47, s47, 4096
  buffer_load_dwordx4 v4, s[8:11], s46 offen offset:0 lds
  buffer_load_dwordx4 a[132:135], v4, s[8:11], s53 offen offset:0
  v_exp_f32 v36, v36
  v_exp_f32 v37, v37
  v_exp_f32 v38, v38
  v_exp_f32 v39, v39
  v_cvt_pk_bf16_f32 v56, v32, v33
  v_cvt_pk_bf16_f32 v57, v34, v35
  v_mfma_f32_32x32x16_bf16 v[16:31], a[84:87], a[20:23], v[16:31]
  v_exp_f32 v40, v40
  v_exp_f32 v41, v41
  v_exp_f32 v42, v42
  v_exp_f32 v43, v43
  v_cvt_pk_bf16_f32 v58, v36, v37
  v_cvt_pk_bf16_f32 v59, v38, v39
  v_mfma_f32_32x32x16_bf16 v[64:79], a[92:95], v[52:55], v[64:79]
  v_exp_f32 v44, v44
  v_exp_f32 v45, v45
  v_exp_f32 v46, v46
  v_exp_f32 v47, v47
  v_cvt_pk_bf16_f32 v60, v40, v41
  v_cvt_pk_bf16_f32 v61, v42, v43
  v_cvt_pk_bf16_f32 v62, v44, v45
  v_cvt_pk_bf16_f32 v63, v46, v47
  v_mfma_f32_32x32x16_bf16 v[32:47], a[80:83], a[24:27], 0
  v_exp_f32 v16, v16
  v_exp_f32 v17, v17
  v_exp_f32 v18, v18
  v_exp_f32 v19, v19
  v_mfma_f32_32x32x16_bf16 v[80:95], a[88:91], v[56:59], v[80:95]
  buffer_load_dwordx4 a[136:139], v4, s[8:11], s52 offen offset:1024
  v_exp_f32 v20, v20
  v_exp_f32 v21, v21
  v_exp_f32 v22, v22
  v_exp_f32 v23, v23
  v_cvt_pk_bf16_f32 v48, v16, v17
  v_cvt_pk_bf16_f32 v49, v18, v19
  v_mfma_f32_32x32x16_bf16 v[32:47], a[84:87], a[28:31], v[32:47]
  v_exp_f32 v24, v24
  v_exp_f32 v25, v25
  v_exp_f32 v26, v26
  v_exp_f32 v27, v27
  v_cvt_pk_bf16_f32 v50, v20, v21
  v_cvt_pk_bf16_f32 v51, v22, v23
  v_mfma_f32_32x32x16_bf16 v[80:95], a[92:95], v[60:63], v[80:95]
  buffer_load_dwordx4 v4, s[8:11], s46 offen offset:1024 lds
  v_exp_f32 v28, v28
  v_exp_f32 v29, v29
  v_exp_f32 v30, v30
  v_exp_f32 v31, v31
  v_cvt_pk_bf16_f32 v52, v24, v25
  v_cvt_pk_bf16_f32 v53, v26, v27
  v_cvt_pk_bf16_f32 v54, v28, v29
  v_cvt_pk_bf16_f32 v55, v30, v31
  s_waitcnt vmcnt(28)
  v_mfma_f32_32x32x16_bf16 v[16:31], a[32:35], a[0:3], 0
  v_exp_f32 v32, v32
  v_exp_f32 v33, v33
  v_exp_f32 v34, v34
  v_exp_f32 v35, v35
  v_mfma_f32_32x32x16_bf16 v[96:111], a[88:91], v[48:51], v[96:111]
  buffer_load_dwordx4 a[140:143], v4, s[8:11], s53 offen offset:1024
  v_exp_f32 v36, v36
  v_exp_f32 v37, v37
  v_exp_f32 v38, v38
  v_exp_f32 v39, v39
  v_cvt_pk_bf16_f32 v56, v32, v33
  v_cvt_pk_bf16_f32 v57, v34, v35
  v_mfma_f32_32x32x16_bf16 v[16:31], a[36:39], a[4:7], v[16:31]
  v_exp_f32 v40, v40
  v_exp_f32 v41, v41
  v_exp_f32 v42, v42
  v_exp_f32 v43, v43
  v_cvt_pk_bf16_f32 v58, v36, v37
  v_cvt_pk_bf16_f32 v59, v38, v39
  v_mfma_f32_32x32x16_bf16 v[96:111], a[92:95], v[52:55], v[96:111]
  buffer_load_dwordx4 v[228:231], v4, s[8:11], s41 offen offset:1024
  v_exp_f32 v44, v44
  v_exp_f32 v45, v45
  v_exp_f32 v46, v46
  v_exp_f32 v47, v47
  v_cvt_pk_bf16_f32 v60, v40, v41
  v_cvt_pk_bf16_f32 v61, v42, v43
  v_cvt_pk_bf16_f32 v62, v44, v45
  v_cvt_pk_bf16_f32 v63, v46, v47
  v_mfma_f32_32x32x16_bf16 v[32:47], a[32:35], a[8:11], 0
  v_exp_f32 v16, v16
  v_exp_f32 v17, v17
  v_exp_f32 v18, v18
  v_exp_f32 v19, v19
  v_mfma_f32_32x32x16_bf16 v[112:127], a[88:91], v[56:59], v[112:127]
  buffer_load_dwordx4 a[144:147], v4, s[8:11], s52 offen offset:2048
  v_exp_f32 v20, v20
  v_exp_f32 v21, v21
  v_exp_f32 v22, v22
  v_exp_f32 v23, v23
  v_cvt_pk_bf16_f32 v48, v16, v17
  v_cvt_pk_bf16_f32 v49, v18, v19
  v_mfma_f32_32x32x16_bf16 v[32:47], a[36:39], a[12:15], v[32:47]
  v_exp_f32 v24, v24
  v_exp_f32 v25, v25
  v_exp_f32 v26, v26
  v_exp_f32 v27, v27
  v_cvt_pk_bf16_f32 v50, v20, v21
  v_cvt_pk_bf16_f32 v51, v22, v23
  v_mfma_f32_32x32x16_bf16 v[112:127], a[92:95], v[60:63], v[112:127]
  buffer_load_dwordx4 a[80:83], v4, s[8:11], s31 offen offset:2048 sc1
  buffer_load_dwordx4 a[84:87], v4, s[8:11], s31 offen offset:3072 sc1
  buffer_load_dwordx4 a[88:91], v4, s[8:11], s32 offen offset:2048 sc1
  buffer_load_dwordx4 a[92:95], v4, s[8:11], s32 offen offset:3072 sc1
  s_add_u32 s31, s31, 4096
  s_add_u32 s32, s32, 4096
  v_exp_f32 v28, v28
  v_exp_f32 v29, v29
  v_exp_f32 v30, v30
  v_exp_f32 v31, v31
  v_cvt_pk_bf16_f32 v52, v24, v25
  v_cvt_pk_bf16_f32 v53, v26, v27
  v_cvt_pk_bf16_f32 v54, v28, v29
  v_cvt_pk_bf16_f32 v55, v30, v31
  s_waitcnt vmcnt(33)
  v_mfma_f32_32x32x16_bf16 v[16:31], a[32:35], a[16:19], 0
  v_exp_f32 v32, v32
  v_exp_f32 v33, v33
  v_exp_f32 v34, v34
  v_exp_f32 v35, v35
  v_mfma_f32_32x32x16_bf16 v[64:79], a[40:43], v[48:51], v[64:79]
  buffer_load_dwordx4 v4, s[8:11], s46 offen offset:2048 lds
  buffer_load_dwordx4 a[148:151], v4, s[8:11], s53 offen offset:2048
  v_exp_f32 v36, v36
  v_exp_f32 v37, v37
  v_exp_f32 v38, v38
  v_exp_f32 v39, v39
  v_cvt_pk_bf16_f32 v56, v32, v33
  v_cvt_pk_bf16_f32 v57, v34, v35
  v_mfma_f32_32x32x16_bf16 v[16:31], a[36:39], a[20:23], v[16:31]
  v_exp_f32 v40, v40
  v_exp_f32 v41, v41
  v_exp_f32 v42, v42
  v_exp_f32 v43, v43
  v_cvt_pk_bf16_f32 v58, v36, v37
  v_cvt_pk_bf16_f32 v59, v38, v39
  v_mfma_f32_32x32x16_bf16 v[64:79], a[44:47], v[52:55], v[64:79]
  v_exp_f32 v44, v44
  v_exp_f32 v45, v45
  v_exp_f32 v46, v46
  v_exp_f32 v47, v47
  v_cvt_pk_bf16_f32 v60, v40, v41
  v_cvt_pk_bf16_f32 v61, v42, v43
  v_cvt_pk_bf16_f32 v62, v44, v45
  v_cvt_pk_bf16_f32 v63, v46, v47
  v_mfma_f32_32x32x16_bf16 v[32:47], a[32:35], a[24:27], 0
  v_exp_f32 v16, v16
  v_exp_f32 v17, v17
  v_exp_f32 v18, v18
  v_exp_f32 v19, v19
  v_mfma_f32_32x32x16_bf16 v[80:95], a[40:43], v[56:59], v[80:95]
  buffer_load_dwordx4 a[152:155], v4, s[8:11], s52 offen offset:3072
  s_add_u32 s52, s52, 4096
  v_exp_f32 v20, v20
  v_exp_f32 v21, v21
  v_exp_f32 v22, v22
  v_exp_f32 v23, v23
  v_cvt_pk_bf16_f32 v48, v16, v17
  v_cvt_pk_bf16_f32 v49, v18, v19
  v_mfma_f32_32x32x16_bf16 v[32:47], a[36:39], a[28:31], v[32:47]
  v_exp_f32 v24, v24
  v_exp_f32 v25, v25
  v_exp_f32 v26, v26
  v_exp_f32 v27, v27
  v_cvt_pk_bf16_f32 v50, v20, v21
  v_cvt_pk_bf16_f32 v51, v22, v23
  v_mfma_f32_32x32x16_bf16 v[80:95], a[44:47], v[60:63], v[80:95]
  buffer_load_dwordx4 v4, s[8:11], s46 offen offset:3072 lds
  s_add_u32 s46, s46, 4096
  v_exp_f32 v28, v28
  v_exp_f32 v29, v29
  v_exp_f32 v30, v30
  v_exp_f32 v31, v31
  v_cvt_pk_bf16_f32 v52, v24, v25
  v_cvt_pk_bf16_f32 v53, v26, v27
  v_cvt_pk_bf16_f32 v54, v28, v29
  v_cvt_pk_bf16_f32 v55, v30, v31
  s_waitcnt vmcnt(28)
  v_mfma_f32_32x32x16_bf16 v[16:31], a[48:51], a[0:3], 0
  v_exp_f32 v32, v32
  v_exp_f32 v33, v33
  v_exp_f32 v34, v34
  v_exp_f32 v35, v35
  v_mfma_f32_32x32x16_bf16 v[96:111], a[40:43], v[48:51], v[96:111]
  buffer_load_dwordx4 a[156:159], v4, s[8:11], s53 offen offset:3072
  s_add_u32 s53, s53, 4096
  v_exp_f32 v36, v36
  v_exp_f32 v37, v37
  v_exp_f32 v38, v38
  v_exp_f32 v39, v39
  v_cvt_pk_bf16_f32 v56, v32, v33
  v_cvt_pk_bf16_f32 v57, v34, v35
  v_mfma_f32_32x32x16_bf16 v[16:31], a[52:55], a[4:7], v[16:31]
  v_exp_f32 v40, v40
  v_exp_f32 v41, v41
  v_exp_f32 v42, v42
  v_exp_f32 v43, v43
  v_cvt_pk_bf16_f32 v58, v36, v37
  v_cvt_pk_bf16_f32 v59, v38, v39
  v_mfma_f32_32x32x16_bf16 v[96:111], a[44:47], v[52:55], v[96:111]
  buffer_load_dwordx4 v[200:203], v4, s[8:11], s40 offen offset:2048
  v_exp_f32 v44, v44
  v_exp_f32 v45, v45
  v_exp_f32 v46, v46
  v_exp_f32 v47, v47
  v_cvt_pk_bf16_f32 v60, v40, v41
  v_cvt_pk_bf16_f32 v61, v42, v43
  v_cvt_pk_bf16_f32 v62, v44, v45
  v_cvt_pk_bf16_f32 v63, v46, v47
  v_mfma_f32_32x32x16_bf16 v[32:47], a[48:51], a[8:11], 0
  v_exp_f32 v16, v16
  v_exp_f32 v17, v17
  v_exp_f32 v18, v18
  v_exp_f32 v19, v19
  v_mfma_f32_32x32x16_bf16 v[112:127], a[40:43], v[56:59], v[112:127]
  buffer_load_dwordx4 a[160:163], v4, s[8:11], s52 offen offset:0
  v_exp_f32 v20, v20
  v_exp_f32 v21, v21
  v_exp_f32 v22, v22
  v_exp_f32 v23, v23
  v_cvt_pk_bf16_f32 v48, v16, v17
  v_cvt_pk_bf16_f32 v49, v18, v19
  v_mfma_f32_32x32x16_bf16 v[32:47], a[52:55], a[12:15], v[32:47]
  v_exp_f32 v24, v24
  v_exp_f32 v25, v25
  v_exp_f32 v26, v26
  v_exp_f32 v27, v27
  v_cvt_pk_bf16_f32 v50, v20, v21
  v_cvt_pk_bf16_f32 v51, v22, v23
  v_mfma_f32_32x32x16_bf16 v[112:127], a[44:47], v[60:63], v[112:127]
  buffer_load_dwordx4 a[32:35], v4, s[8:11], s31 offen offset:0 sc1
  buffer_load_dwordx4 a[36:39], v4, s[8:11], s31 offen offset:1024 sc1
  buffer_load_dwordx4 a[40:43], v4, s[8:11], s32 offen offset:0 sc1
  buffer_load_dwordx4 a[44:47], v4, s[8:11], s32 offen offset:1024 sc1
  v_exp_f32 v28, v28
  v_exp_f32 v29, v29
  v_exp_f32 v30, v30
  v_exp_f32 v31, v31
  v_cvt_pk_bf16_f32 v52, v24, v25
  v_cvt_pk_bf16_f32 v53, v26, v27
  v_cvt_pk_bf16_f32 v54, v28, v29
  v_cvt_pk_bf16_f32 v55, v30, v31
  s_waitcnt vmcnt(33)
  v_mfma_f32_32x32x16_bf16 v[16:31], a[48:51], a[16:19], 0
  v_exp_f32 v32, v32
  v_exp_f32 v33, v33
  v_exp_f32 v34, v34
  v_exp_f32 v35, v35
  v_mfma_f32_32x32x16_bf16 v[64:79], a[56:59], v[48:51], v[64:79]
  s_mov_b32 m0, s47
  s_add_u32 s47, s47, 4096
  buffer_load_dwordx4 v4, s[8:11], s46 offen offset:0 lds
  v_exp_f32 v36, v36
  v_exp_f32 v37, v37
  v_exp_f32 v38, v38
  v_exp_f32 v39, v39
  v_cvt_pk_bf16_f32 v56, v32, v33
  v_cvt_pk_bf16_f32 v57, v34, v35
  v_mfma_f32_32x32x16_bf16 v[16:31], a[52:55], a[20:23], v[16:31]
  v_exp_f32 v40, v40
  v_exp_f32 v41, v41
  v_exp_f32 v42, v42
  v_exp_f32 v43, v43
  v_cvt_pk_bf16_f32 v58, v36, v37
  v_cvt_pk_bf16_f32 v59, v38, v39
  v_mfma_f32_32x32x16_bf16 v[64:79], a[60:63], v[52:55], v[64:79]
  buffer_load_dwordx4 a[164:167], v4, s[8:11], s53 offen offset:0
  v_exp_f32 v44, v44
  v_exp_f32 v45, v45
  v_exp_f32 v46, v46
  v_exp_f32 v47, v47
  v_cvt_pk_bf16_f32 v60, v40, v41
  v_cvt_pk_bf16_f32 v61, v42, v43
  v_cvt_pk_bf16_f32 v62, v44, v45
  v_cvt_pk_bf16_f32 v63, v46, v47
  v_mfma_f32_32x32x16_bf16 v[32:47], a[48:51], a[24:27], 0
  v_exp_f32 v16, v16
  v_exp_f32 v17, v17
  v_exp_f32 v18, v18
  v_exp_f32 v19, v19
  v_mfma_f32_32x32x16_bf16 v[80:95], a[56:59], v[56:59], v[80:95]
  buffer_load_dwordx4 a[168:171], v4, s[8:11], s52 offen offset:1024
  v_exp_f32 v20, v20
  v_exp_f32 v21, v21
  v_exp_f32 v22, v22
  v_exp_f32 v23, v23
  v_cvt_pk_bf16_f32 v48, v16, v17
  v_cvt_pk_bf16_f32 v49, v18, v19
  v_mfma_f32_32x32x16_bf16 v[32:47], a[52:55], a[28:31], v[32:47]
  v_exp_f32 v24, v24
  v_exp_f32 v25, v25
  v_exp_f32 v26, v26
  v_exp_f32 v27, v27
  v_cvt_pk_bf16_f32 v50, v20, v21
  v_cvt_pk_bf16_f32 v51, v22, v23
  v_mfma_f32_32x32x16_bf16 v[80:95], a[60:63], v[60:63], v[80:95]
  buffer_load_dwordx4 v4, s[8:11], s46 offen offset:1024 lds
  v_exp_f32 v28, v28
  v_exp_f32 v29, v29
  v_exp_f32 v30, v30
  v_exp_f32 v31, v31
  v_cvt_pk_bf16_f32 v52, v24, v25
  v_cvt_pk_bf16_f32 v53, v26, v27
  v_cvt_pk_bf16_f32 v54, v28, v29
  v_cvt_pk_bf16_f32 v55, v30, v31
  s_waitcnt vmcnt(28)
  v_mfma_f32_32x32x16_bf16 v[16:31], a[64:67], a[0:3], 0
  v_exp_f32 v32, v32
  v_exp_f32 v33, v33
  v_exp_f32 v34, v34
  v_exp_f32 v35, v35
  v_mfma_f32_32x32x16_bf16 v[96:111], a[56:59], v[48:51], v[96:111]
  buffer_load_dwordx4 v[232:235], v4, s[8:11], s41 offen offset:2048
  v_exp_f32 v36, v36
  v_exp_f32 v37, v37
  v_exp_f32 v38, v38
  v_exp_f32 v39, v39
  v_cvt_pk_bf16_f32 v56, v32, v33
  v_cvt_pk_bf16_f32 v57, v34, v35
  v_mfma_f32_32x32x16_bf16 v[16:31], a[68:71], a[4:7], v[16:31]
  v_exp_f32 v40, v40
  v_exp_f32 v41, v41
  v_exp_f32 v42, v42
  v_exp_f32 v43, v43
  v_cvt_pk_bf16_f32 v58, v36, v37
  v_cvt_pk_bf16_f32 v59, v38, v39
  v_mfma_f32_32x32x16_bf16 v[96:111], a[60:63], v[52:55], v[96:111]
  buffer_load_dwordx4 a[172:175], v4, s[8:11], s53 offen offset:1024
  v_exp_f32 v44, v44
  v_exp_f32 v45, v45
  v_exp_f32 v46, v46
  v_exp_f32 v47, v47
  v_cvt_pk_bf16_f32 v60, v40, v41
  v_cvt_pk_bf16_f32 v61, v42, v43
  v_cvt_pk_bf16_f32 v62, v44, v45
  v_cvt_pk_bf16_f32 v63, v46, v47
  v_mfma_f32_32x32x16_bf16 v[32:47], a[64:67], a[8:11], 0
  v_exp_f32 v16, v16
  v_exp_f32 v17, v17
  v_exp_f32 v18, v18
  v_exp_f32 v19, v19
  v_mfma_f32_32x32x16_bf16 v[112:127], a[56:59], v[56:59], v[112:127]
  buffer_load_dwordx4 a[176:179], v4, s[8:11], s52 offen offset:2048
  v_exp_f32 v20, v20
  v_exp_f32 v21, v21
  v_exp_f32 v22, v22
  v_exp_f32 v23, v23
  v_cvt_pk_bf16_f32 v48, v16, v17
  v_cvt_pk_bf16_f32 v49, v18, v19
  v_mfma_f32_32x32x16_bf16 v[32:47], a[68:71], a[12:15], v[32:47]
  v_exp_f32 v24, v24
  v_exp_f32 v25, v25
  v_exp_f32 v26, v26
  v_exp_f32 v27, v27
  v_cvt_pk_bf16_f32 v50, v20, v21
  v_cvt_pk_bf16_f32 v51, v22, v23
  v_mfma_f32_32x32x16_bf16 v[112:127], a[60:63], v[60:63], v[112:127]
  buffer_load_dwordx4 a[48:51], v4, s[8:11], s31 offen offset:2048 sc1
  buffer_load_dwordx4 a[52:55], v4, s[8:11], s31 offen offset:3072 sc1
  buffer_load_dwordx4 a[56:59], v4, s[8:11], s32 offen offset:2048 sc1
  buffer_load_dwordx4 a[60:63], v4, s[8:11], s32 offen offset:3072 sc1
  s_add_u32 s31, s31, 4096
  s_add_u32 s32, s32, 4096
  v_exp_f32 v28, v28
  v_exp_f32 v29, v29
  v_exp_f32 v30, v30
  v_exp_f32 v31, v31
  v_cvt_pk_bf16_f32 v52, v24, v25
  v_cvt_pk_bf16_f32 v53, v26, v27
  v_cvt_pk_bf16_f32 v54, v28, v29
  v_cvt_pk_bf16_f32 v55, v30, v31
  s_waitcnt vmcnt(33)
  v_mfma_f32_32x32x16_bf16 v[16:31], a[64:67], a[16:19], 0
  v_exp_f32 v32, v32
  v_exp_f32 v33, v33
  v_exp_f32 v34, v34
  v_exp_f32 v35, v35
  v_mfma_f32_32x32x16_bf16 v[64:79], a[72:75], v[48:51], v[64:79]
  buffer_load_dwordx4 v4, s[8:11], s46 offen offset:2048 lds
  v_exp_f32 v36, v36
  v_exp_f32 v37, v37
  v_exp_f32 v38, v38
  v_exp_f32 v39, v39
  v_cvt_pk_bf16_f32 v56, v32, v33
  v_cvt_pk_bf16_f32 v57, v34, v35
  v_mfma_f32_32x32x16_bf16 v[16:31], a[68:71], a[20:23], v[16:31]
  v_exp_f32 v40, v40
  v_exp_f32 v41, v41
  v_exp_f32 v42, v42
  v_exp_f32 v43, v43
  v_cvt_pk_bf16_f32 v58, v36, v37
  v_cvt_pk_bf16_f32 v59, v38, v39
  v_mfma_f32_32x32x16_bf16 v[64:79], a[76:79], v[52:55], v[64:79]
  buffer_load_dwordx4 a[180:183], v4, s[8:11], s53 offen offset:2048
  v_exp_f32 v44, v44
  v_exp_f32 v45, v45
  v_exp_f32 v46, v46
  v_exp_f32 v47, v47
  v_cvt_pk_bf16_f32 v60, v40, v41
  v_cvt_pk_bf16_f32 v61, v42, v43
  v_cvt_pk_bf16_f32 v62, v44, v45
  v_cvt_pk_bf16_f32 v63, v46, v47
  v_mfma_f32_32x32x16_bf16 v[32:47], a[64:67], a[24:27], 0
  v_exp_f32 v16, v16
  v_exp_f32 v17, v17
  v_exp_f32 v18, v18
  v_exp_f32 v19, v19
  v_mfma_f32_32x32x16_bf16 v[80:95], a[72:75], v[56:59], v[80:95]
  buffer_load_dwordx4 a[184:187], v4, s[8:11], s52 offen offset:3072
  s_add_u32 s52, s52, 4096
  v_exp_f32 v20, v20
  v_exp_f32 v21, v21
  v_exp_f32 v22, v22
  v_exp_f32 v23, v23
  v_cvt_pk_bf16_f32 v48, v16, v17
  v_cvt_pk_bf16_f32 v49, v18, v19
  v_mfma_f32_32x32x16_bf16 v[32:47], a[68:71], a[28:31], v[32:47]
  v_exp_f32 v24, v24
  v_exp_f32 v25, v25
  v_exp_f32 v26, v26
  v_exp_f32 v27, v27
  v_cvt_pk_bf16_f32 v50, v20, v21
  v_cvt_pk_bf16_f32 v51, v22, v23
  v_mfma_f32_32x32x16_bf16 v[80:95], a[76:79], v[60:63], v[80:95]
  buffer_load_dwordx4 v[204:207], v4, s[8:11], s40 offen offset:3072
  s_add_u32 s40, s40, 4096
  v_exp_f32 v28, v28
  v_exp_f32 v29, v29
  v_exp_f32 v30, v30
  v_exp_f32 v31, v31
  v_cvt_pk_bf16_f32 v52, v24, v25
  v_cvt_pk_bf16_f32 v53, v26, v27
  v_cvt_pk_bf16_f32 v54, v28, v29
  v_cvt_pk_bf16_f32 v55, v30, v31
  s_waitcnt vmcnt(28)
  v_mfma_f32_32x32x16_bf16 v[16:31], a[80:83], a[0:3], 0
  v_exp_f32 v32, v32
  v_exp_f32 v33, v33
  v_exp_f32 v34, v34
  v_exp_f32 v35, v35
  v_mfma_f32_32x32x16_bf16 v[96:111], a[72:75], v[48:51], v[96:111]
  buffer_load_dwordx4 v4, s[8:11], s46 offen offset:3072 lds
  s_add_u32 s46, s46, 4096
  v_exp_f32 v36, v36
  v_exp_f32 v37, v37
  v_exp_f32 v38, v38
  v_exp_f32 v39, v39
  v_cvt_pk_bf16_f32 v56, v32, v33
  v_cvt_pk_bf16_f32 v57, v34, v35
  v_mfma_f32_32x32x16_bf16 v[16:31], a[84:87], a[4:7], v[16:31]
  v_exp_f32 v40, v40
  v_exp_f32 v41, v41
  v_exp_f32 v42, v42
  v_exp_f32 v43, v43
  v_cvt_pk_bf16_f32 v58, v36, v37
  v_cvt_pk_bf16_f32 v59, v38, v39
  v_mfma_f32_32x32x16_bf16 v[96:111], a[76:79], v[52:55], v[96:111]
  buffer_load_dwordx4 a[188:191], v4, s[8:11], s53 offen offset:3072
  s_add_u32 s53, s53, 4096
  v_exp_f32 v44, v44
  v_exp_f32 v45, v45
  v_exp_f32 v46, v46
  v_exp_f32 v47, v47
  v_cvt_pk_bf16_f32 v60, v40, v41
  v_cvt_pk_bf16_f32 v61, v42, v43
  v_cvt_pk_bf16_f32 v62, v44, v45
  v_cvt_pk_bf16_f32 v63, v46, v47
  v_mfma_f32_32x32x16_bf16 v[32:47], a[80:83], a[8:11], 0
  v_exp_f32 v16, v16
  v_exp_f32 v17, v17
  v_exp_f32 v18, v18
  v_exp_f32 v19, v19
  v_mfma_f32_32x32x16_bf16 v[112:127], a[72:75], v[56:59], v[112:127]
  v_exp_f32 v20, v20
  v_exp_f32 v21, v21
  v_exp_f32 v22, v22
  v_exp_f32 v23, v23
  v_cvt_pk_bf16_f32 v48, v16, v17
  v_cvt_pk_bf16_f32 v49, v18, v19
  v_mfma_f32_32x32x16_bf16 v[32:47], a[84:87], a[12:15], v[32:47]
  v_exp_f32 v24, v24
  v_exp_f32 v25, v25
  v_exp_f32 v26, v26
  v_exp_f32 v27, v27
  v_cvt_pk_bf16_f32 v50, v20, v21
  v_cvt_pk_bf16_f32 v51, v22, v23
  v_mfma_f32_32x32x16_bf16 v[112:127], a[76:79], v[60:63], v[112:127]
  buffer_load_dwordx4 a[64:67], v4, s[8:11], s31 offen offset:0 sc1
  buffer_load_dwordx4 a[68:71], v4, s[8:11], s31 offen offset:1024 sc1
  buffer_load_dwordx4 a[72:75], v4, s[8:11], s32 offen offset:0 sc1
  buffer_load_dwordx4 a[76:79], v4, s[8:11], s32 offen offset:1024 sc1
  v_exp_f32 v28, v28
  v_exp_f32 v29, v29
  v_exp_f32 v30, v30
  v_exp_f32 v31, v31
  v_cvt_pk_bf16_f32 v52, v24, v25
  v_cvt_pk_bf16_f32 v53, v26, v27
  v_cvt_pk_bf16_f32 v54, v28, v29
  v_cvt_pk_bf16_f32 v55, v30, v31
  s_waitcnt vmcnt(32)
  v_mfma_f32_32x32x16_bf16 v[16:31], a[80:83], a[16:19], 0
  v_exp_f32 v32, v32
  v_exp_f32 v33, v33
  v_exp_f32 v34, v34
  v_exp_f32 v35, v35
  v_mfma_f32_32x32x16_bf16 v[64:79], a[88:91], v[48:51], v[64:79]
  buffer_load_dwordx4 a[192:195], v4, s[8:11], s52 offen offset:0
  s_mov_b32 m0, s47
  s_add_u32 s47, s47, 4096
  buffer_load_dwordx4 v4, s[8:11], s46 offen offset:0 lds
  v_exp_f32 v36, v36
  v_exp_f32 v37, v37
  v_exp_f32 v38, v38
  v_exp_f32 v39, v39
  v_cvt_pk_bf16_f32 v56, v32, v33
  v_cvt_pk_bf16_f32 v57, v34, v35
  v_mfma_f32_32x32x16_bf16 v[16:31], a[84:87], a[20:23], v[16:31]
  v_exp_f32 v40, v40
  v_exp_f32 v41, v41
  v_exp_f32 v42, v42
  v_exp_f32 v43, v43
  v_cvt_pk_bf16_f32 v58, v36, v37
  v_cvt_pk_bf16_f32 v59, v38, v39
  v_mfma_f32_32x32x16_bf16 v[64:79], a[92:95], v[52:55], v[64:79]
  buffer_load_dwordx4 a[196:199], v4, s[8:11], s53 offen offset:0
  v_exp_f32 v44, v44
  v_exp_f32 v45, v45
  v_exp_f32 v46, v46
  v_exp_f32 v47, v47
  v_cvt_pk_bf16_f32 v60, v40, v41
  v_cvt_pk_bf16_f32 v61, v42, v43
  v_cvt_pk_bf16_f32 v62, v44, v45
  v_cvt_pk_bf16_f32 v63, v46, v47
  v_mfma_f32_32x32x16_bf16 v[32:47], a[80:83], a[24:27], 0
  v_exp_f32 v16, v16
  v_exp_f32 v17, v17
  v_exp_f32 v18, v18
  v_exp_f32 v19, v19
  v_mfma_f32_32x32x16_bf16 v[80:95], a[88:91], v[56:59], v[80:95]
  buffer_load_dwordx4 v[236:239], v4, s[8:11], s41 offen offset:3072
  s_add_u32 s41, s41, 4096
  v_exp_f32 v20, v20
  v_exp_f32 v21, v21
  v_exp_f32 v22, v22
  v_exp_f32 v23, v23
  v_cvt_pk_bf16_f32 v48, v16, v17
  v_cvt_pk_bf16_f32 v49, v18, v19
  v_mfma_f32_32x32x16_bf16 v[32:47], a[84:87], a[28:31], v[32:47]
  v_exp_f32 v24, v24
  v_exp_f32 v25, v25
  v_exp_f32 v26, v26
  v_exp_f32 v27, v27
  v_cvt_pk_bf16_f32 v50, v20, v21
  v_cvt_pk_bf16_f32 v51, v22, v23
  v_mfma_f32_32x32x16_bf16 v[80:95], a[92:95], v[60:63], v[80:95]
  buffer_load_dwordx4 a[200:203], v4, s[8:11], s52 offen offset:1024
  v_exp_f32 v28, v28
  v_exp_f32 v29, v29
  v_exp_f32 v30, v30
  v_exp_f32 v31, v31
  v_cvt_pk_bf16_f32 v52, v24, v25
  v_cvt_pk_bf16_f32 v53, v26, v27
  v_cvt_pk_bf16_f32 v54, v28, v29
  v_cvt_pk_bf16_f32 v55, v30, v31
  s_waitcnt vmcnt(28)
  v_mfma_f32_32x32x16_bf16 v[16:31], a[32:35], a[0:3], 0
  v_exp_f32 v32, v32
  v_exp_f32 v33, v33
  v_exp_f32 v34, v34
  v_exp_f32 v35, v35
  v_mfma_f32_32x32x16_bf16 v[96:111], a[88:91], v[48:51], v[96:111]
  buffer_load_dwordx4 v4, s[8:11], s46 offen offset:1024 lds
  v_exp_f32 v36, v36
  v_exp_f32 v37, v37
  v_exp_f32 v38, v38
  v_exp_f32 v39, v39
  v_cvt_pk_bf16_f32 v56, v32, v33
  v_cvt_pk_bf16_f32 v57, v34, v35
  v_mfma_f32_32x32x16_bf16 v[16:31], a[36:39], a[4:7], v[16:31]
  v_exp_f32 v40, v40
  v_exp_f32 v41, v41
  v_exp_f32 v42, v42
  v_exp_f32 v43, v43
  v_cvt_pk_bf16_f32 v58, v36, v37
  v_cvt_pk_bf16_f32 v59, v38, v39
  v_mfma_f32_32x32x16_bf16 v[96:111], a[92:95], v[52:55], v[96:111]
  buffer_load_dwordx4 a[204:207], v4, s[8:11], s53 offen offset:1024
  v_exp_f32 v44, v44
  v_exp_f32 v45, v45
  v_exp_f32 v46, v46
  v_exp_f32 v47, v47
  v_cvt_pk_bf16_f32 v60, v40, v41
  v_cvt_pk_bf16_f32 v61, v42, v43
  v_cvt_pk_bf16_f32 v62, v44, v45
  v_cvt_pk_bf16_f32 v63, v46, v47
  v_mfma_f32_32x32x16_bf16 v[32:47], a[32:35], a[8:11], 0
  v_exp_f32 v16, v16
  v_exp_f32 v17, v17
  v_exp_f32 v18, v18
  v_exp_f32 v19, v19
  v_mfma_f32_32x32x16_bf16 v[112:127], a[88:91], v[56:59], v[112:127]
  v_exp_f32 v20, v20
  v_exp_f32 v21, v21
  v_exp_f32 v22, v22
  v_exp_f32 v23, v23
  v_cvt_pk_bf16_f32 v48, v16, v17
  v_cvt_pk_bf16_f32 v49, v18, v19
  v_mfma_f32_32x32x16_bf16 v[32:47], a[36:39], a[12:15], v[32:47]
  v_exp_f32 v24, v24
  v_exp_f32 v25, v25
  v_exp_f32 v26, v26
  v_exp_f32 v27, v27
  v_cvt_pk_bf16_f32 v50, v20, v21
  v_cvt_pk_bf16_f32 v51, v22, v23
  v_mfma_f32_32x32x16_bf16 v[112:127], a[92:95], v[60:63], v[112:127]
  buffer_load_dwordx4 a[80:83], v4, s[8:11], s31 offen offset:2048 sc1
  buffer_load_dwordx4 a[84:87], v4, s[8:11], s31 offen offset:3072 sc1
  buffer_load_dwordx4 a[88:91], v4, s[8:11], s32 offen offset:2048 sc1
  buffer_load_dwordx4 a[92:95], v4, s[8:11], s32 offen offset:3072 sc1
  s_add_u32 s31, s31, 4096
  s_add_u32 s32, s32, 4096
  v_exp_f32 v28, v28
  v_exp_f32 v29, v29
  v_exp_f32 v30, v30
  v_exp_f32 v31, v31
  v_cvt_pk_bf16_f32 v52, v24, v25
  v_cvt_pk_bf16_f32 v53, v26, v27
  v_cvt_pk_bf16_f32 v54, v28, v29
  v_cvt_pk_bf16_f32 v55, v30, v31
  s_waitcnt vmcnt(32)
  v_mfma_f32_32x32x16_bf16 v[16:31], a[32:35], a[16:19], 0
  v_exp_f32 v32, v32
  v_exp_f32 v33, v33
  v_exp_f32 v34, v34
  v_exp_f32 v35, v35
  v_mfma_f32_32x32x16_bf16 v[64:79], a[40:43], v[48:51], v[64:79]
  buffer_load_dwordx4 a[208:211], v4, s[8:11], s52 offen offset:2048
  buffer_load_dwordx4 v4, s[8:11], s46 offen offset:2048 lds
  v_exp_f32 v36, v36
  v_exp_f32 v37, v37
  v_exp_f32 v38, v38
  v_exp_f32 v39, v39
  v_cvt_pk_bf16_f32 v56, v32, v33
  v_cvt_pk_bf16_f32 v57, v34, v35
  v_mfma_f32_32x32x16_bf16 v[16:31], a[36:39], a[20:23], v[16:31]
  v_exp_f32 v40, v40
  v_exp_f32 v41, v41
  v_exp_f32 v42, v42
  v_exp_f32 v43, v43
  v_cvt_pk_bf16_f32 v58, v36, v37
  v_cvt_pk_bf16_f32 v59, v38, v39
  v_mfma_f32_32x32x16_bf16 v[64:79], a[44:47], v[52:55], v[64:79]
  buffer_load_dwordx4 a[212:215], v4, s[8:11], s53 offen offset:2048
  v_exp_f32 v44, v44
  v_exp_f32 v45, v45
  v_exp_f32 v46, v46
  v_exp_f32 v47, v47
  v_cvt_pk_bf16_f32 v60, v40, v41
  v_cvt_pk_bf16_f32 v61, v42, v43
  v_cvt_pk_bf16_f32 v62, v44, v45
  v_cvt_pk_bf16_f32 v63, v46, v47
  v_mfma_f32_32x32x16_bf16 v[32:47], a[32:35], a[24:27], 0
  v_exp_f32 v16, v16
  v_exp_f32 v17, v17
  v_exp_f32 v18, v18
  v_exp_f32 v19, v19
  v_mfma_f32_32x32x16_bf16 v[80:95], a[40:43], v[56:59], v[80:95]
  buffer_load_dwordx4 v[208:211], v4, s[8:11], s40 offen offset:0
  v_exp_f32 v20, v20
  v_exp_f32 v21, v21
  v_exp_f32 v22, v22
  v_exp_f32 v23, v23
  v_cvt_pk_bf16_f32 v48, v16, v17
  v_cvt_pk_bf16_f32 v49, v18, v19
  v_mfma_f32_32x32x16_bf16 v[32:47], a[36:39], a[28:31], v[32:47]
  v_exp_f32 v24, v24
  v_exp_f32 v25, v25
  v_exp_f32 v26, v26
  v_exp_f32 v27, v27
  v_cvt_pk_bf16_f32 v50, v20, v21
  v_cvt_pk_bf16_f32 v51, v22, v23
  v_mfma_f32_32x32x16_bf16 v[80:95], a[44:47], v[60:63], v[80:95]
  buffer_load_dwordx4 a[216:219], v4, s[8:11], s52 offen offset:3072
  s_add_u32 s52, s52, 4096
  v_exp_f32 v28, v28
  v_exp_f32 v29, v29
  v_exp_f32 v30, v30
  v_exp_f32 v31, v31
  v_cvt_pk_bf16_f32 v52, v24, v25
  v_cvt_pk_bf16_f32 v53, v26, v27
  v_cvt_pk_bf16_f32 v54, v28, v29
  v_cvt_pk_bf16_f32 v55, v30, v31
  s_waitcnt vmcnt(28)
  v_mfma_f32_32x32x16_bf16 v[16:31], a[48:51], a[0:3], 0
  v_exp_f32 v32, v32
  v_exp_f32 v33, v33
  v_exp_f32 v34, v34
  v_exp_f32 v35, v35
  v_mfma_f32_32x32x16_bf16 v[96:111], a[40:43], v[48:51], v[96:111]
  buffer_load_dwordx4 v4, s[8:11], s46 offen offset:3072 lds
  s_add_u32 s46, s46, 4096
  v_exp_f32 v36, v36
  v_exp_f32 v37, v37
  v_exp_f32 v38, v38
  v_exp_f32 v39, v39
  v_cvt_pk_bf16_f32 v56, v32, v33
  v_cvt_pk_bf16_f32 v57, v34, v35
  v_mfma_f32_32x32x16_bf16 v[16:31], a[52:55], a[4:7], v[16:31]
  v_exp_f32 v40, v40
  v_exp_f32 v41, v41
  v_exp_f32 v42, v42
  v_exp_f32 v43, v43
  v_cvt_pk_bf16_f32 v58, v36, v37
  v_cvt_pk_bf16_f32 v59, v38, v39
  v_mfma_f32_32x32x16_bf16 v[96:111], a[44:47], v[52:55], v[96:111]
  v_exp_f32 v44, v44
  v_exp_f32 v45, v45
  v_exp_f32 v46, v46
  v_exp_f32 v47, v47
  v_cvt_pk_bf16_f32 v60, v40, v41
  v_cvt_pk_bf16_f32 v61, v42, v43
  v_cvt_pk_bf16_f32 v62, v44, v45
  v_cvt_pk_bf16_f32 v63, v46, v47
  v_mfma_f32_32x32x16_bf16 v[32:47], a[48:51], a[8:11], 0
  v_exp_f32 v16, v16
  v_exp_f32 v17, v17
  v_exp_f32 v18, v18
  v_exp_f32 v19, v19
  v_mfma_f32_32x32x16_bf16 v[112:127], a[40:43], v[56:59], v[112:127]
  buffer_load_dwordx4 a[220:223], v4, s[8:11], s53 offen offset:3072
  s_add_u32 s53, s53, 4096
  v_exp_f32 v20, v20
  v_exp_f32 v21, v21
  v_exp_f32 v22, v22
  v_exp_f32 v23, v23
  v_cvt_pk_bf16_f32 v48, v16, v17
  v_cvt_pk_bf16_f32 v49, v18, v19
  v_mfma_f32_32x32x16_bf16 v[32:47], a[52:55], a[12:15], v[32:47]
  v_exp_f32 v24, v24
  v_exp_f32 v25, v25
  v_exp_f32 v26, v26
  v_exp_f32 v27, v27
  v_cvt_pk_bf16_f32 v50, v20, v21
  v_cvt_pk_bf16_f32 v51, v22, v23
  v_mfma_f32_32x32x16_bf16 v[112:127], a[44:47], v[60:63], v[112:127]
  buffer_load_dwordx4 a[32:35], v4, s[8:11], s31 offen offset:0 sc1
  buffer_load_dwordx4 a[36:39], v4, s[8:11], s31 offen offset:1024 sc1
  buffer_load_dwordx4 a[40:43], v4, s[8:11], s32 offen offset:0 sc1
  buffer_load_dwordx4 a[44:47], v4, s[8:11], s32 offen offset:1024 sc1
  v_exp_f32 v28, v28
  v_exp_f32 v29, v29
  v_exp_f32 v30, v30
  v_exp_f32 v31, v31
  v_cvt_pk_bf16_f32 v52, v24, v25
  v_cvt_pk_bf16_f32 v53, v26, v27
  v_cvt_pk_bf16_f32 v54, v28, v29
  v_cvt_pk_bf16_f32 v55, v30, v31
  s_waitcnt vmcnt(32)
  v_mfma_f32_32x32x16_bf16 v[16:31], a[48:51], a[16:19], 0
  v_exp_f32 v32, v32
  v_exp_f32 v33, v33
  v_exp_f32 v34, v34
  v_exp_f32 v35, v35
  v_mfma_f32_32x32x16_bf16 v[64:79], a[56:59], v[48:51], v[64:79]
  buffer_load_dwordx4 a[224:227], v4, s[8:11], s52 offen offset:0
  s_mov_b32 m0, s47
  s_add_u32 s47, s47, 4096
  buffer_load_dwordx4 v4, s[8:11], s46 offen offset:0 lds
  v_exp_f32 v36, v36
  v_exp_f32 v37, v37
  v_exp_f32 v38, v38
  v_exp_f32 v39, v39
  v_cvt_pk_bf16_f32 v56, v32, v33
  v_cvt_pk_bf16_f32 v57, v34, v35
  v_mfma_f32_32x32x16_bf16 v[16:31], a[52:55], a[20:23], v[16:31]
  v_exp_f32 v40, v40
  v_exp_f32 v41, v41
  v_exp_f32 v42, v42
  v_exp_f32 v43, v43
  v_cvt_pk_bf16_f32 v58, v36, v37
  v_cvt_pk_bf16_f32 v59, v38, v39
  v_mfma_f32_32x32x16_bf16 v[64:79], a[60:63], v[52:55], v[64:79]
  buffer_load_dwordx4 v[240:243], v4, s[8:11], s41 offen offset:0
  v_exp_f32 v44, v44
  v_exp_f32 v45, v45
  v_exp_f32 v46, v46
  v_exp_f32 v47, v47
  v_cvt_pk_bf16_f32 v60, v40, v41
  v_cvt_pk_bf16_f32 v61, v42, v43
  v_cvt_pk_bf16_f32 v62, v44, v45
  v_cvt_pk_bf16_f32 v63, v46, v47
  v_mfma_f32_32x32x16_bf16 v[32:47], a[48:51], a[24:27], 0
  v_exp_f32 v16, v16
  v_exp_f32 v17, v17
  v_exp_f32 v18, v18
  v_exp_f32 v19, v19
  v_mfma_f32_32x32x16_bf16 v[80:95], a[56:59], v[56:59], v[80:95]
  buffer_load_dwordx4 a[228:231], v4, s[8:11], s53 offen offset:0
  v_exp_f32 v20, v20
  v_exp_f32 v21, v21
  v_exp_f32 v22, v22
  v_exp_f32 v23, v23
  v_cvt_pk_bf16_f32 v48, v16, v17
  v_cvt_pk_bf16_f32 v49, v18, v19
  v_mfma_f32_32x32x16_bf16 v[32:47], a[52:55], a[28:31], v[32:47]
  v_exp_f32 v24, v24
  v_exp_f32 v25, v25
  v_exp_f32 v26, v26
  v_exp_f32 v27, v27
  v_cvt_pk_bf16_f32 v50, v20, v21
  v_cvt_pk_bf16_f32 v51, v22, v23
  v_mfma_f32_32x32x16_bf16 v[80:95], a[60:63], v[60:63], v[80:95]
  buffer_load_dwordx4 a[232:235], v4, s[8:11], s52 offen offset:1024
  v_exp_f32 v28, v28
  v_exp_f32 v29, v29
  v_exp_f32 v30, v30
  v_exp_f32 v31, v31
  v_cvt_pk_bf16_f32 v52, v24, v25
  v_cvt_pk_bf16_f32 v53, v26, v27
  v_cvt_pk_bf16_f32 v54, v28, v29
  v_cvt_pk_bf16_f32 v55, v30, v31
  s_waitcnt vmcnt(29)
  v_mfma_f32_32x32x16_bf16 v[16:31], a[64:67], a[0:3], 0
  v_exp_f32 v32, v32
  v_exp_f32 v33, v33
  v_exp_f32 v34, v34
  v_exp_f32 v35, v35
  v_mfma_f32_32x32x16_bf16 v[96:111], a[56:59], v[48:51], v[96:111]
  v_exp_f32 v36, v36
  v_exp_f32 v37, v37
  v_exp_f32 v38, v38
  v_exp_f32 v39, v39
  v_cvt_pk_bf16_f32 v56, v32, v33
  v_cvt_pk_bf16_f32 v57, v34, v35
  v_mfma_f32_32x32x16_bf16 v[16:31], a[68:71], a[4:7], v[16:31]
  v_exp_f32 v40, v40
  v_exp_f32 v41, v41
  v_exp_f32 v42, v42
  v_exp_f32 v43, v43
  v_cvt_pk_bf16_f32 v58, v36, v37
  v_cvt_pk_bf16_f32 v59, v38, v39
  v_mfma_f32_32x32x16_bf16 v[96:111], a[60:63], v[52:55], v[96:111]
  buffer_load_dwordx4 v4, s[8:11], s46 offen offset:1024 lds
  v_exp_f32 v44, v44
  v_exp_f32 v45, v45
  v_exp_f32 v46, v46
  v_exp_f32 v47, v47
  v_cvt_pk_bf16_f32 v60, v40, v41
  v_cvt_pk_bf16_f32 v61, v42, v43
  v_cvt_pk_bf16_f32 v62, v44, v45
  v_cvt_pk_bf16_f32 v63, v46, v47
  v_mfma_f32_32x32x16_bf16 v[32:47], a[64:67], a[8:11], 0
  v_exp_f32 v16, v16
  v_exp_f32 v17, v17
  v_exp_f32 v18, v18
  v_exp_f32 v19, v19
  v_mfma_f32_32x32x16_bf16 v[112:127], a[56:59], v[56:59], v[112:127]
  buffer_load_dwordx4 a[236:239], v4, s[8:11], s53 offen offset:1024
  v_exp_f32 v20, v20
  v_exp_f32 v21, v21
  v_exp_f32 v22, v22
  v_exp_f32 v23, v23
  v_cvt_pk_bf16_f32 v48, v16, v17
  v_cvt_pk_bf16_f32 v49, v18, v19
  v_mfma_f32_32x32x16_bf16 v[32:47], a[68:71], a[12:15], v[32:47]
  v_exp_f32 v24, v24
  v_exp_f32 v25, v25
  v_exp_f32 v26, v26
  v_exp_f32 v27, v27
  v_cvt_pk_bf16_f32 v50, v20, v21
  v_cvt_pk_bf16_f32 v51, v22, v23
  v_mfma_f32_32x32x16_bf16 v[112:127], a[60:63], v[60:63], v[112:127]
  buffer_load_dwordx4 a[48:51], v4, s[8:11], s31 offen offset:2048 sc1
  buffer_load_dwordx4 a[52:55], v4, s[8:11], s31 offen offset:3072 sc1
  buffer_load_dwordx4 a[56:59], v4, s[8:11], s32 offen offset:2048 sc1
  buffer_load_dwordx4 a[60:63], v4, s[8:11], s32 offen offset:3072 sc1
  s_add_u32 s31, s31, 4096
  s_add_u32 s32, s32, 4096
  v_exp_f32 v28, v28
  v_exp_f32 v29, v29
  v_exp_f32 v30, v30
  v_exp_f32 v31, v31
  v_cvt_pk_bf16_f32 v52, v24, v25
  v_cvt_pk_bf16_f32 v53, v26, v27
  v_cvt_pk_bf16_f32 v54, v28, v29
  v_cvt_pk_bf16_f32 v55, v30, v31
  s_waitcnt vmcnt(33)
  v_mfma_f32_32x32x16_bf16 v[16:31], a[64:67], a[16:19], 0
  v_exp_f32 v32, v32
  v_exp_f32 v33, v33
  v_exp_f32 v34, v34
  v_exp_f32 v35, v35
  v_mfma_f32_32x32x16_bf16 v[64:79], a[72:75], v[48:51], v[64:79]
  buffer_load_dwordx4 a[240:243], v4, s[8:11], s52 offen offset:2048
  buffer_load_dwordx4 v[212:215], v4, s[8:11], s40 offen offset:1024
  v_exp_f32 v36, v36
  v_exp_f32 v37, v37
  v_exp_f32 v38, v38
  v_exp_f32 v39, v39
  v_cvt_pk_bf16_f32 v56, v32, v33
  v_cvt_pk_bf16_f32 v57, v34, v35
  v_mfma_f32_32x32x16_bf16 v[16:31], a[68:71], a[20:23], v[16:31]
  v_exp_f32 v40, v40
  v_exp_f32 v41, v41
  v_exp_f32 v42, v42
  v_exp_f32 v43, v43
  v_cvt_pk_bf16_f32 v58, v36, v37
  v_cvt_pk_bf16_f32 v59, v38, v39
  v_mfma_f32_32x32x16_bf16 v[64:79], a[76:79], v[52:55], v[64:79]
  buffer_load_dwordx4 v4, s[8:11], s46 offen offset:2048 lds
  v_exp_f32 v44, v44
  v_exp_f32 v45, v45
  v_exp_f32 v46, v46
  v_exp_f32 v47, v47
  v_cvt_pk_bf16_f32 v60, v40, v41
  v_cvt_pk_bf16_f32 v61, v42, v43
  v_cvt_pk_bf16_f32 v62, v44, v45
  v_cvt_pk_bf16_f32 v63, v46, v47
  v_mfma_f32_32x32x16_bf16 v[32:47], a[64:67], a[24:27], 0
  v_exp_f32 v16, v16
  v_exp_f32 v17, v17
  v_exp_f32 v18, v18
  v_exp_f32 v19, v19
  v_mfma_f32_32x32x16_bf16 v[80:95], a[72:75], v[56:59], v[80:95]
  buffer_load_dwordx4 a[244:247], v4, s[8:11], s53 offen offset:2048
  v_exp_f32 v20, v20
  v_exp_f32 v21, v21
  v_exp_f32 v22, v22
  v_exp_f32 v23, v23
  v_cvt_pk_bf16_f32 v48, v16, v17
  v_cvt_pk_bf16_f32 v49, v18, v19
  v_mfma_f32_32x32x16_bf16 v[32:47], a[68:71], a[28:31], v[32:47]
  v_exp_f32 v24, v24
  v_exp_f32 v25, v25
  v_exp_f32 v26, v26
  v_exp_f32 v27, v27
  v_cvt_pk_bf16_f32 v50, v20, v21
  v_cvt_pk_bf16_f32 v51, v22, v23
  v_mfma_f32_32x32x16_bf16 v[80:95], a[76:79], v[60:63], v[80:95]
  v_exp_f32 v28, v28
  v_exp_f32 v29, v29
  v_exp_f32 v30, v30
  v_exp_f32 v31, v31
  v_cvt_pk_bf16_f32 v52, v24, v25
  v_cvt_pk_bf16_f32 v53, v26, v27
  v_cvt_pk_bf16_f32 v54, v28, v29
  v_cvt_pk_bf16_f32 v55, v30, v31
  s_waitcnt vmcnt(28)
  v_mfma_f32_32x32x16_bf16 v[16:31], a[80:83], a[0:3], 0
  v_exp_f32 v32, v32
  v_exp_f32 v33, v33
  v_exp_f32 v34, v34
  v_exp_f32 v35, v35
  v_mfma_f32_32x32x16_bf16 v[96:111], a[72:75], v[48:51], v[96:111]
  buffer_load_dwordx4 a[248:251], v4, s[8:11], s52 offen offset:3072
  s_add_u32 s52, s52, 4096
  v_exp_f32 v36, v36
  v_exp_f32 v37, v37
  v_exp_f32 v38, v38
  v_exp_f32 v39, v39
  v_cvt_pk_bf16_f32 v56, v32, v33
  v_cvt_pk_bf16_f32 v57, v34, v35
  v_mfma_f32_32x32x16_bf16 v[16:31], a[84:87], a[4:7], v[16:31]
  v_exp_f32 v40, v40
  v_exp_f32 v41, v41
  v_exp_f32 v42, v42
  v_exp_f32 v43, v43
  v_cvt_pk_bf16_f32 v58, v36, v37
  v_cvt_pk_bf16_f32 v59, v38, v39
  v_mfma_f32_32x32x16_bf16 v[96:111], a[76:79], v[52:55], v[96:111]
  buffer_load_dwordx4 v4, s[8:11], s46 offen offset:3072 lds
  s_add_u32 s46, s46, 4096
  v_exp_f32 v44, v44
  v_exp_f32 v45, v45
  v_exp_f32 v46, v46
  v_exp_f32 v47, v47
  v_cvt_pk_bf16_f32 v60, v40, v41
  v_cvt_pk_bf16_f32 v61, v42, v43
  v_cvt_pk_bf16_f32 v62, v44, v45
  v_cvt_pk_bf16_f32 v63, v46, v47
  v_mfma_f32_32x32x16_bf16 v[32:47], a[80:83], a[8:11], 0
  v_exp_f32 v16, v16
  v_exp_f32 v17, v17
  v_exp_f32 v18, v18
  v_exp_f32 v19, v19
  v_mfma_f32_32x32x16_bf16 v[112:127], a[72:75], v[56:59], v[112:127]
  buffer_load_dwordx4 a[252:255], v4, s[8:11], s53 offen offset:3072
  s_add_u32 s53, s53, 4096
  v_exp_f32 v20, v20
  v_exp_f32 v21, v21
  v_exp_f32 v22, v22
  v_exp_f32 v23, v23
  v_cvt_pk_bf16_f32 v48, v16, v17
  v_cvt_pk_bf16_f32 v49, v18, v19
  v_mfma_f32_32x32x16_bf16 v[32:47], a[84:87], a[12:15], v[32:47]
  v_exp_f32 v24, v24
  v_exp_f32 v25, v25
  v_exp_f32 v26, v26
  v_exp_f32 v27, v27
  v_cvt_pk_bf16_f32 v50, v20, v21
  v_cvt_pk_bf16_f32 v51, v22, v23
  v_mfma_f32_32x32x16_bf16 v[112:127], a[76:79], v[60:63], v[112:127]
  buffer_load_dwordx4 a[64:67], v4, s[8:11], s31 offen offset:0 sc1
  buffer_load_dwordx4 a[68:71], v4, s[8:11], s31 offen offset:1024 sc1
  buffer_load_dwordx4 a[72:75], v4, s[8:11], s32 offen offset:0 sc1
  buffer_load_dwordx4 a[76:79], v4, s[8:11], s32 offen offset:1024 sc1
  v_exp_f32 v28, v28
  v_exp_f32 v29, v29
  v_exp_f32 v30, v30
  v_exp_f32 v31, v31
  v_cvt_pk_bf16_f32 v52, v24, v25
  v_cvt_pk_bf16_f32 v53, v26, v27
  v_cvt_pk_bf16_f32 v54, v28, v29
  v_cvt_pk_bf16_f32 v55, v30, v31
  s_waitcnt vmcnt(33)
  v_mfma_f32_32x32x16_bf16 v[16:31], a[80:83], a[16:19], 0
  v_exp_f32 v32, v32
  v_exp_f32 v33, v33
  v_exp_f32 v34, v34
  v_exp_f32 v35, v35
  v_mfma_f32_32x32x16_bf16 v[64:79], a[88:91], v[48:51], v[64:79]
  buffer_load_dwordx4 v[244:247], v4, s[8:11], s41 offen offset:1024
  buffer_load_dwordx4 v[128:131], v4, s[8:11], s52 offen offset:0
  v_exp_f32 v36, v36
  v_exp_f32 v37, v37
  v_exp_f32 v38, v38
  v_exp_f32 v39, v39
  v_cvt_pk_bf16_f32 v56, v32, v33
  v_cvt_pk_bf16_f32 v57, v34, v35
  v_mfma_f32_32x32x16_bf16 v[16:31], a[84:87], a[20:23], v[16:31]
  v_exp_f32 v40, v40
  v_exp_f32 v41, v41
  v_exp_f32 v42, v42
  v_exp_f32 v43, v43
  v_cvt_pk_bf16_f32 v58, v36, v37
  v_cvt_pk_bf16_f32 v59, v38, v39
  v_mfma_f32_32x32x16_bf16 v[64:79], a[92:95], v[52:55], v[64:79]
  s_mov_b32 m0, s47
  s_add_u32 s47, s47, 4096
  buffer_load_dwordx4 v4, s[8:11], s46 offen offset:0 lds
  v_exp_f32 v44, v44
  v_exp_f32 v45, v45
  v_exp_f32 v46, v46
  v_exp_f32 v47, v47
  v_cvt_pk_bf16_f32 v60, v40, v41
  v_cvt_pk_bf16_f32 v61, v42, v43
  v_cvt_pk_bf16_f32 v62, v44, v45
  v_cvt_pk_bf16_f32 v63, v46, v47
  v_mfma_f32_32x32x16_bf16 v[32:47], a[80:83], a[24:27], 0
  v_exp_f32 v16, v16
  v_exp_f32 v17, v17
  v_exp_f32 v18, v18
  v_exp_f32 v19, v19
  v_mfma_f32_32x32x16_bf16 v[80:95], a[88:91], v[56:59], v[80:95]
  buffer_load_dwordx4 v[132:135], v4, s[8:11], s53 offen offset:0
  v_exp_f32 v20, v20
  v_exp_f32 v21, v21
  v_exp_f32 v22, v22
  v_exp_f32 v23, v23
  v_cvt_pk_bf16_f32 v48, v16, v17
  v_cvt_pk_bf16_f32 v49, v18, v19
  v_mfma_f32_32x32x16_bf16 v[32:47], a[84:87], a[28:31], v[32:47]
  v_exp_f32 v24, v24
  v_exp_f32 v25, v25
  v_exp_f32 v26, v26
  v_exp_f32 v27, v27
  v_cvt_pk_bf16_f32 v50, v20, v21
  v_cvt_pk_bf16_f32 v51, v22, v23
  v_mfma_f32_32x32x16_bf16 v[80:95], a[92:95], v[60:63], v[80:95]
  v_exp_f32 v28, v28
  v_exp_f32 v29, v29
  v_exp_f32 v30, v30
  v_exp_f32 v31, v31
  v_cvt_pk_bf16_f32 v52, v24, v25
  v_cvt_pk_bf16_f32 v53, v26, v27
  v_cvt_pk_bf16_f32 v54, v28, v29
  v_cvt_pk_bf16_f32 v55, v30, v31
  s_waitcnt vmcnt(28)
  v_mfma_f32_32x32x16_bf16 v[16:31], a[32:35], a[0:3], 0
  v_exp_f32 v32, v32
  v_exp_f32 v33, v33
  v_exp_f32 v34, v34
  v_exp_f32 v35, v35
  v_mfma_f32_32x32x16_bf16 v[96:111], a[88:91], v[48:51], v[96:111]
  buffer_load_dwordx4 v[136:139], v4, s[8:11], s52 offen offset:1024
  v_exp_f32 v36, v36
  v_exp_f32 v37, v37
  v_exp_f32 v38, v38
  v_exp_f32 v39, v39
  v_cvt_pk_bf16_f32 v56, v32, v33
  v_cvt_pk_bf16_f32 v57, v34, v35
  v_mfma_f32_32x32x16_bf16 v[16:31], a[36:39], a[4:7], v[16:31]
  v_exp_f32 v40, v40
  v_exp_f32 v41, v41
  v_exp_f32 v42, v42
  v_exp_f32 v43, v43
  v_cvt_pk_bf16_f32 v58, v36, v37
  v_cvt_pk_bf16_f32 v59, v38, v39
  v_mfma_f32_32x32x16_bf16 v[96:111], a[92:95], v[52:55], v[96:111]
  buffer_load_dwordx4 v4, s[8:11], s46 offen offset:1024 lds
  v_exp_f32 v44, v44
  v_exp_f32 v45, v45
  v_exp_f32 v46, v46
  v_exp_f32 v47, v47
  v_cvt_pk_bf16_f32 v60, v40, v41
  v_cvt_pk_bf16_f32 v61, v42, v43
  v_cvt_pk_bf16_f32 v62, v44, v45
  v_cvt_pk_bf16_f32 v63, v46, v47
  v_mfma_f32_32x32x16_bf16 v[32:47], a[32:35], a[8:11], 0
  v_exp_f32 v16, v16
  v_exp_f32 v17, v17
  v_exp_f32 v18, v18
  v_exp_f32 v19, v19
  v_mfma_f32_32x32x16_bf16 v[112:127], a[88:91], v[56:59], v[112:127]
  buffer_load_dwordx4 v[140:143], v4, s[8:11], s53 offen offset:1024
  v_exp_f32 v20, v20
  v_exp_f32 v21, v21
  v_exp_f32 v22, v22
  v_exp_f32 v23, v23
  v_cvt_pk_bf16_f32 v48, v16, v17
  v_cvt_pk_bf16_f32 v49, v18, v19
  v_mfma_f32_32x32x16_bf16 v[32:47], a[36:39], a[12:15], v[32:47]
  v_exp_f32 v24, v24
  v_exp_f32 v25, v25
  v_exp_f32 v26, v26
  v_exp_f32 v27, v27
  v_cvt_pk_bf16_f32 v50, v20, v21
  v_cvt_pk_bf16_f32 v51, v22, v23
  v_mfma_f32_32x32x16_bf16 v[112:127], a[92:95], v[60:63], v[112:127]
  buffer_load_dwordx4 a[80:83], v4, s[8:11], s31 offen offset:2048 sc1
  buffer_load_dwordx4 a[84:87], v4, s[8:11], s31 offen offset:3072 sc1
  buffer_load_dwordx4 a[88:91], v4, s[8:11], s32 offen offset:2048 sc1
  buffer_load_dwordx4 a[92:95], v4, s[8:11], s32 offen offset:3072 sc1
  s_add_u32 s31, s31, 4096
  s_add_u32 s32, s32, 4096
  v_exp_f32 v28, v28
  v_exp_f32 v29, v29
  v_exp_f32 v30, v30
  v_exp_f32 v31, v31
  v_cvt_pk_bf16_f32 v52, v24, v25
  v_cvt_pk_bf16_f32 v53, v26, v27
  v_cvt_pk_bf16_f32 v54, v28, v29
  v_cvt_pk_bf16_f32 v55, v30, v31
  s_waitcnt vmcnt(33)
  v_mfma_f32_32x32x16_bf16 v[16:31], a[32:35], a[16:19], 0
  v_exp_f32 v32, v32
  v_exp_f32 v33, v33
  v_exp_f32 v34, v34
  v_exp_f32 v35, v35
  v_mfma_f32_32x32x16_bf16 v[64:79], a[40:43], v[48:51], v[64:79]
  buffer_load_dwordx4 v[216:219], v4, s[8:11], s40 offen offset:2048
  buffer_load_dwordx4 v[144:147], v4, s[8:11], s52 offen offset:2048
  v_exp_f32 v36, v36
  v_exp_f32 v37, v37
  v_exp_f32 v38, v38
  v_exp_f32 v39, v39
  v_cvt_pk_bf16_f32 v56, v32, v33
  v_cvt_pk_bf16_f32 v57, v34, v35
  v_mfma_f32_32x32x16_bf16 v[16:31], a[36:39], a[20:23], v[16:31]
  v_exp_f32 v40, v40
  v_exp_f32 v41, v41
  v_exp_f32 v42, v42
  v_exp_f32 v43, v43
  v_cvt_pk_bf16_f32 v58, v36, v37
  v_cvt_pk_bf16_f32 v59, v38, v39
  v_mfma_f32_32x32x16_bf16 v[64:79], a[44:47], v[52:55], v[64:79]
  buffer_load_dwordx4 v4, s[8:11], s46 offen offset:2048 lds
  v_exp_f32 v44, v44
  v_exp_f32 v45, v45
  v_exp_f32 v46, v46
  v_exp_f32 v47, v47
  v_cvt_pk_bf16_f32 v60, v40, v41
  v_cvt_pk_bf16_f32 v61, v42, v43
  v_cvt_pk_bf16_f32 v62, v44, v45
  v_cvt_pk_bf16_f32 v63, v46, v47
  v_mfma_f32_32x32x16_bf16 v[32:47], a[32:35], a[24:27], 0
  v_exp_f32 v16, v16
  v_exp_f32 v17, v17
  v_exp_f32 v18, v18
  v_exp_f32 v19, v19
  v_mfma_f32_32x32x16_bf16 v[80:95], a[40:43], v[56:59], v[80:95]
  v_exp_f32 v20, v20
  v_exp_f32 v21, v21
  v_exp_f32 v22, v22
  v_exp_f32 v23, v23
  v_cvt_pk_bf16_f32 v48, v16, v17
  v_cvt_pk_bf16_f32 v49, v18, v19
  v_mfma_f32_32x32x16_bf16 v[32:47], a[36:39], a[28:31], v[32:47]
  v_exp_f32 v24, v24
  v_exp_f32 v25, v25
  v_exp_f32 v26, v26
  v_exp_f32 v27, v27
  v_cvt_pk_bf16_f32 v50, v20, v21
  v_cvt_pk_bf16_f32 v51, v22, v23
  v_mfma_f32_32x32x16_bf16 v[80:95], a[44:47], v[60:63], v[80:95]
  buffer_load_dwordx4 v[148:151], v4, s[8:11], s53 offen offset:2048
  v_exp_f32 v28, v28
  v_exp_f32 v29, v29
  v_exp_f32 v30, v30
  v_exp_f32 v31, v31
  v_cvt_pk_bf16_f32 v52, v24, v25
  v_cvt_pk_bf16_f32 v53, v26, v27
  v_cvt_pk_bf16_f32 v54, v28, v29
  v_cvt_pk_bf16_f32 v55, v30, v31
  s_waitcnt vmcnt(28)
  v_mfma_f32_32x32x16_bf16 v[16:31], a[48:51], a[0:3], 0
  v_exp_f32 v32, v32
  v_exp_f32 v33, v33
  v_exp_f32 v34, v34
  v_exp_f32 v35, v35
  v_mfma_f32_32x32x16_bf16 v[96:111], a[40:43], v[48:51], v[96:111]
  buffer_load_dwordx4 v[152:155], v4, s[8:11], s52 offen offset:3072
  s_add_u32 s52, s52, 4096
  v_exp_f32 v36, v36
  v_exp_f32 v37, v37
  v_exp_f32 v38, v38
  v_exp_f32 v39, v39
  v_cvt_pk_bf16_f32 v56, v32, v33
  v_cvt_pk_bf16_f32 v57, v34, v35
  v_mfma_f32_32x32x16_bf16 v[16:31], a[52:55], a[4:7], v[16:31]
  v_exp_f32 v40, v40
  v_exp_f32 v41, v41
  v_exp_f32 v42, v42
  v_exp_f32 v43, v43
  v_cvt_pk_bf16_f32 v58, v36, v37
  v_cvt_pk_bf16_f32 v59, v38, v39
  v_mfma_f32_32x32x16_bf16 v[96:111], a[44:47], v[52:55], v[96:111]
  buffer_load_dwordx4 v4, s[8:11], s46 offen offset:3072 lds
  s_add_u32 s46, s46, 4096
  v_exp_f32 v44, v44
  v_exp_f32 v45, v45
  v_exp_f32 v46, v46
  v_exp_f32 v47, v47
  v_cvt_pk_bf16_f32 v60, v40, v41
  v_cvt_pk_bf16_f32 v61, v42, v43
  v_cvt_pk_bf16_f32 v62, v44, v45
  v_cvt_pk_bf16_f32 v63, v46, v47
  v_mfma_f32_32x32x16_bf16 v[32:47], a[48:51], a[8:11], 0
  v_exp_f32 v16, v16
  v_exp_f32 v17, v17
  v_exp_f32 v18, v18
  v_exp_f32 v19, v19
  v_mfma_f32_32x32x16_bf16 v[112:127], a[40:43], v[56:59], v[112:127]
  buffer_load_dwordx4 v[248:251], v4, s[8:11], s41 offen offset:2048
  v_exp_f32 v20, v20
  v_exp_f32 v21, v21
  v_exp_f32 v22, v22
  v_exp_f32 v23, v23
  v_cvt_pk_bf16_f32 v48, v16, v17
  v_cvt_pk_bf16_f32 v49, v18, v19
  v_mfma_f32_32x32x16_bf16 v[32:47], a[52:55], a[12:15], v[32:47]
  v_exp_f32 v24, v24
  v_exp_f32 v25, v25
  v_exp_f32 v26, v26
  v_exp_f32 v27, v27
  v_cvt_pk_bf16_f32 v50, v20, v21
  v_cvt_pk_bf16_f32 v51, v22, v23
  v_mfma_f32_32x32x16_bf16 v[112:127], a[44:47], v[60:63], v[112:127]
  buffer_load_dwordx4 v[156:159], v4, s[8:11], s53 offen offset:3072
  s_add_u32 s53, s53, 4096
  v_exp_f32 v28, v28
  v_exp_f32 v29, v29
  v_exp_f32 v30, v30
  v_exp_f32 v31, v31
  v_cvt_pk_bf16_f32 v52, v24, v25
  v_cvt_pk_bf16_f32 v53, v26, v27
  v_cvt_pk_bf16_f32 v54, v28, v29
  v_cvt_pk_bf16_f32 v55, v30, v31
  s_waitcnt vmcnt(30)
  v_mfma_f32_32x32x16_bf16 v[16:31], a[48:51], a[16:19], 0
  v_exp_f32 v32, v32
  v_exp_f32 v33, v33
  v_exp_f32 v34, v34
  v_exp_f32 v35, v35
  v_mfma_f32_32x32x16_bf16 v[64:79], a[56:59], v[48:51], v[64:79]
  buffer_load_dwordx4 v[160:163], v4, s[8:11], s52 offen offset:0
  v_exp_f32 v36, v36
  v_exp_f32 v37, v37
  v_exp_f32 v38, v38
  v_exp_f32 v39, v39
  v_cvt_pk_bf16_f32 v56, v32, v33
  v_cvt_pk_bf16_f32 v57, v34, v35
  v_mfma_f32_32x32x16_bf16 v[16:31], a[52:55], a[20:23], v[16:31]
  v_exp_f32 v40, v40
  v_exp_f32 v41, v41
  v_exp_f32 v42, v42
  v_exp_f32 v43, v43
  v_cvt_pk_bf16_f32 v58, v36, v37
  v_cvt_pk_bf16_f32 v59, v38, v39
  v_mfma_f32_32x32x16_bf16 v[64:79], a[60:63], v[52:55], v[64:79]
  v_exp_f32 v44, v44
  v_exp_f32 v45, v45
  v_exp_f32 v46, v46
  v_exp_f32 v47, v47
  v_cvt_pk_bf16_f32 v60, v40, v41
  v_cvt_pk_bf16_f32 v61, v42, v43
  v_cvt_pk_bf16_f32 v62, v44, v45
  v_cvt_pk_bf16_f32 v63, v46, v47
  v_mfma_f32_32x32x16_bf16 v[32:47], a[48:51], a[24:27], 0
  v_exp_f32 v16, v16
  v_exp_f32 v17, v17
  v_exp_f32 v18, v18
  v_exp_f32 v19, v19
  v_mfma_f32_32x32x16_bf16 v[80:95], a[56:59], v[56:59], v[80:95]
  s_mov_b32 m0, s47
  s_add_u32 s47, s47, 4096
  buffer_load_dwordx4 v4, s[8:11], s46 offen offset:0 lds
  v_exp_f32 v20, v20
  v_exp_f32 v21, v21
  v_exp_f32 v22, v22
  v_exp_f32 v23, v23
  v_cvt_pk_bf16_f32 v48, v16, v17
  v_cvt_pk_bf16_f32 v49, v18, v19
  v_mfma_f32_32x32x16_bf16 v[32:47], a[52:55], a[28:31], v[32:47]
  v_exp_f32 v24, v24
  v_exp_f32 v25, v25
  v_exp_f32 v26, v26
  v_exp_f32 v27, v27
  v_cvt_pk_bf16_f32 v50, v20, v21
  v_cvt_pk_bf16_f32 v51, v22, v23
  v_mfma_f32_32x32x16_bf16 v[80:95], a[60:63], v[60:63], v[80:95]
  buffer_load_dwordx4 v[164:167], v4, s[8:11], s53 offen offset:0
  v_exp_f32 v28, v28
  v_exp_f32 v29, v29
  v_exp_f32 v30, v30
  v_exp_f32 v31, v31
  v_cvt_pk_bf16_f32 v52, v24, v25
  v_cvt_pk_bf16_f32 v53, v26, v27
  v_cvt_pk_bf16_f32 v54, v28, v29
  v_cvt_pk_bf16_f32 v55, v30, v31
  s_waitcnt vmcnt(24)
  v_mfma_f32_32x32x16_bf16 v[16:31], a[64:67], a[0:3], 0
  v_exp_f32 v32, v32
  v_exp_f32 v33, v33
  v_exp_f32 v34, v34
  v_exp_f32 v35, v35
  v_mfma_f32_32x32x16_bf16 v[96:111], a[56:59], v[48:51], v[96:111]
  buffer_load_dwordx4 v[168:171], v4, s[8:11], s52 offen offset:1024
  v_exp_f32 v36, v36
  v_exp_f32 v37, v37
  v_exp_f32 v38, v38
  v_exp_f32 v39, v39
  v_cvt_pk_bf16_f32 v56, v32, v33
  v_cvt_pk_bf16_f32 v57, v34, v35
  v_mfma_f32_32x32x16_bf16 v[16:31], a[68:71], a[4:7], v[16:31]
  v_exp_f32 v40, v40
  v_exp_f32 v41, v41
  v_exp_f32 v42, v42
  v_exp_f32 v43, v43
  v_cvt_pk_bf16_f32 v58, v36, v37
  v_cvt_pk_bf16_f32 v59, v38, v39
  v_mfma_f32_32x32x16_bf16 v[96:111], a[60:63], v[52:55], v[96:111]
  buffer_load_dwordx4 v[220:223], v4, s[8:11], s40 offen offset:3072
  s_add_u32 s40, s40, 4096
  v_exp_f32 v44, v44
  v_exp_f32 v45, v45
  v_exp_f32 v46, v46
  v_exp_f32 v47, v47
  v_cvt_pk_bf16_f32 v60, v40, v41
  v_cvt_pk_bf16_f32 v61, v42, v43
  v_cvt_pk_bf16_f32 v62, v44, v45
  v_cvt_pk_bf16_f32 v63, v46, v47
  v_mfma_f32_32x32x16_bf16 v[32:47], a[64:67], a[8:11], 0
  v_exp_f32 v16, v16
  v_exp_f32 v17, v17
  v_exp_f32 v18, v18
  v_exp_f32 v19, v19
  v_mfma_f32_32x32x16_bf16 v[112:127], a[56:59], v[56:59], v[112:127]
  buffer_load_dwordx4 v4, s[8:11], s46 offen offset:1024 lds
  v_exp_f32 v20, v20
  v_exp_f32 v21, v21
  v_exp_f32 v22, v22
  v_exp_f32 v23, v23
  v_cvt_pk_bf16_f32 v48, v16, v17
  v_cvt_pk_bf16_f32 v49, v18, v19
  v_mfma_f32_32x32x16_bf16 v[32:47], a[68:71], a[12:15], v[32:47]
  v_exp_f32 v24, v24
  v_exp_f32 v25, v25
  v_exp_f32 v26, v26
  v_exp_f32 v27, v27
  v_cvt_pk_bf16_f32 v50, v20, v21
  v_cvt_pk_bf16_f32 v51, v22, v23
  v_mfma_f32_32x32x16_bf16 v[112:127], a[60:63], v[60:63], v[112:127]
  buffer_load_dwordx4 v[172:175], v4, s[8:11], s53 offen offset:1024
  v_exp_f32 v28, v28
  v_exp_f32 v29, v29
  v_exp_f32 v30, v30
  v_exp_f32 v31, v31
  v_cvt_pk_bf16_f32 v52, v24, v25
  v_cvt_pk_bf16_f32 v53, v26, v27
  v_cvt_pk_bf16_f32 v54, v28, v29
  v_cvt_pk_bf16_f32 v55, v30, v31
  s_waitcnt vmcnt(26)
  v_mfma_f32_32x32x16_bf16 v[16:31], a[64:67], a[16:19], 0
  v_exp_f32 v32, v32
  v_exp_f32 v33, v33
  v_exp_f32 v34, v34
  v_exp_f32 v35, v35
  v_mfma_f32_32x32x16_bf16 v[64:79], a[72:75], v[48:51], v[64:79]
  v_exp_f32 v36, v36
  v_exp_f32 v37, v37
  v_exp_f32 v38, v38
  v_exp_f32 v39, v39
  v_cvt_pk_bf16_f32 v56, v32, v33
  v_cvt_pk_bf16_f32 v57, v34, v35
  v_mfma_f32_32x32x16_bf16 v[16:31], a[68:71], a[20:23], v[16:31]
  v_exp_f32 v40, v40
  v_exp_f32 v41, v41
  v_exp_f32 v42, v42
  v_exp_f32 v43, v43
  v_cvt_pk_bf16_f32 v58, v36, v37
  v_cvt_pk_bf16_f32 v59, v38, v39
  v_mfma_f32_32x32x16_bf16 v[64:79], a[76:79], v[52:55], v[64:79]
  buffer_load_dwordx4 v[176:179], v4, s[8:11], s52 offen offset:2048
  v_exp_f32 v44, v44
  v_exp_f32 v45, v45
  v_exp_f32 v46, v46
  v_exp_f32 v47, v47
  v_cvt_pk_bf16_f32 v60, v40, v41
  v_cvt_pk_bf16_f32 v61, v42, v43
  v_cvt_pk_bf16_f32 v62, v44, v45
  v_cvt_pk_bf16_f32 v63, v46, v47
  v_mfma_f32_32x32x16_bf16 v[32:47], a[64:67], a[24:27], 0
  v_exp_f32 v16, v16
  v_exp_f32 v17, v17
  v_exp_f32 v18, v18
  v_exp_f32 v19, v19
  v_mfma_f32_32x32x16_bf16 v[80:95], a[72:75], v[56:59], v[80:95]
  buffer_load_dwordx4 v4, s[8:11], s46 offen offset:2048 lds
  v_exp_f32 v20, v20
  v_exp_f32 v21, v21
  v_exp_f32 v22, v22
  v_exp_f32 v23, v23
  v_cvt_pk_bf16_f32 v48, v16, v17
  v_cvt_pk_bf16_f32 v49, v18, v19
  v_mfma_f32_32x32x16_bf16 v[32:47], a[68:71], a[28:31], v[32:47]
  v_exp_f32 v24, v24
  v_exp_f32 v25, v25
  v_exp_f32 v26, v26
  v_exp_f32 v27, v27
  v_cvt_pk_bf16_f32 v50, v20, v21
  v_cvt_pk_bf16_f32 v51, v22, v23
  v_mfma_f32_32x32x16_bf16 v[80:95], a[76:79], v[60:63], v[80:95]
  buffer_load_dwordx4 v[180:183], v4, s[8:11], s53 offen offset:2048
  v_exp_f32 v28, v28
  v_exp_f32 v29, v29
  v_exp_f32 v30, v30
  v_exp_f32 v31, v31
  v_cvt_pk_bf16_f32 v52, v24, v25
  v_cvt_pk_bf16_f32 v53, v26, v27
  v_cvt_pk_bf16_f32 v54, v28, v29
  v_cvt_pk_bf16_f32 v55, v30, v31
  s_waitcnt vmcnt(20)
  v_mfma_f32_32x32x16_bf16 v[16:31], a[80:83], a[8:11], 0
  v_exp_f32 v32, v32
  v_exp_f32 v33, v33
  v_exp_f32 v34, v34
  v_exp_f32 v35, v35
  v_mfma_f32_32x32x16_bf16 v[96:111], a[72:75], v[48:51], v[96:111]
  buffer_load_dwordx4 v[252:255], v4, s[8:11], s41 offen offset:3072
  s_add_u32 s41, s41, 4096
  v_exp_f32 v36, v36
  v_exp_f32 v37, v37
  v_exp_f32 v38, v38
  v_exp_f32 v39, v39
  v_cvt_pk_bf16_f32 v56, v32, v33
  v_cvt_pk_bf16_f32 v57, v34, v35
  v_mfma_f32_32x32x16_bf16 v[16:31], a[84:87], a[12:15], v[16:31]
  v_exp_f32 v40, v40
  v_exp_f32 v41, v41
  v_exp_f32 v42, v42
  v_exp_f32 v43, v43
  v_cvt_pk_bf16_f32 v58, v36, v37
  v_cvt_pk_bf16_f32 v59, v38, v39
  v_mfma_f32_32x32x16_bf16 v[96:111], a[76:79], v[52:55], v[96:111]
  buffer_load_dwordx4 v[184:187], v4, s[8:11], s52 offen offset:3072
  s_add_u32 s52, s52, 4096
  v_exp_f32 v44, v44
  v_exp_f32 v45, v45
  v_exp_f32 v46, v46
  v_exp_f32 v47, v47
  v_cvt_pk_bf16_f32 v60, v40, v41
  v_cvt_pk_bf16_f32 v61, v42, v43
  v_cvt_pk_bf16_f32 v62, v44, v45
  v_cvt_pk_bf16_f32 v63, v46, v47
  v_mfma_f32_32x32x16_bf16 v[32:47], a[80:83], a[16:19], 0
  v_exp_f32 v16, v16
  v_exp_f32 v17, v17
  v_exp_f32 v18, v18
  v_exp_f32 v19, v19
  v_mfma_f32_32x32x16_bf16 v[112:127], a[72:75], v[56:59], v[112:127]
  buffer_load_dwordx4 v4, s[8:11], s46 offen offset:3072 lds
  s_add_u32 s46, s46, 4096
  v_exp_f32 v20, v20
  v_exp_f32 v21, v21
  v_exp_f32 v22, v22
  v_exp_f32 v23, v23
  v_cvt_pk_bf16_f32 v48, v16, v17
  v_cvt_pk_bf16_f32 v49, v18, v19
  v_mfma_f32_32x32x16_bf16 v[32:47], a[84:87], a[20:23], v[32:47]
  v_exp_f32 v24, v24
  v_exp_f32 v25, v25
  v_exp_f32 v26, v26
  v_exp_f32 v27, v27
  v_cvt_pk_bf16_f32 v50, v20, v21
  v_cvt_pk_bf16_f32 v51, v22, v23
  v_mfma_f32_32x32x16_bf16 v[112:127], a[76:79], v[60:63], v[112:127]
  buffer_load_dwordx4 v[188:191], v4, s[8:11], s53 offen offset:3072
  s_add_u32 s53, s53, 4096
  v_exp_f32 v28, v28
  v_exp_f32 v29, v29
  v_exp_f32 v30, v30
  v_exp_f32 v31, v31
  v_cvt_pk_bf16_f32 v52, v24, v25
  v_cvt_pk_bf16_f32 v53, v26, v27
  v_cvt_pk_bf16_f32 v54, v28, v29
  v_cvt_pk_bf16_f32 v55, v30, v31
  s_waitcnt vmcnt(22)
  v_mfma_f32_32x32x16_bf16 v[16:31], a[80:83], a[24:27], 0
  v_exp_f32 v32, v32
  v_exp_f32 v33, v33
  v_exp_f32 v34, v34
  v_exp_f32 v35, v35
  v_mfma_f32_32x32x16_bf16 v[80:95], a[88:91], v[48:51], v[80:95]
  v_exp_f32 v36, v36
  v_exp_f32 v37, v37
  v_exp_f32 v38, v38
  v_exp_f32 v39, v39
  v_cvt_pk_bf16_f32 v56, v32, v33
  v_cvt_pk_bf16_f32 v57, v34, v35
  v_mfma_f32_32x32x16_bf16 v[16:31], a[84:87], a[28:31], v[16:31]
  v_exp_f32 v40, v40
  v_exp_f32 v41, v41
  v_exp_f32 v42, v42
  v_exp_f32 v43, v43
  v_cvt_pk_bf16_f32 v58, v36, v37
  v_cvt_pk_bf16_f32 v59, v38, v39
  v_mfma_f32_32x32x16_bf16 v[80:95], a[92:95], v[52:55], v[80:95]
  v_exp_f32 v44, v44
  v_exp_f32 v45, v45
  v_exp_f32 v46, v46
  v_exp_f32 v47, v47
  v_cvt_pk_bf16_f32 v60, v40, v41
  v_cvt_pk_bf16_f32 v61, v42, v43
  v_cvt_pk_bf16_f32 v62, v44, v45
  v_cvt_pk_bf16_f32 v63, v46, v47
  v_mfma_f32_32x32x16_bf16 v[32:47], a[80:83], a[0:3], 0
  v_exp_f32 v16, v16
  v_exp_f32 v17, v17
  v_exp_f32 v18, v18
  v_exp_f32 v19, v19
  v_mfma_f32_32x32x16_bf16 v[96:111], a[88:91], v[56:59], v[96:111]
  ds_write_b128 v9, v[80:83] offset:0
  ds_write_b128 v9, v[84:87] offset:1024
  ds_write_b128 v9, v[88:91] offset:2048
  ds_write_b128 v9, v[92:95] offset:3072
  v_exp_f32 v20, v20
  v_exp_f32 v21, v21
  v_exp_f32 v22, v22
  v_exp_f32 v23, v23
  v_cvt_pk_bf16_f32 v48, v16, v17
  v_cvt_pk_bf16_f32 v49, v18, v19
  v_mfma_f32_32x32x16_bf16 v[32:47], a[84:87], a[4:7], v[32:47]
  v_exp_f32 v24, v24
  v_exp_f32 v25, v25
  v_exp_f32 v26, v26
  v_exp_f32 v27, v27
  v_cvt_pk_bf16_f32 v50, v20, v21
  v_cvt_pk_bf16_f32 v51, v22, v23
  v_mfma_f32_32x32x16_bf16 v[96:111], a[92:95], v[60:63], v[96:111]
  v_exp_f32 v28, v28
  v_exp_f32 v29, v29
  v_exp_f32 v30, v30
  v_exp_f32 v31, v31
  v_cvt_pk_bf16_f32 v52, v24, v25
  v_cvt_pk_bf16_f32 v53, v26, v27
  v_cvt_pk_bf16_f32 v54, v28, v29
  v_cvt_pk_bf16_f32 v55, v30, v31
  v_exp_f32 v32, v32
  v_exp_f32 v33, v33
  v_exp_f32 v34, v34
  v_exp_f32 v35, v35
  v_mfma_f32_32x32x16_bf16 v[112:127], a[88:91], v[48:51], v[112:127]
  ds_write_b128 v10, v[96:99] offset:0
  ds_write_b128 v10, v[100:103] offset:1024
  ds_write_b128 v10, v[104:107] offset:2048
  ds_write_b128 v10, v[108:111] offset:3072
  v_exp_f32 v36, v36
  v_exp_f32 v37, v37
  v_exp_f32 v38, v38
  v_exp_f32 v39, v39
  v_cvt_pk_bf16_f32 v56, v32, v33
  v_cvt_pk_bf16_f32 v57, v34, v35
  v_exp_f32 v40, v40
  v_exp_f32 v41, v41
  v_exp_f32 v42, v42
  v_exp_f32 v43, v43
  v_cvt_pk_bf16_f32 v58, v36, v37
  v_cvt_pk_bf16_f32 v59, v38, v39
  v_mfma_f32_32x32x16_bf16 v[112:127], a[92:95], v[52:55], v[112:127]
  v_exp_f32 v44, v44
  v_exp_f32 v45, v45
  v_exp_f32 v46, v46
  v_exp_f32 v47, v47
  v_cvt_pk_bf16_f32 v60, v40, v41
  v_cvt_pk_bf16_f32 v61, v42, v43
  v_cvt_pk_bf16_f32 v62, v44, v45
  v_cvt_pk_bf16_f32 v63, v46, v47
  s_nop 0
  v_mfma_f32_32x32x16_bf16 v[64:79], a[88:91], v[56:59], v[64:79]
  v_mfma_f32_32x32x16_bf16 v[64:79], a[92:95], v[60:63], v[64:79]
  s_nop 4
  ds_write_b128 v11, v[112:115] offset:0
  ds_write_b128 v11, v[116:119] offset:1024
  ds_write_b128 v11, v[120:123] offset:2048
  ds_write_b128 v11, v[124:127] offset:3072
La_reduce:
  s_waitcnt lgkmcnt(0)
  s_barrier
  ds_read_b128 v[80:83], v12 offset:0
  ds_read_b128 v[84:87], v12 offset:1024
  ds_read_b128 v[88:91], v12 offset:2048
  ds_read_b128 v[92:95], v12 offset:3072
  ds_read_b128 v[96:99], v12 offset:4096
  ds_read_b128 v[100:103], v12 offset:5120
  ds_read_b128 v[104:107], v12 offset:6144
  ds_read_b128 v[108:111], v12 offset:7168
  ds_read_b128 v[112:115], v12 offset:8192
  ds_read_b128 v[116:119], v12 offset:9216
  ds_read_b128 v[120:123], v12 offset:10240
  ds_read_b128 v[124:127], v12 offset:11264
  s_mul_i32 s42, s3, 0x200000
  s_add_u32 s42, s42, 0x1a00000
  s_lshl_b32 s43, s26, 2
  s_add_u32 s43, s43, s16
  s_lshl_b32 s43, s43, 5
  s_lshl_b32 s44, s25, 1
  s_add_u32 s43, s43, s44
  s_lshl_b32 s43, s43, 10
  s_add_u32 s42, s42, s43
  s_waitcnt lgkmcnt(8)
  v_pk_add_f32 v[64:65], v[64:65], v[80:81]
  v_pk_add_f32 v[66:67], v[66:67], v[82:83]
  v_pk_add_f32 v[68:69], v[68:69], v[84:85]
  v_pk_add_f32 v[70:71], v[70:71], v[86:87]
  v_pk_add_f32 v[72:73], v[72:73], v[88:89]
  v_pk_add_f32 v[74:75], v[74:75], v[90:91]
  v_pk_add_f32 v[76:77], v[76:77], v[92:93]
  v_pk_add_f32 v[78:79], v[78:79], v[94:95]
  s_waitcnt lgkmcnt(4)
  v_pk_add_f32 v[64:65], v[64:65], v[96:97]
  v_pk_add_f32 v[66:67], v[66:67], v[98:99]
  v_pk_add_f32 v[68:69], v[68:69], v[100:101]
  v_pk_add_f32 v[70:71], v[70:71], v[102:103]
  v_pk_add_f32 v[72:73], v[72:73], v[104:105]
  v_pk_add_f32 v[74:75], v[74:75], v[106:107]
  v_pk_add_f32 v[76:77], v[76:77], v[108:109]
  v_pk_add_f32 v[78:79], v[78:79], v[110:111]
  s_waitcnt lgkmcnt(0)
  v_pk_add_f32 v[64:65], v[64:65], v[112:113]
  v_pk_add_f32 v[66:67], v[66:67], v[114:115]
  v_pk_add_f32 v[68:69], v[68:69], v[116:117]
  v_pk_add_f32 v[70:71], v[70:71], v[118:119]
  v_pk_add_f32 v[72:73], v[72:73], v[120:121]
  v_pk_add_f32 v[74:75], v[74:75], v[122:123]
  v_pk_add_f32 v[76:77], v[76:77], v[124:125]
  v_pk_add_f32 v[78:79], v[78:79], v[126:127]
  v_mov_b32 v6, v76
  v_mov_b32 v7, v76
  s_nop 1
  v_permlane32_swap_b32 v6, v7
  s_nop 1
  v_rcp_f32 v6, v7
  s_nop 0
  v_pk_mul_f32 v[64:65], v[64:65], v[6:7] op_sel_hi:[1,0]
  v_pk_mul_f32 v[66:67], v[66:67], v[6:7] op_sel_hi:[1,0]
  v_pk_mul_f32 v[68:69], v[68:69], v[6:7] op_sel_hi:[1,0]
  v_pk_mul_f32 v[70:71], v[70:71], v[6:7] op_sel_hi:[1,0]
  v_pk_mul_f32 v[72:73], v[72:73], v[6:7] op_sel_hi:[1,0]
  v_pk_mul_f32 v[74:75], v[74:75], v[6:7] op_sel_hi:[1,0]
  v_pk_mul_f32 v[76:77], v[76:77], v[6:7] op_sel_hi:[1,0]
  v_pk_mul_f32 v[78:79], v[78:79], v[6:7] op_sel_hi:[1,0]
  v_cvt_pk_bf16_f32 v16, v64, v65
  v_cvt_pk_bf16_f32 v17, v66, v67
  v_cvt_pk_bf16_f32 v18, v68, v69
  v_cvt_pk_bf16_f32 v19, v70, v71
  v_cvt_pk_bf16_f32 v20, v72, v73
  v_cvt_pk_bf16_f32 v21, v74, v75
  v_cvt_pk_bf16_f32 v22, v76, v77
  v_cvt_pk_bf16_f32 v23, v78, v79
  buffer_store_dwordx4 v[16:19], v4, s[8:11], s42 offen sc1
  buffer_store_dwordx4 v[20:23], v4, s[8:11], s42 offen offset:1024 sc1
  s_mul_i32 s30, s3, 10240
  s_add_u32 s30, s30, 0xd10800
  s_lshl_b32 s63, s26, 7
  s_add_u32 s30, s30, s63
  s_lshl_b32 s63, s25, 2
  s_add_u32 s30, s30, s63
  v_mov_b32 v6, 0
  v_mov_b32 v7, s66
  s_cmp_lg_u32 s16, 0
  s_waitcnt vmcnt(0)
  s_barrier
  s_cbranch_scc1 La_fa_nf
  s_mov_b64 exec, 1
  buffer_store_dword v7, v6, s[8:11], s30 offen sc1
  s_mov_b64 exec, -1
La_fa_nf:
  s_branch La_done
La_slow:
  v_mov_b32 v56, 0xff61b1e6
  v_mov_b32 v57, 0xff61b1e6
  v_mov_b32 v58, 0xff61b1e6
  v_mov_b32 v59, 0xff61b1e6
  v_mov_b32 v64, 0
  v_mov_b32 v65, 0
  v_mov_b32 v66, 0
  v_mov_b32 v67, 0
  v_mov_b32 v68, 0
  v_mov_b32 v69, 0
  v_mov_b32 v70, 0
  v_mov_b32 v71, 0
  v_mov_b32 v72, 0
  v_mov_b32 v73, 0
  v_mov_b32 v74, 0
  v_mov_b32 v75, 0
  v_mov_b32 v76, 0
  v_mov_b32 v77, 0
  v_mov_b32 v78, 0
  v_mov_b32 v79, 0
  v_mov_b32 v80, 0
  v_mov_b32 v81, 0
  v_mov_b32 v82, 0
  v_mov_b32 v83, 0
  v_mov_b32 v84, 0
  v_mov_b32 v85, 0
  v_mov_b32 v86, 0
  v_mov_b32 v87, 0
  v_mov_b32 v88, 0
  v_mov_b32 v89, 0
  v_mov_b32 v90, 0
  v_mov_b32 v91, 0
  v_mov_b32 v92, 0
  v_mov_b32 v93, 0
  v_mov_b32 v94, 0
  v_mov_b32 v95, 0
  v_mov_b32 v96, 0
  v_mov_b32 v97, 0
  v_mov_b32 v98, 0
  v_mov_b32 v99, 0
  v_mov_b32 v100, 0
  v_mov_b32 v101, 0
  v_mov_b32 v102, 0
  v_mov_b32 v103, 0
  v_mov_b32 v104, 0
  v_mov_b32 v105, 0
  v_mov_b32 v106, 0
  v_mov_b32 v107, 0
  v_mov_b32 v108, 0
  v_mov_b32 v109, 0
  v_mov_b32 v110, 0
  v_mov_b32 v111, 0
  v_mov_b32 v112, 0
  v_mov_b32 v113, 0
  v_mov_b32 v114, 0
  v_mov_b32 v115, 0
  v_mov_b32 v116, 0
  v_mov_b32 v117, 0
  v_mov_b32 v118, 0
  v_mov_b32 v119, 0
  v_mov_b32 v120, 0
  v_mov_b32 v121, 0
  v_mov_b32 v122, 0
  v_mov_b32 v123, 0
  v_mov_b32 v124, 0
  v_mov_b32 v125, 0
  v_mov_b32 v126, 0
  v_mov_b32 v127, 0
  s_waitcnt vmcnt(0)
  buffer_load_dwordx4 a[16:19], v4, s[8:11], s35 offen sc1
  buffer_load_dwordx4 a[20:23], v4, s[8:11], s35 offen offset:1024 sc1
  buffer_load_dwordx4 a[24:27], v4, s[8:11], s36 offen sc1
  buffer_load_dwordx4 a[28:31], v4, s[8:11], s36 offen offset:1024 sc1
  buffer_load_dwordx4 a[96:99], v4, s[8:11], s52 offen offset:0
  s_mov_b32 m0, s47
  s_add_u32 s47, s47, 4096
  buffer_load_dwordx4 v4, s[8:11], s46 offen offset:0 lds
  buffer_load_dwordx4 a[100:103], v4, s[8:11], s53 offen offset:0
  buffer_load_dwordx4 v[192:195], v4, s[8:11], s40 offen offset:0
  buffer_load_dwordx4 a[104:107], v4, s[8:11], s52 offen offset:1024
  buffer_load_dwordx4 v4, s[8:11], s46 offen offset:1024 lds
  buffer_load_dwordx4 a[108:111], v4, s[8:11], s53 offen offset:1024
  buffer_load_dwordx4 a[112:115], v4, s[8:11], s52 offen offset:2048
  buffer_load_dwordx4 v4, s[8:11], s46 offen offset:2048 lds
  buffer_load_dwordx4 v[224:227], v4, s[8:11], s41 offen offset:0
  buffer_load_dwordx4 a[116:119], v4, s[8:11], s53 offen offset:2048
  buffer_load_dwordx4 a[120:123], v4, s[8:11], s52 offen offset:3072
  s_add_u32 s52, s52, 4096
  buffer_load_dwordx4 v4, s[8:11], s46 offen offset:3072 lds
  s_add_u32 s46, s46, 4096
  buffer_load_dwordx4 a[124:127], v4, s[8:11], s53 offen offset:3072
  s_add_u32 s53, s53, 4096
  buffer_load_dwordx4 a[128:131], v4, s[8:11], s52 offen offset:0
  buffer_load_dwordx4 v[196:199], v4, s[8:11], s40 offen offset:1024
  s_mov_b32 m0, s47
  s_add_u32 s47, s47, 4096
  buffer_load_dwordx4 v4, s[8:11], s46 offen offset:0 lds
  buffer_load_dwordx4 a[132:135], v4, s[8:11], s53 offen offset:0
  buffer_load_dwordx4 a[136:139], v4, s[8:11], s52 offen offset:1024
  buffer_load_dwordx4 v4, s[8:11], s46 offen offset:1024 lds
  buffer_load_dwordx4 a[140:143], v4, s[8:11], s53 offen offset:1024
  buffer_load_dwordx4 v[228:231], v4, s[8:11], s41 offen offset:1024
  buffer_load_dwordx4 a[144:147], v4, s[8:11], s52 offen offset:2048
  buffer_load_dwordx4 v4, s[8:11], s46 offen offset:2048 lds
  buffer_load_dwordx4 a[148:151], v4, s[8:11], s53 offen offset:2048
  buffer_load_dwordx4 a[152:155], v4, s[8:11], s52 offen offset:3072
  s_add_u32 s52, s52, 4096
  buffer_load_dwordx4 v4, s[8:11], s46 offen offset:3072 lds
  s_add_u32 s46, s46, 4096
  buffer_load_dwordx4 a[156:159], v4, s[8:11], s53 offen offset:3072
  s_add_u32 s53, s53, 4096
  buffer_load_dwordx4 v[200:203], v4, s[8:11], s40 offen offset:2048
  buffer_load_dwordx4 a[160:163], v4, s[8:11], s52 offen offset:0
  s_mov_b32 m0, s47
  s_add_u32 s47, s47, 4096
  buffer_load_dwordx4 v4, s[8:11], s46 offen offset:0 lds
  buffer_load_dwordx4 a[164:167], v4, s[8:11], s53 offen offset:0
  buffer_load_dwordx4 a[168:171], v4, s[8:11], s52 offen offset:1024
  buffer_load_dwordx4 v4, s[8:11], s46 offen offset:1024 lds
  buffer_load_dwordx4 v[232:235], v4, s[8:11], s41 offen offset:2048
  buffer_load_dwordx4 a[172:175], v4, s[8:11], s53 offen offset:1024
  buffer_load_dwordx4 a[176:179], v4, s[8:11], s52 offen offset:2048
  buffer_load_dwordx4 v4, s[8:11], s46 offen offset:2048 lds
  buffer_load_dwordx4 a[180:183], v4, s[8:11], s53 offen offset:2048
  buffer_load_dwordx4 a[184:187], v4, s[8:11], s52 offen offset:3072
  s_add_u32 s52, s52, 4096
  buffer_load_dwordx4 v[204:207], v4, s[8:11], s40 offen offset:3072
  s_add_u32 s40, s40, 4096
  buffer_load_dwordx4 v4, s[8:11], s46 offen offset:3072 lds
  s_add_u32 s46, s46, 4096
  buffer_load_dwordx4 a[188:191], v4, s[8:11], s53 offen offset:3072
  s_add_u32 s53, s53, 4096
  buffer_load_dwordx4 a[192:195], v4, s[8:11], s52 offen offset:0
  s_mov_b32 m0, s47
  s_add_u32 s47, s47, 4096
  buffer_load_dwordx4 v4, s[8:11], s46 offen offset:0 lds
  buffer_load_dwordx4 a[196:199], v4, s[8:11], s53 offen offset:0
  buffer_load_dwordx4 v[236:239], v4, s[8:11], s41 offen offset:3072
  s_add_u32 s41, s41, 4096
  buffer_load_dwordx4 a[200:203], v4, s[8:11], s52 offen offset:1024
  buffer_load_dwordx4 v4, s[8:11], s46 offen offset:1024 lds
  buffer_load_dwordx4 a[204:207], v4, s[8:11], s53 offen offset:1024
  buffer_load_dwordx4 a[208:211], v4, s[8:11], s52 offen offset:2048
  buffer_load_dwordx4 v4, s[8:11], s46 offen offset:2048 lds
  buffer_load_dwordx4 a[212:215], v4, s[8:11], s53 offen offset:2048
  buffer_load_dwordx4 v[208:211], v4, s[8:11], s40 offen offset:0
  buffer_load_dwordx4 a[216:219], v4, s[8:11], s52 offen offset:3072
  s_add_u32 s52, s52, 4096
  buffer_load_dwordx4 v4, s[8:11], s46 offen offset:3072 lds
  s_add_u32 s46, s46, 4096
  buffer_load_dwordx4 a[220:223], v4, s[8:11], s53 offen offset:3072
  s_add_u32 s53, s53, 4096
  buffer_load_dwordx4 a[224:227], v4, s[8:11], s52 offen offset:0
  s_mov_b32 m0, s47
  s_add_u32 s47, s47, 4096
  buffer_load_dwordx4 v4, s[8:11], s46 offen offset:0 lds
  buffer_load_dwordx4 v[240:243], v4, s[8:11], s41 offen offset:0
  buffer_load_dwordx4 a[228:231], v4, s[8:11], s53 offen offset:0
  buffer_load_dwordx4 a[232:235], v4, s[8:11], s52 offen offset:1024
  buffer_load_dwordx4 v4, s[8:11], s46 offen offset:1024 lds
  buffer_load_dwordx4 a[236:239], v4, s[8:11], s53 offen offset:1024
  buffer_load_dwordx4 a[240:243], v4, s[8:11], s52 offen offset:2048
  buffer_load_dwordx4 v[212:215], v4, s[8:11], s40 offen offset:1024
  buffer_load_dwordx4 v4, s[8:11], s46 offen offset:2048 lds
  buffer_load_dwordx4 a[244:247], v4, s[8:11], s53 offen offset:2048
  buffer_load_dwordx4 a[248:251], v4, s[8:11], s52 offen offset:3072
  s_add_u32 s52, s52, 4096
  buffer_load_dwordx4 v4, s[8:11], s46 offen offset:3072 lds
  s_add_u32 s46, s46, 4096
  buffer_load_dwordx4 a[252:255], v4, s[8:11], s53 offen offset:3072
  s_add_u32 s53, s53, 4096
  buffer_load_dwordx4 v[244:247], v4, s[8:11], s41 offen offset:1024
  buffer_load_dwordx4 v[128:131], v4, s[8:11], s52 offen offset:0
  s_mov_b32 m0, s47
  s_add_u32 s47, s47, 4096
  buffer_load_dwordx4 v4, s[8:11], s46 offen offset:0 lds
  buffer_load_dwordx4 v[132:135], v4, s[8:11], s53 offen offset:0
  buffer_load_dwordx4 v[136:139], v4, s[8:11], s52 offen offset:1024
  buffer_load_dwordx4 v4, s[8:11], s46 offen offset:1024 lds
  buffer_load_dwordx4 v[140:143], v4, s[8:11], s53 offen offset:1024
  buffer_load_dwordx4 v[216:219], v4, s[8:11], s40 offen offset:2048
  buffer_load_dwordx4 v[144:147], v4, s[8:11], s52 offen offset:2048
  buffer_load_dwordx4 v4, s[8:11], s46 offen offset:2048 lds
  buffer_load_dwordx4 v[148:151], v4, s[8:11], s53 offen offset:2048
  buffer_load_dwordx4 v[152:155], v4, s[8:11], s52 offen offset:3072
  s_add_u32 s52, s52, 4096
  buffer_load_dwordx4 v4, s[8:11], s46 offen offset:3072 lds
  s_add_u32 s46, s46, 4096
  buffer_load_dwordx4 v[248:251], v4, s[8:11], s41 offen offset:2048
  buffer_load_dwordx4 v[156:159], v4, s[8:11], s53 offen offset:3072
  s_add_u32 s53, s53, 4096
  buffer_load_dwordx4 v[160:163], v4, s[8:11], s52 offen offset:0
  s_mov_b32 m0, s47
  s_add_u32 s47, s47, 4096
  buffer_load_dwordx4 v4, s[8:11], s46 offen offset:0 lds
  buffer_load_dwordx4 v[164:167], v4, s[8:11], s53 offen offset:0
  buffer_load_dwordx4 v[168:171], v4, s[8:11], s52 offen offset:1024
  buffer_load_dwordx4 v[220:223], v4, s[8:11], s40 offen offset:3072
  s_add_u32 s40, s40, 4096
  buffer_load_dwordx4 v4, s[8:11], s46 offen offset:1024 lds
  buffer_load_dwordx4 v[172:175], v4, s[8:11], s53 offen offset:1024
  buffer_load_dwordx4 v[176:179], v4, s[8:11], s52 offen offset:2048
  buffer_load_dwordx4 v4, s[8:11], s46 offen offset:2048 lds
  buffer_load_dwordx4 v[180:183], v4, s[8:11], s53 offen offset:2048
  buffer_load_dwordx4 v[252:255], v4, s[8:11], s41 offen offset:3072
  s_add_u32 s41, s41, 4096
  buffer_load_dwordx4 v[184:187], v4, s[8:11], s52 offen offset:3072
  s_add_u32 s52, s52, 4096
  buffer_load_dwordx4 v4, s[8:11], s46 offen offset:3072 lds
  s_add_u32 s46, s46, 4096
  buffer_load_dwordx4 v[188:191], v4, s[8:11], s53 offen offset:3072
  s_add_u32 s53, s53, 4096
  s_mov_b32 s49, 16
La_sloop:
  buffer_load_dwordx4 a[32:35], v4, s[8:11], s31 offen sc1
  buffer_load_dwordx4 a[36:39], v4, s[8:11], s31 offen offset:1024 sc1
  buffer_load_dwordx4 a[40:43], v4, s[8:11], s32 offen sc1
  buffer_load_dwordx4 a[44:47], v4, s[8:11], s32 offen offset:1024 sc1
  s_add_u32 s31, s31, 2048
  s_add_u32 s32, s32, 2048
  s_waitcnt vmcnt(0)
  v_mfma_f32_32x32x16_bf16 v[16:31], a[32:35], a[0:3], 0
  v_mfma_f32_32x32x16_bf16 v[16:31], a[36:39], a[4:7], v[16:31]
  s_nop 7
  s_nop 7
  v_max_f32 v6, v16, v17
  v_max_f32 v6, v6, v18
  v_max_f32 v6, v6, v19
  v_max_f32 v6, v6, v20
  v_max_f32 v6, v6, v21
  v_max_f32 v6, v6, v22
  v_max_f32 v6, v6, v23
  v_max_f32 v6, v6, v24
  v_max_f32 v6, v6, v25
  v_max_f32 v6, v6, v26
  v_max_f32 v6, v6, v27
  v_max_f32 v6, v6, v28
  v_max_f32 v6, v6, v29
  v_max_f32 v6, v6, v30
  v_max_f32 v6, v6, v31
  v_mov_b32 v7, v6
  s_nop 1
  v_permlane32_swap_b32 v6, v7
  s_nop 1
  v_max_f32 v6, v6, v7
  v_max_f32 v6, v6, v56
  v_sub_f32 v7, v56, v6
  v_exp_f32 v7, v7
  v_mov_b32 v56, v6
  v_sub_f32 v16, v16, v6
  v_sub_f32 v17, v17, v6
  v_sub_f32 v18, v18, v6
  v_sub_f32 v19, v19, v6
  v_sub_f32 v20, v20, v6
  v_sub_f32 v21, v21, v6
  v_sub_f32 v22, v22, v6
  v_sub_f32 v23, v23, v6
  v_sub_f32 v24, v24, v6
  v_sub_f32 v25, v25, v6
  v_sub_f32 v26, v26, v6
  v_sub_f32 v27, v27, v6
  v_sub_f32 v28, v28, v6
  v_sub_f32 v29, v29, v6
  v_sub_f32 v30, v30, v6
  v_sub_f32 v31, v31, v6
  v_exp_f32 v16, v16
  v_exp_f32 v17, v17
  v_exp_f32 v18, v18
  v_exp_f32 v19, v19
  v_exp_f32 v20, v20
  v_exp_f32 v21, v21
  v_exp_f32 v22, v22
  v_exp_f32 v23, v23
  v_exp_f32 v24, v24
  v_exp_f32 v25, v25
  v_exp_f32 v26, v26
  v_exp_f32 v27, v27
  v_exp_f32 v28, v28
  v_exp_f32 v29, v29
  v_exp_f32 v30, v30
  v_exp_f32 v31, v31
  v_mul_f32 v64, v64, v7
  v_mul_f32 v65, v65, v7
  v_mul_f32 v66, v66, v7
  v_mul_f32 v67, v67, v7
  v_mul_f32 v68, v68, v7
  v_mul_f32 v69, v69, v7
  v_mul_f32 v70, v70, v7
  v_mul_f32 v71, v71, v7
  v_mul_f32 v72, v72, v7
  v_mul_f32 v73, v73, v7
  v_mul_f32 v74, v74, v7
  v_mul_f32 v75, v75, v7
  v_mul_f32 v76, v76, v7
  v_mul_f32 v77, v77, v7
  v_mul_f32 v78, v78, v7
  v_mul_f32 v79, v79, v7
  v_cvt_pk_bf16_f32 v48, v16, v17
  v_cvt_pk_bf16_f32 v49, v18, v19
  v_cvt_pk_bf16_f32 v50, v20, v21
  v_cvt_pk_bf16_f32 v51, v22, v23
  v_cvt_pk_bf16_f32 v52, v24, v25
  v_cvt_pk_bf16_f32 v53, v26, v27
  v_cvt_pk_bf16_f32 v54, v28, v29
  v_cvt_pk_bf16_f32 v55, v30, v31
  s_nop 1
  v_mfma_f32_32x32x16_bf16 v[64:79], a[40:43], v[48:51], v[64:79]
  v_mfma_f32_32x32x16_bf16 v[64:79], a[44:47], v[52:55], v[64:79]
  s_nop 7
  s_nop 7
  v_mfma_f32_32x32x16_bf16 v[16:31], a[32:35], a[8:11], 0
  v_mfma_f32_32x32x16_bf16 v[16:31], a[36:39], a[12:15], v[16:31]
  s_nop 7
  s_nop 7
  v_max_f32 v6, v16, v17
  v_max_f32 v6, v6, v18
  v_max_f32 v6, v6, v19
  v_max_f32 v6, v6, v20
  v_max_f32 v6, v6, v21
  v_max_f32 v6, v6, v22
  v_max_f32 v6, v6, v23
  v_max_f32 v6, v6, v24
  v_max_f32 v6, v6, v25
  v_max_f32 v6, v6, v26
  v_max_f32 v6, v6, v27
  v_max_f32 v6, v6, v28
  v_max_f32 v6, v6, v29
  v_max_f32 v6, v6, v30
  v_max_f32 v6, v6, v31
  v_mov_b32 v7, v6
  s_nop 1
  v_permlane32_swap_b32 v6, v7
  s_nop 1
  v_max_f32 v6, v6, v7
  v_max_f32 v6, v6, v57
  v_sub_f32 v7, v57, v6
  v_exp_f32 v7, v7
  v_mov_b32 v57, v6
  v_sub_f32 v16, v16, v6
  v_sub_f32 v17, v17, v6
  v_sub_f32 v18, v18, v6
  v_sub_f32 v19, v19, v6
  v_sub_f32 v20, v20, v6
  v_sub_f32 v21, v21, v6
  v_sub_f32 v22, v22, v6
  v_sub_f32 v23, v23, v6
  v_sub_f32 v24, v24, v6
  v_sub_f32 v25, v25, v6
  v_sub_f32 v26, v26, v6
  v_sub_f32 v27, v27, v6
  v_sub_f32 v28, v28, v6
  v_sub_f32 v29, v29, v6
  v_sub_f32 v30, v30, v6
  v_sub_f32 v31, v31, v6
  v_exp_f32 v16, v16
  v_exp_f32 v17, v17
  v_exp_f32 v18, v18
  v_exp_f32 v19, v19
  v_exp_f32 v20, v20
  v_exp_f32 v21, v21
  v_exp_f32 v22, v22
  v_exp_f32 v23, v23
  v_exp_f32 v24, v24
  v_exp_f32 v25, v25
  v_exp_f32 v26, v26
  v_exp_f32 v27, v27
  v_exp_f32 v28, v28
  v_exp_f32 v29, v29
  v_exp_f32 v30, v30
  v_exp_f32 v31, v31
  v_mul_f32 v80, v80, v7
  v_mul_f32 v81, v81, v7
  v_mul_f32 v82, v82, v7
  v_mul_f32 v83, v83, v7
  v_mul_f32 v84, v84, v7
  v_mul_f32 v85, v85, v7
  v_mul_f32 v86, v86, v7
  v_mul_f32 v87, v87, v7
  v_mul_f32 v88, v88, v7
  v_mul_f32 v89, v89, v7
  v_mul_f32 v90, v90, v7
  v_mul_f32 v91, v91, v7
  v_mul_f32 v92, v92, v7
  v_mul_f32 v93, v93, v7
  v_mul_f32 v94, v94, v7
  v_mul_f32 v95, v95, v7
  v_cvt_pk_bf16_f32 v48, v16, v17
  v_cvt_pk_bf16_f32 v49, v18, v19
  v_cvt_pk_bf16_f32 v50, v20, v21
  v_cvt_pk_bf16_f32 v51, v22, v23
  v_cvt_pk_bf16_f32 v52, v24, v25
  v_cvt_pk_bf16_f32 v53, v26, v27
  v_cvt_pk_bf16_f32 v54, v28, v29
  v_cvt_pk_bf16_f32 v55, v30, v31
  s_nop 1
  v_mfma_f32_32x32x16_bf16 v[80:95], a[40:43], v[48:51], v[80:95]
  v_mfma_f32_32x32x16_bf16 v[80:95], a[44:47], v[52:55], v[80:95]
  s_nop 7
  s_nop 7
  v_mfma_f32_32x32x16_bf16 v[16:31], a[32:35], a[16:19], 0
  v_mfma_f32_32x32x16_bf16 v[16:31], a[36:39], a[20:23], v[16:31]
  s_nop 7
  s_nop 7
  v_max_f32 v6, v16, v17
  v_max_f32 v6, v6, v18
  v_max_f32 v6, v6, v19
  v_max_f32 v6, v6, v20
  v_max_f32 v6, v6, v21
  v_max_f32 v6, v6, v22
  v_max_f32 v6, v6, v23
  v_max_f32 v6, v6, v24
  v_max_f32 v6, v6, v25
  v_max_f32 v6, v6, v26
  v_max_f32 v6, v6, v27
  v_max_f32 v6, v6, v28
  v_max_f32 v6, v6, v29
  v_max_f32 v6, v6, v30
  v_max_f32 v6, v6, v31
  v_mov_b32 v7, v6
  s_nop 1
  v_permlane32_swap_b32 v6, v7
  s_nop 1
  v_max_f32 v6, v6, v7
  v_max_f32 v6, v6, v58
  v_sub_f32 v7, v58, v6
  v_exp_f32 v7, v7
  v_mov_b32 v58, v6
  v_sub_f32 v16, v16, v6
  v_sub_f32 v17, v17, v6
  v_sub_f32 v18, v18, v6
  v_sub_f32 v19, v19, v6
  v_sub_f32 v20, v20, v6
  v_sub_f32 v21, v21, v6
  v_sub_f32 v22, v22, v6
  v_sub_f32 v23, v23, v6
  v_sub_f32 v24, v24, v6
  v_sub_f32 v25, v25, v6
  v_sub_f32 v26, v26, v6
  v_sub_f32 v27, v27, v6
  v_sub_f32 v28, v28, v6
  v_sub_f32 v29, v29, v6
  v_sub_f32 v30, v30, v6
  v_sub_f32 v31, v31, v6
  v_exp_f32 v16, v16
  v_exp_f32 v17, v17
  v_exp_f32 v18, v18
  v_exp_f32 v19, v19
  v_exp_f32 v20, v20
  v_exp_f32 v21, v21
  v_exp_f32 v22, v22
  v_exp_f32 v23, v23
  v_exp_f32 v24, v24
  v_exp_f32 v25, v25
  v_exp_f32 v26, v26
  v_exp_f32 v27, v27
  v_exp_f32 v28, v28
  v_exp_f32 v29, v29
  v_exp_f32 v30, v30
  v_exp_f32 v31, v31
  v_mul_f32 v96, v96, v7
  v_mul_f32 v97, v97, v7
  v_mul_f32 v98, v98, v7
  v_mul_f32 v99, v99, v7
  v_mul_f32 v100, v100, v7
  v_mul_f32 v101, v101, v7
  v_mul_f32 v102, v102, v7
  v_mul_f32 v103, v103, v7
  v_mul_f32 v104, v104, v7
  v_mul_f32 v105, v105, v7
  v_mul_f32 v106, v106, v7
  v_mul_f32 v107, v107, v7
  v_mul_f32 v108, v108, v7
  v_mul_f32 v109, v109, v7
  v_mul_f32 v110, v110, v7
  v_mul_f32 v111, v111, v7
  v_cvt_pk_bf16_f32 v48, v16, v17
  v_cvt_pk_bf16_f32 v49, v18, v19
  v_cvt_pk_bf16_f32 v50, v20, v21
  v_cvt_pk_bf16_f32 v51, v22, v23
  v_cvt_pk_bf16_f32 v52, v24, v25
  v_cvt_pk_bf16_f32 v53, v26, v27
  v_cvt_pk_bf16_f32 v54, v28, v29
  v_cvt_pk_bf16_f32 v55, v30, v31
  s_nop 1
  v_mfma_f32_32x32x16_bf16 v[96:111], a[40:43], v[48:51], v[96:111]
  v_mfma_f32_32x32x16_bf16 v[96:111], a[44:47], v[52:55], v[96:111]
  s_nop 7
  s_nop 7
  v_mfma_f32_32x32x16_bf16 v[16:31], a[32:35], a[24:27], 0
  v_mfma_f32_32x32x16_bf16 v[16:31], a[36:39], a[28:31], v[16:31]
  s_nop 7
  s_nop 7
  v_max_f32 v6, v16, v17
  v_max_f32 v6, v6, v18
  v_max_f32 v6, v6, v19
  v_max_f32 v6, v6, v20
  v_max_f32 v6, v6, v21
  v_max_f32 v6, v6, v22
  v_max_f32 v6, v6, v23
  v_max_f32 v6, v6, v24
  v_max_f32 v6, v6, v25
  v_max_f32 v6, v6, v26
  v_max_f32 v6, v6, v27
  v_max_f32 v6, v6, v28
  v_max_f32 v6, v6, v29
  v_max_f32 v6, v6, v30
  v_max_f32 v6, v6, v31
  v_mov_b32 v7, v6
  s_nop 1
  v_permlane32_swap_b32 v6, v7
  s_nop 1
  v_max_f32 v6, v6, v7
  v_max_f32 v6, v6, v59
  v_sub_f32 v7, v59, v6
  v_exp_f32 v7, v7
  v_mov_b32 v59, v6
  v_sub_f32 v16, v16, v6
  v_sub_f32 v17, v17, v6
  v_sub_f32 v18, v18, v6
  v_sub_f32 v19, v19, v6
  v_sub_f32 v20, v20, v6
  v_sub_f32 v21, v21, v6
  v_sub_f32 v22, v22, v6
  v_sub_f32 v23, v23, v6
  v_sub_f32 v24, v24, v6
  v_sub_f32 v25, v25, v6
  v_sub_f32 v26, v26, v6
  v_sub_f32 v27, v27, v6
  v_sub_f32 v28, v28, v6
  v_sub_f32 v29, v29, v6
  v_sub_f32 v30, v30, v6
  v_sub_f32 v31, v31, v6
  v_exp_f32 v16, v16
  v_exp_f32 v17, v17
  v_exp_f32 v18, v18
  v_exp_f32 v19, v19
  v_exp_f32 v20, v20
  v_exp_f32 v21, v21
  v_exp_f32 v22, v22
  v_exp_f32 v23, v23
  v_exp_f32 v24, v24
  v_exp_f32 v25, v25
  v_exp_f32 v26, v26
  v_exp_f32 v27, v27
  v_exp_f32 v28, v28
  v_exp_f32 v29, v29
  v_exp_f32 v30, v30
  v_exp_f32 v31, v31
  v_mul_f32 v112, v112, v7
  v_mul_f32 v113, v113, v7
  v_mul_f32 v114, v114, v7
  v_mul_f32 v115, v115, v7
  v_mul_f32 v116, v116, v7
  v_mul_f32 v117, v117, v7
  v_mul_f32 v118, v118, v7
  v_mul_f32 v119, v119, v7
  v_mul_f32 v120, v120, v7
  v_mul_f32 v121, v121, v7
  v_mul_f32 v122, v122, v7
  v_mul_f32 v123, v123, v7
  v_mul_f32 v124, v124, v7
  v_mul_f32 v125, v125, v7
  v_mul_f32 v126, v126, v7
  v_mul_f32 v127, v127, v7
  v_cvt_pk_bf16_f32 v48, v16, v17
  v_cvt_pk_bf16_f32 v49, v18, v19
  v_cvt_pk_bf16_f32 v50, v20, v21
  v_cvt_pk_bf16_f32 v51, v22, v23
  v_cvt_pk_bf16_f32 v52, v24, v25
  v_cvt_pk_bf16_f32 v53, v26, v27
  v_cvt_pk_bf16_f32 v54, v28, v29
  v_cvt_pk_bf16_f32 v55, v30, v31
  s_nop 1
  v_mfma_f32_32x32x16_bf16 v[112:127], a[40:43], v[48:51], v[112:127]
  v_mfma_f32_32x32x16_bf16 v[112:127], a[44:47], v[52:55], v[112:127]
  s_nop 7
  s_nop 7
  s_sub_u32 s49, s49, 1
  s_cmp_lg_u32 s49, 0
  s_cbranch_scc1 La_sloop
  s_xor_b32 s42, s16, 0
  s_lshl_b32 s42, s42, 7
  s_lshl_b32 s43, s16, 9
  s_add_u32 s42, s42, s43
  s_add_u32 s42, s42, 114688
  v_lshl_add_u32 v13, v2, 2, s42
  ds_write_b32 v13, v56
  s_xor_b32 s42, s16, 1
  s_lshl_b32 s42, s42, 7
  s_lshl_b32 s43, s16, 9
  s_add_u32 s42, s42, s43
  s_add_u32 s42, s42, 114688
  v_lshl_add_u32 v13, v2, 2, s42
  ds_write_b32 v13, v57
  s_xor_b32 s42, s16, 2
  s_lshl_b32 s42, s42, 7
  s_lshl_b32 s43, s16, 9
  s_add_u32 s42, s42, s43
  s_add_u32 s42, s42, 114688
  v_lshl_add_u32 v13, v2, 2, s42
  ds_write_b32 v13, v58
  s_xor_b32 s42, s16, 3
  s_lshl_b32 s42, s42, 7
  s_lshl_b32 s43, s16, 9
  s_add_u32 s42, s42, s43
  s_add_u32 s42, s42, 114688
  v_lshl_add_u32 v13, v2, 2, s42
  ds_write_b32 v13, v59
  s_waitcnt lgkmcnt(0)
  s_barrier
  s_xor_b32 s42, s16, 0
  s_lshl_b32 s42, s42, 7
  s_add_u32 s42, s42, 114688
  v_lshl_add_u32 v13, v2, 2, s42
  ds_read_b32 v16, v13 offset:0
  ds_read_b32 v17, v13 offset:512
  ds_read_b32 v18, v13 offset:1024
  ds_read_b32 v19, v13 offset:1536
  s_xor_b32 s42, s16, 1
  s_lshl_b32 s42, s42, 7
  s_add_u32 s42, s42, 114688
  v_lshl_add_u32 v13, v2, 2, s42
  ds_read_b32 v20, v13 offset:0
  ds_read_b32 v21, v13 offset:512
  ds_read_b32 v22, v13 offset:1024
  ds_read_b32 v23, v13 offset:1536
  s_xor_b32 s42, s16, 2
  s_lshl_b32 s42, s42, 7
  s_add_u32 s42, s42, 114688
  v_lshl_add_u32 v13, v2, 2, s42
  ds_read_b32 v24, v13 offset:0
  ds_read_b32 v25, v13 offset:512
  ds_read_b32 v26, v13 offset:1024
  ds_read_b32 v27, v13 offset:1536
  s_xor_b32 s42, s16, 3
  s_lshl_b32 s42, s42, 7
  s_add_u32 s42, s42, 114688
  v_lshl_add_u32 v13, v2, 2, s42
  ds_read_b32 v28, v13 offset:0
  ds_read_b32 v29, v13 offset:512
  ds_read_b32 v30, v13 offset:1024
  ds_read_b32 v31, v13 offset:1536
  s_waitcnt lgkmcnt(0)
  s_barrier
  v_max_f32 v6, v16, v17
  v_max_f32 v7, v18, v19
  v_max_f32 v6, v6, v7
  v_sub_f32 v7, v56, v6
  v_exp_f32 v7, v7
  s_nop 0
  v_mul_f32 v64, v64, v7
  v_mul_f32 v65, v65, v7
  v_mul_f32 v66, v66, v7
  v_mul_f32 v67, v67, v7
  v_mul_f32 v68, v68, v7
  v_mul_f32 v69, v69, v7
  v_mul_f32 v70, v70, v7
  v_mul_f32 v71, v71, v7
  v_mul_f32 v72, v72, v7
  v_mul_f32 v73, v73, v7
  v_mul_f32 v74, v74, v7
  v_mul_f32 v75, v75, v7
  v_mul_f32 v76, v76, v7
  v_mul_f32 v77, v77, v7
  v_mul_f32 v78, v78, v7
  v_mul_f32 v79, v79, v7
  v_max_f32 v6, v20, v21
  v_max_f32 v7, v22, v23
  v_max_f32 v6, v6, v7
  v_sub_f32 v7, v57, v6
  v_exp_f32 v7, v7
  s_nop 0
  v_mul_f32 v80, v80, v7
  v_mul_f32 v81, v81, v7
  v_mul_f32 v82, v82, v7
  v_mul_f32 v83, v83, v7
  v_mul_f32 v84, v84, v7
  v_mul_f32 v85, v85, v7
  v_mul_f32 v86, v86, v7
  v_mul_f32 v87, v87, v7
  v_mul_f32 v88, v88, v7
  v_mul_f32 v89, v89, v7
  v_mul_f32 v90, v90, v7
  v_mul_f32 v91, v91, v7
  v_mul_f32 v92, v92, v7
  v_mul_f32 v93, v93, v7
  v_mul_f32 v94, v94, v7
  v_mul_f32 v95, v95, v7
  v_max_f32 v6, v24, v25
  v_max_f32 v7, v26, v27
  v_max_f32 v6, v6, v7
  v_sub_f32 v7, v58, v6
  v_exp_f32 v7, v7
  s_nop 0
  v_mul_f32 v96, v96, v7
  v_mul_f32 v97, v97, v7
  v_mul_f32 v98, v98, v7
  v_mul_f32 v99, v99, v7
  v_mul_f32 v100, v100, v7
  v_mul_f32 v101, v101, v7
  v_mul_f32 v102, v102, v7
  v_mul_f32 v103, v103, v7
  v_mul_f32 v104, v104, v7
  v_mul_f32 v105, v105, v7
  v_mul_f32 v106, v106, v7
  v_mul_f32 v107, v107, v7
  v_mul_f32 v108, v108, v7
  v_mul_f32 v109, v109, v7
  v_mul_f32 v110, v110, v7
  v_mul_f32 v111, v111, v7
  v_max_f32 v6, v28, v29
  v_max_f32 v7, v30, v31
  v_max_f32 v6, v6, v7
  v_sub_f32 v7, v59, v6
  v_exp_f32 v7, v7
  s_nop 0
  v_mul_f32 v112, v112, v7
  v_mul_f32 v113, v113, v7
  v_mul_f32 v114, v114, v7
  v_mul_f32 v115, v115, v7
  v_mul_f32 v116, v116, v7
  v_mul_f32 v117, v117, v7
  v_mul_f32 v118, v118, v7
  v_mul_f32 v119, v119, v7
  v_mul_f32 v120, v120, v7
  v_mul_f32 v121, v121, v7
  v_mul_f32 v122, v122, v7
  v_mul_f32 v123, v123, v7
  v_mul_f32 v124, v124, v7
  v_mul_f32 v125, v125, v7
  v_mul_f32 v126, v126, v7
  v_mul_f32 v127, v127, v7
  ds_write_b128 v9, v[80:83] offset:0
  ds_write_b128 v9, v[84:87] offset:1024
  ds_write_b128 v9, v[88:91] offset:2048
  ds_write_b128 v9, v[92:95] offset:3072
  ds_write_b128 v10, v[96:99] offset:0
  ds_write_b128 v10, v[100:103] offset:1024
  ds_write_b128 v10, v[104:107] offset:2048
  ds_write_b128 v10, v[108:111] offset:3072
  ds_write_b128 v11, v[112:115] offset:0
  ds_write_b128 v11, v[116:119] offset:1024
  ds_write_b128 v11, v[120:123] offset:2048
  ds_write_b128 v11, v[124:127] offset:3072
  s_branch La_reduce
La_done:
  s_branch Lmain_attnx
Lmain_attn1:
  s_and_b32 s25, s2, 7
  s_lshl_b32 s25, s25, 1
  s_bfe_u32 s26, s2, 0x10003
  s_add_u32 s25, s25, s26
  s_lshr_b32 s26, s2, 4
  s_lshr_b32 s46, s2, 4
  s_min_u32 s46, s46, 13
  s_mul_i32 s46, s46, 114688
  s_mul_i32 s47, s16, 21504
  s_add_u32 s46, s46, s47
  s_add_u32 s46, s46, 0x1c0000
  s_lshr_b32 s54, s2, 5
  s_min_u32 s54, s54, 6
  s_lshr_b32 s55, s16, 1
  s_xor_b32 s55, s55, 0
  s_lshl_b32 s63, s54, 1
  s_add_u32 s55, s55, s63
  s_lshl_b32 s63, s55, 15
  s_lshl_b32 s61, s16, 13
  s_add_u32 s63, s63, s61
  s_add_u32 s40, s63, 0x150000
  s_mul_i32 s55, s55, 114688
  s_mul_i32 s63, s16, 28672
  s_add_u32 s55, s55, s63
  s_add_u32 s52, s55, 0x348000
  s_lshr_b32 s55, s16, 1
  s_xor_b32 s55, s55, 1
  s_lshl_b32 s63, s54, 1
  s_add_u32 s55, s55, s63
  s_lshl_b32 s63, s55, 15
  s_lshl_b32 s61, s16, 13
  s_add_u32 s63, s63, s61
  s_add_u32 s41, s63, 0x150000
  s_mul_i32 s55, s55, 114688
  s_mul_i32 s63, s16, 28672
  s_add_u32 s55, s55, s63
  s_add_u32 s53, s55, 0x348000
  s_mul_i32 s27, s3, 0x2000
  s_add_u32 s27, s27, 0xd00000
  s_lshl_b32 s28, s25, 8
  s_add_u32 s27, s27, s28
  s_lshl_b32 s28, s26, 4
  s_add_u32 s28, s28, s27
  s_add_u32 s27, s27, 0x1000
  s_mul_i32 s29, s3, 0x600000
  s_add_u32 s29, s29, 0xe00000
  s_lshl_b32 s30, s25, 17
  s_add_u32 s29, s29, s30
  s_lshl_b32 s31, s16, 15
  s_add_u32 s31, s31, s29
  s_add_u32 s32, s31, 0x400000
  s_add_u32 s31, s31, 0x200000
  s_xor_b32 s33, s16, 0
  s_lshl_b32 s37, s26, 2
  s_add_u32 s33, s33, s37
  s_lshl_b32 s33, s33, 11
  s_add_u32 s33, s33, s29
  s_xor_b32 s34, s16, 1
  s_lshl_b32 s37, s26, 2
  s_add_u32 s34, s34, s37
  s_lshl_b32 s34, s34, 11
  s_add_u32 s34, s34, s29
  s_xor_b32 s35, s16, 2
  s_lshl_b32 s37, s26, 2
  s_add_u32 s35, s35, s37
  s_lshl_b32 s35, s35, 11
  s_add_u32 s35, s35, s29
  s_xor_b32 s36, s16, 3
  s_lshl_b32 s37, s26, 2
  s_add_u32 s36, s36, s37
  s_lshl_b32 s36, s36, 11
  s_add_u32 s36, s36, s29
  s_xor_b32 s60, s16, 1
  s_mul_i32 s60, s60, 12288
  s_add_u32 s60, s60, 114688
  v_add_u32 v9, s60, v4
  s_xor_b32 s60, s16, 2
  s_mul_i32 s60, s60, 12288
  s_add_u32 s60, s60, 118784
  v_add_u32 v10, s60, v4
  s_xor_b32 s60, s16, 3
  s_mul_i32 s60, s60, 12288
  s_add_u32 s60, s60, 122880
  v_add_u32 v11, s60, v4
  s_mul_i32 s60, s16, 12288
  s_add_u32 s60, s60, 114688
  v_add_u32 v12, s60, v4
  s_mul_i32 s30, s3, 10240
  s_add_u32 s30, s30, 0xd10000
  s_lshl_b32 s63, s25, 7
  s_add_u32 s30, s30, s63
  s_cmp_lg_u32 s16, 0
  s_cbranch_scc1 Lb_woth
  v_min_u32 v6, 15, v1
  v_lshlrev_b32 v6, 2, v6
  v_lshlrev_b32 v7, 3, v1
  s_mov_b32 s49, 0xd18200
  s_mov_b32 s62, 0
Lb_wpoll:
  buffer_load_dword v13, v6, s[8:11], s30 offen sc1
  s_add_u32 s62, s62, 1
  s_cmp_gt_u32 s62, 300000
  s_cbranch_scc1 Lb_woth
  s_waitcnt vmcnt(0)
  v_cmp_ne_u32 vcc, s66, v13
  s_cbranch_vccnz Lb_wpoll
Lb_woth:
  s_waitcnt vmcnt(0)
  s_barrier
  v_lshlrev_b32 v14, 2, v1
  v_and_b32 v15, 12, v14
  buffer_load_dwordx4 a[0:3], v4, s[8:11], s33 offen sc1
  buffer_load_dwordx4 a[4:7], v4, s[8:11], s33 offen offset:1024 sc1
  buffer_load_dwordx4 a[32:35], v4, s[8:11], s31 offen offset:0 sc1
  buffer_load_dwordx4 a[36:39], v4, s[8:11], s31 offen offset:1024 sc1
  buffer_load_dword v6, v14, s[8:11], s27 offen sc1
  buffer_load_dword v7, v15, s[8:11], s28 offen sc1
  buffer_load_dwordx4 a[8:11], v4, s[8:11], s34 offen sc1
  buffer_load_dwordx4 a[12:15], v4, s[8:11], s34 offen offset:1024 sc1
  buffer_load_dwordx4 a[40:43], v4, s[8:11], s32 offen offset:0 sc1
  buffer_load_dwordx4 a[44:47], v4, s[8:11], s32 offen offset:1024 sc1
  s_waitcnt vmcnt(4)
  s_nop 0
  v_max_f32_dpp v6, v6, v6 row_ror:8 row_mask:0xf bank_mask:0xf
  v_max_f32_dpp v7, v7, v7 row_ror:8 row_mask:0xf bank_mask:0xf
  s_nop 0
  v_max_f32_dpp v6, v6, v6 row_ror:4 row_mask:0xf bank_mask:0xf
  v_max_f32_dpp v7, v7, v7 row_ror:4 row_mask:0xf bank_mask:0xf
  s_nop 0
  v_max_f32_dpp v6, v6, v6 row_ror:2 row_mask:0xf bank_mask:0xf
  v_max_f32_dpp v7, v7, v7 row_ror:2 row_mask:0xf bank_mask:0xf
  s_nop 0
  v_max_f32_dpp v6, v6, v6 row_ror:1 row_mask:0xf bank_mask:0xf
  v_max_f32_dpp v7, v7, v7 row_ror:1 row_mask:0xf bank_mask:0xf
  s_nop 1
  v_readlane_b32 s42, v6, 0
  v_readlane_b32 s43, v6, 16
  v_readlane_b32 s44, v6, 32
  v_readlane_b32 s45, v6, 48
  v_readlane_b32 s48, v7, 0
  v_mfma_f32_32x32x16_bf16 v[16:31], a[32:35], a[0:3], 0
  v_mfma_f32_32x32x16_bf16 v[16:31], a[36:39], a[4:7], v[16:31]
  s_max_u32 s42, s42, s43
  s_max_u32 s44, s44, s45
  s_max_u32 s42, s42, s44
  v_mov_b32 v6, s42
  v_mul_f32 v6, s48, v6
  v_mov_b32 v7, 0x45800000
  v_cmp_le_f32 vcc, v6, v7
  s_nop 4
  s_cbranch_vccz Lb_slow
  s_nop 2
  s_waitcnt vmcnt(2)
  v_mfma_f32_32x32x16_bf16 v[32:47], a[32:35], a[8:11], 0
  buffer_load_dwordx4 a[16:19], v4, s[8:11], s35 offen sc1
  buffer_load_dwordx4 a[20:23], v4, s[8:11], s35 offen offset:1024 sc1
  v_exp_f32 v16, v16
  v_exp_f32 v17, v17
  v_exp_f32 v18, v18
  v_exp_f32 v19, v19
  v_exp_f32 v20, v20
  v_exp_f32 v21, v21
  v_exp_f32 v22, v22
  v_exp_f32 v23, v23
  v_cvt_pk_bf16_f32 v48, v16, v17
  v_cvt_pk_bf16_f32 v49, v18, v19
  v_mfma_f32_32x32x16_bf16 v[32:47], a[36:39], a[12:15], v[32:47]
  buffer_load_dwordx4 a[24:27], v4, s[8:11], s36 offen sc1
  buffer_load_dwordx4 a[28:31], v4, s[8:11], s36 offen offset:1024 sc1
  v_exp_f32 v24, v24
  v_exp_f32 v25, v25
  v_exp_f32 v26, v26
  v_exp_f32 v27, v27
  v_cvt_pk_bf16_f32 v50, v20, v21
  v_cvt_pk_bf16_f32 v51, v22, v23
  v_exp_f32 v28, v28
  v_exp_f32 v29, v29
  v_exp_f32 v30, v30
  v_exp_f32 v31, v31
  v_cvt_pk_bf16_f32 v52, v24, v25
  v_cvt_pk_bf16_f32 v53, v26, v27
  v_cvt_pk_bf16_f32 v54, v28, v29
  v_cvt_pk_bf16_f32 v55, v30, v31
  s_waitcnt vmcnt(2)
  s_waitcnt vmcnt(4)
  v_mfma_f32_32x32x16_bf16 v[16:31], a[32:35], a[16:19], 0
  buffer_load_dwordx4 a[48:51], v4, s[8:11], s31 offen offset:2048 sc1
  buffer_load_dwordx4 a[52:55], v4, s[8:11], s31 offen offset:3072 sc1
  buffer_load_dwordx4 a[56:59], v4, s[8:11], s32 offen offset:2048 sc1
  buffer_load_dwordx4 a[60:63], v4, s[8:11], s32 offen offset:3072 sc1
  s_add_u32 s31, s31, 4096
  s_add_u32 s32, s32, 4096
  v_exp_f32 v32, v32
  v_exp_f32 v33, v33
  v_exp_f32 v34, v34
  v_exp_f32 v35, v35
  v_mfma_f32_32x32x16_bf16 v[64:79], a[40:43], v[48:51], 0
  v_exp_f32 v36, v36
  v_exp_f32 v37, v37
  v_exp_f32 v38, v38
  v_exp_f32 v39, v39
  v_cvt_pk_bf16_f32 v56, v32, v33
  v_cvt_pk_bf16_f32 v57, v34, v35
  v_mfma_f32_32x32x16_bf16 v[16:31], a[36:39], a[20:23], v[16:31]
  buffer_load_dwordx4 a[64:67], v4, s[8:11], s31 offen offset:0 sc1
  buffer_load_dwordx4 a[68:71], v4, s[8:11], s31 offen offset:1024 sc1
  buffer_load_dwordx4 a[72:75], v4, s[8:11], s32 offen offset:0 sc1
  buffer_load_dwordx4 a[76:79], v4, s[8:11], s32 offen offset:1024 sc1
  v_exp_f32 v40, v40
  v_exp_f32 v41, v41
  v_exp_f32 v42, v42
  v_exp_f32 v43, v43
  v_cvt_pk_bf16_f32 v58, v36, v37
  v_cvt_pk_bf16_f32 v59, v38, v39
  v_mfma_f32_32x32x16_bf16 v[64:79], a[44:47], v[52:55], v[64:79]
  v_exp_f32 v44, v44
  v_exp_f32 v45, v45
  v_exp_f32 v46, v46
  v_exp_f32 v47, v47
  v_cvt_pk_bf16_f32 v60, v40, v41
  v_cvt_pk_bf16_f32 v61, v42, v43
  v_cvt_pk_bf16_f32 v62, v44, v45
  v_cvt_pk_bf16_f32 v63, v46, v47
  s_waitcnt vmcnt(8)
  v_mfma_f32_32x32x16_bf16 v[32:47], a[32:35], a[24:27], 0
  v_exp_f32 v16, v16
  v_exp_f32 v17, v17
  v_exp_f32 v18, v18
  v_exp_f32 v19, v19
  v_mfma_f32_32x32x16_bf16 v[80:95], a[40:43], v[56:59], 0
  v_exp_f32 v20, v20
  v_exp_f32 v21, v21
  v_exp_f32 v22, v22
  v_exp_f32 v23, v23
  v_cvt_pk_bf16_f32 v48, v16, v17
  v_cvt_pk_bf16_f32 v49, v18, v19
  v_mfma_f32_32x32x16_bf16 v[32:47], a[36:39], a[28:31], v[32:47]
  v_exp_f32 v24, v24
  v_exp_f32 v25, v25
  v_exp_f32 v26, v26
  v_exp_f32 v27, v27
  v_cvt_pk_bf16_f32 v50, v20, v21
  v_cvt_pk_bf16_f32 v51, v22, v23
  v_mfma_f32_32x32x16_bf16 v[80:95], a[44:47], v[60:63], v[80:95]
  buffer_load_dwordx4 a[80:83], v4, s[8:11], s31 offen offset:2048 sc1
  buffer_load_dwordx4 a[84:87], v4, s[8:11], s31 offen offset:3072 sc1
  buffer_load_dwordx4 a[88:91], v4, s[8:11], s32 offen offset:2048 sc1
  buffer_load_dwordx4 a[92:95], v4, s[8:11], s32 offen offset:3072 sc1
  s_add_u32 s31, s31, 4096
  s_add_u32 s32, s32, 4096
  v_exp_f32 v28, v28
  v_exp_f32 v29, v29
  v_exp_f32 v30, v30
  v_exp_f32 v31, v31
  v_cvt_pk_bf16_f32 v52, v24, v25
  v_cvt_pk_bf16_f32 v53, v26, v27
  v_cvt_pk_bf16_f32 v54, v28, v29
  v_cvt_pk_bf16_f32 v55, v30, v31
  s_waitcnt vmcnt(10)
  v_mfma_f32_32x32x16_bf16 v[16:31], a[48:51], a[0:3], 0
  v_exp_f32 v32, v32
  v_exp_f32 v33, v33
  v_exp_f32 v34, v34
  v_exp_f32 v35, v35
  v_mfma_f32_32x32x16_bf16 v[96:111], a[40:43], v[48:51], 0
  v_exp_f32 v36, v36
  v_exp_f32 v37, v37
  v_exp_f32 v38, v38
  v_exp_f32 v39, v39
  v_cvt_pk_bf16_f32 v56, v32, v33
  v_cvt_pk_bf16_f32 v57, v34, v35
  v_mfma_f32_32x32x16_bf16 v[16:31], a[52:55], a[4:7], v[16:31]
  v_exp_f32 v40, v40
  v_exp_f32 v41, v41
  v_exp_f32 v42, v42
  v_exp_f32 v43, v43
  v_cvt_pk_bf16_f32 v58, v36, v37
  v_cvt_pk_bf16_f32 v59, v38, v39
  v_mfma_f32_32x32x16_bf16 v[96:111], a[44:47], v[52:55], v[96:111]
  v_exp_f32 v44, v44
  v_exp_f32 v45, v45
  v_exp_f32 v46, v46
  v_exp_f32 v47, v47
  v_cvt_pk_bf16_f32 v60, v40, v41
  v_cvt_pk_bf16_f32 v61, v42, v43
  v_cvt_pk_bf16_f32 v62, v44, v45
  v_cvt_pk_bf16_f32 v63, v46, v47
  v_mfma_f32_32x32x16_bf16 v[32:47], a[48:51], a[8:11], 0
  v_exp_f32 v16, v16
  v_exp_f32 v17, v17
  v_exp_f32 v18, v18
  v_exp_f32 v19, v19
  v_mfma_f32_32x32x16_bf16 v[112:127], a[40:43], v[56:59], 0
  v_exp_f32 v20, v20
  v_exp_f32 v21, v21
  v_exp_f32 v22, v22
  v_exp_f32 v23, v23
  v_cvt_pk_bf16_f32 v48, v16, v17
  v_cvt_pk_bf16_f32 v49, v18, v19
  v_mfma_f32_32x32x16_bf16 v[32:47], a[52:55], a[12:15], v[32:47]
  v_exp_f32 v24, v24
  v_exp_f32 v25, v25
  v_exp_f32 v26, v26
  v_exp_f32 v27, v27
  v_cvt_pk_bf16_f32 v50, v20, v21
  v_cvt_pk_bf16_f32 v51, v22, v23
  v_mfma_f32_32x32x16_bf16 v[112:127], a[44:47], v[60:63], v[112:127]
  buffer_load_dwordx4 a[32:35], v4, s[8:11], s31 offen offset:0 sc1
  buffer_load_dwordx4 a[36:39], v4, s[8:11], s31 offen offset:1024 sc1
  buffer_load_dwordx4 a[40:43], v4, s[8:11], s32 offen offset:0 sc1
  buffer_load_dwordx4 a[44:47], v4, s[8:11], s32 offen offset:1024 sc1
  v_exp_f32 v28, v28
  v_exp_f32 v29, v29
  v_exp_f32 v30, v30
  v_exp_f32 v31, v31
  v_cvt_pk_bf16_f32 v52, v24, v25
  v_cvt_pk_bf16_f32 v53, v26, v27
  v_cvt_pk_bf16_f32 v54, v28, v29
  v_cvt_pk_bf16_f32 v55, v30, v31
  s_waitcnt vmcnt(12)
  v_mfma_f32_32x32x16_bf16 v[16:31], a[48:51], a[16:19], 0
  v_exp_f32 v32, v32
  v_exp_f32 v33, v33
  v_exp_f32 v34, v34
  v_exp_f32 v35, v35
  v_mfma_f32_32x32x16_bf16 v[64:79], a[56:59], v[48:51], v[64:79]
  s_mov_b32 m0, s47
  s_add_u32 s47, s47, 4096
  buffer_load_dwordx4 v4, s[8:11], s46 offen offset:0 lds
  v_exp_f32 v36, v36
  v_exp_f32 v37, v37
  v_exp_f32 v38, v38
  v_exp_f32 v39, v39
  v_cvt_pk_bf16_f32 v56, v32, v33
  v_cvt_pk_bf16_f32 v57, v34, v35
  v_mfma_f32_32x32x16_bf16 v[16:31], a[52:55], a[20:23], v[16:31]
  v_exp_f32 v40, v40
  v_exp_f32 v41, v41
  v_exp_f32 v42, v42
  v_exp_f32 v43, v43
  v_cvt_pk_bf16_f32 v58, v36, v37
  v_cvt_pk_bf16_f32 v59, v38, v39
  v_mfma_f32_32x32x16_bf16 v[64:79], a[60:63], v[52:55], v[64:79]
  v_exp_f32 v44, v44
  v_exp_f32 v45, v45
  v_exp_f32 v46, v46
  v_exp_f32 v47, v47
  v_cvt_pk_bf16_f32 v60, v40, v41
  v_cvt_pk_bf16_f32 v61, v42, v43
  v_cvt_pk_bf16_f32 v62, v44, v45
  v_cvt_pk_bf16_f32 v63, v46, v47
  v_mfma_f32_32x32x16_bf16 v[32:47], a[48:51], a[24:27], 0
  v_exp_f32 v16, v16
  v_exp_f32 v17, v17
  v_exp_f32 v18, v18
  v_exp_f32 v19, v19
  v_mfma_f32_32x32x16_bf16 v[80:95], a[56:59], v[56:59], v[80:95]
  buffer_load_dwordx4 v[192:195], v4, s[8:11], s40 offen offset:0
  v_exp_f32 v20, v20
  v_exp_f32 v21, v21
  v_exp_f32 v22, v22
  v_exp_f32 v23, v23
  v_cvt_pk_bf16_f32 v48, v16, v17
  v_cvt_pk_bf16_f32 v49, v18, v19
  v_mfma_f32_32x32x16_bf16 v[32:47], a[52:55], a[28:31], v[32:47]
  v_exp_f32 v24, v24
  v_exp_f32 v25, v25
  v_exp_f32 v26, v26
  v_exp_f32 v27, v27
  v_cvt_pk_bf16_f32 v50, v20, v21
  v_cvt_pk_bf16_f32 v51, v22, v23
  v_mfma_f32_32x32x16_bf16 v[80:95], a[60:63], v[60:63], v[80:95]
  v_exp_f32 v28, v28
  v_exp_f32 v29, v29
  v_exp_f32 v30, v30
  v_exp_f32 v31, v31
  v_cvt_pk_bf16_f32 v52, v24, v25
  v_cvt_pk_bf16_f32 v53, v26, v27
  v_cvt_pk_bf16_f32 v54, v28, v29
  v_cvt_pk_bf16_f32 v55, v30, v31
  s_waitcnt vmcnt(12)
  v_mfma_f32_32x32x16_bf16 v[16:31], a[64:67], a[0:3], 0
  v_exp_f32 v32, v32
  v_exp_f32 v33, v33
  v_exp_f32 v34, v34
  v_exp_f32 v35, v35
  v_mfma_f32_32x32x16_bf16 v[96:111], a[56:59], v[48:51], v[96:111]
  v_exp_f32 v36, v36
  v_exp_f32 v37, v37
  v_exp_f32 v38, v38
  v_exp_f32 v39, v39
  v_cvt_pk_bf16_f32 v56, v32, v33
  v_cvt_pk_bf16_f32 v57, v34, v35
  v_mfma_f32_32x32x16_bf16 v[16:31], a[68:71], a[4:7], v[16:31]
  v_exp_f32 v40, v40
  v_exp_f32 v41, v41
  v_exp_f32 v42, v42
  v_exp_f32 v43, v43
  v_cvt_pk_bf16_f32 v58, v36, v37
  v_cvt_pk_bf16_f32 v59, v38, v39
  v_mfma_f32_32x32x16_bf16 v[96:111], a[60:63], v[52:55], v[96:111]
  buffer_load_dwordx4 v4, s[8:11], s46 offen offset:1024 lds
  v_exp_f32 v44, v44
  v_exp_f32 v45, v45
  v_exp_f32 v46, v46
  v_exp_f32 v47, v47
  v_cvt_pk_bf16_f32 v60, v40, v41
  v_cvt_pk_bf16_f32 v61, v42, v43
  v_cvt_pk_bf16_f32 v62, v44, v45
  v_cvt_pk_bf16_f32 v63, v46, v47
  v_mfma_f32_32x32x16_bf16 v[32:47], a[64:67], a[8:11], 0
  v_exp_f32 v16, v16
  v_exp_f32 v17, v17
  v_exp_f32 v18, v18
  v_exp_f32 v19, v19
  v_mfma_f32_32x32x16_bf16 v[112:127], a[56:59], v[56:59], v[112:127]
  v_exp_f32 v20, v20
  v_exp_f32 v21, v21
  v_exp_f32 v22, v22
  v_exp_f32 v23, v23
  v_cvt_pk_bf16_f32 v48, v16, v17
  v_cvt_pk_bf16_f32 v49, v18, v19
  v_mfma_f32_32x32x16_bf16 v[32:47], a[68:71], a[12:15], v[32:47]
  v_exp_f32 v24, v24
  v_exp_f32 v25, v25
  v_exp_f32 v26, v26
  v_exp_f32 v27, v27
  v_cvt_pk_bf16_f32 v50, v20, v21
  v_cvt_pk_bf16_f32 v51, v22, v23
  v_mfma_f32_32x32x16_bf16 v[112:127], a[60:63], v[60:63], v[112:127]
  buffer_load_dwordx4 a[48:51], v4, s[8:11], s31 offen offset:2048 sc1
  buffer_load_dwordx4 a[52:55], v4, s[8:11], s31 offen offset:3072 sc1
  buffer_load_dwordx4 a[56:59], v4, s[8:11], s32 offen offset:2048 sc1
  buffer_load_dwordx4 a[60:63], v4, s[8:11], s32 offen offset:3072 sc1
  s_add_u32 s31, s31, 4096
  s_add_u32 s32, s32, 4096
  v_exp_f32 v28, v28
  v_exp_f32 v29, v29
  v_exp_f32 v30, v30
  v_exp_f32 v31, v31
  v_cvt_pk_bf16_f32 v52, v24, v25
  v_cvt_pk_bf16_f32 v53, v26, v27
  v_cvt_pk_bf16_f32 v54, v28, v29
  v_cvt_pk_bf16_f32 v55, v30, v31
  s_waitcnt vmcnt(15)
  v_mfma_f32_32x32x16_bf16 v[16:31], a[64:67], a[16:19], 0
  v_exp_f32 v32, v32
  v_exp_f32 v33, v33
  v_exp_f32 v34, v34
  v_exp_f32 v35, v35
  v_mfma_f32_32x32x16_bf16 v[64:79], a[72:75], v[48:51], v[64:79]
  buffer_load_dwordx4 v[224:227], v4, s[8:11], s41 offen offset:0
  v_exp_f32 v36, v36
  v_exp_f32 v37, v37
  v_exp_f32 v38, v38
  v_exp_f32 v39, v39
  v_cvt_pk_bf16_f32 v56, v32, v33
  v_cvt_pk_bf16_f32 v57, v34, v35
  v_mfma_f32_32x32x16_bf16 v[16:31], a[68:71], a[20:23], v[16:31]
  v_exp_f32 v40, v40
  v_exp_f32 v41, v41
  v_exp_f32 v42, v42
  v_exp_f32 v43, v43
  v_cvt_pk_bf16_f32 v58, v36, v37
  v_cvt_pk_bf16_f32 v59, v38, v39
  v_mfma_f32_32x32x16_bf16 v[64:79], a[76:79], v[52:55], v[64:79]
  v_exp_f32 v44, v44
  v_exp_f32 v45, v45
  v_exp_f32 v46, v46
  v_exp_f32 v47, v47
  v_cvt_pk_bf16_f32 v60, v40, v41
  v_cvt_pk_bf16_f32 v61, v42, v43
  v_cvt_pk_bf16_f32 v62, v44, v45
  v_cvt_pk_bf16_f32 v63, v46, v47
  v_mfma_f32_32x32x16_bf16 v[32:47], a[64:67], a[24:27], 0
  v_exp_f32 v16, v16
  v_exp_f32 v17, v17
  v_exp_f32 v18, v18
  v_exp_f32 v19, v19
  v_mfma_f32_32x32x16_bf16 v[80:95], a[72:75], v[56:59], v[80:95]
  v_exp_f32 v20, v20
  v_exp_f32 v21, v21
  v_exp_f32 v22, v22
  v_exp_f32 v23, v23
  v_cvt_pk_bf16_f32 v48, v16, v17
  v_cvt_pk_bf16_f32 v49, v18, v19
  v_mfma_f32_32x32x16_bf16 v[32:47], a[68:71], a[28:31], v[32:47]
  v_exp_f32 v24, v24
  v_exp_f32 v25, v25
  v_exp_f32 v26, v26
  v_exp_f32 v27, v27
  v_cvt_pk_bf16_f32 v50, v20, v21
  v_cvt_pk_bf16_f32 v51, v22, v23
  v_mfma_f32_32x32x16_bf16 v[80:95], a[76:79], v[60:63], v[80:95]
  buffer_load_dwordx4 v4, s[8:11], s46 offen offset:2048 lds
  v_exp_f32 v28, v28
  v_exp_f32 v29, v29
  v_exp_f32 v30, v30
  v_exp_f32 v31, v31
  v_cvt_pk_bf16_f32 v52, v24, v25
  v_cvt_pk_bf16_f32 v53, v26, v27
  v_cvt_pk_bf16_f32 v54, v28, v29
  v_cvt_pk_bf16_f32 v55, v30, v31
  s_waitcnt vmcnt(15)
  v_mfma_f32_32x32x16_bf16 v[16:31], a[80:83], a[0:3], 0
  v_exp_f32 v32, v32
  v_exp_f32 v33, v33
  v_exp_f32 v34, v34
  v_exp_f32 v35, v35
  v_mfma_f32_32x32x16_bf16 v[96:111], a[72:75], v[48:51], v[96:111]
  v_exp_f32 v36, v36
  v_exp_f32 v37, v37
  v_exp_f32 v38, v38
  v_exp_f32 v39, v39
  v_cvt_pk_bf16_f32 v56, v32, v33
  v_cvt_pk_bf16_f32 v57, v34, v35
  v_mfma_f32_32x32x16_bf16 v[16:31], a[84:87], a[4:7], v[16:31]
  v_exp_f32 v40, v40
  v_exp_f32 v41, v41
  v_exp_f32 v42, v42
  v_exp_f32 v43, v43
  v_cvt_pk_bf16_f32 v58, v36, v37
  v_cvt_pk_bf16_f32 v59, v38, v39
  v_mfma_f32_32x32x16_bf16 v[96:111], a[76:79], v[52:55], v[96:111]
  v_exp_f32 v44, v44
  v_exp_f32 v45, v45
  v_exp_f32 v46, v46
  v_exp_f32 v47, v47
  v_cvt_pk_bf16_f32 v60, v40, v41
  v_cvt_pk_bf16_f32 v61, v42, v43
  v_cvt_pk_bf16_f32 v62, v44, v45
  v_cvt_pk_bf16_f32 v63, v46, v47
  v_mfma_f32_32x32x16_bf16 v[32:47], a[80:83], a[8:11], 0
  v_exp_f32 v16, v16
  v_exp_f32 v17, v17
  v_exp_f32 v18, v18
  v_exp_f32 v19, v19
  v_mfma_f32_32x32x16_bf16 v[112:127], a[72:75], v[56:59], v[112:127]
  buffer_load_dwordx4 v[196:199], v4, s[8:11], s40 offen offset:1024
  v_exp_f32 v20, v20
  v_exp_f32 v21, v21
  v_exp_f32 v22, v22
  v_exp_f32 v23, v23
  v_cvt_pk_bf16_f32 v48, v16, v17
  v_cvt_pk_bf16_f32 v49, v18, v19
  v_mfma_f32_32x32x16_bf16 v[32:47], a[84:87], a[12:15], v[32:47]
  v_exp_f32 v24, v24
  v_exp_f32 v25, v25
  v_exp_f32 v26, v26
  v_exp_f32 v27, v27
  v_cvt_pk_bf16_f32 v50, v20, v21
  v_cvt_pk_bf16_f32 v51, v22, v23
  v_mfma_f32_32x32x16_bf16 v[112:127], a[76:79], v[60:63], v[112:127]
  buffer_load_dwordx4 a[64:67], v4, s[8:11], s31 offen offset:0 sc1
  buffer_load_dwordx4 a[68:71], v4, s[8:11], s31 offen offset:1024 sc1
  buffer_load_dwordx4 a[72:75], v4, s[8:11], s32 offen offset:0 sc1
  buffer_load_dwordx4 a[76:79], v4, s[8:11], s32 offen offset:1024 sc1
  v_exp_f32 v28, v28
  v_exp_f32 v29, v29
  v_exp_f32 v30, v30
  v_exp_f32 v31, v31
  v_cvt_pk_bf16_f32 v52, v24, v25
  v_cvt_pk_bf16_f32 v53, v26, v27
  v_cvt_pk_bf16_f32 v54, v28, v29
  v_cvt_pk_bf16_f32 v55, v30, v31
  s_waitcnt vmcnt(18)
  v_mfma_f32_32x32x16_bf16 v[16:31], a[80:83], a[16:19], 0
  v_exp_f32 v32, v32
  v_exp_f32 v33, v33
  v_exp_f32 v34, v34
  v_exp_f32 v35, v35
  v_mfma_f32_32x32x16_bf16 v[64:79], a[88:91], v[48:51], v[64:79]
  v_exp_f32 v36, v36
  v_exp_f32 v37, v37
  v_exp_f32 v38, v38
  v_exp_f32 v39, v39
  v_cvt_pk_bf16_f32 v56, v32, v33
  v_cvt_pk_bf16_f32 v57, v34, v35
  v_mfma_f32_32x32x16_bf16 v[16:31], a[84:87], a[20:23], v[16:31]
  v_exp_f32 v40, v40
  v_exp_f32 v41, v41
  v_exp_f32 v42, v42
  v_exp_f32 v43, v43
  v_cvt_pk_bf16_f32 v58, v36, v37
  v_cvt_pk_bf16_f32 v59, v38, v39
  v_mfma_f32_32x32x16_bf16 v[64:79], a[92:95], v[52:55], v[64:79]
  buffer_load_dwordx4 v4, s[8:11], s46 offen offset:3072 lds
  s_add_u32 s46, s46, 4096
  v_exp_f32 v44, v44
  v_exp_f32 v45, v45
  v_exp_f32 v46, v46
  v_exp_f32 v47, v47
  v_cvt_pk_bf16_f32 v60, v40, v41
  v_cvt_pk_bf16_f32 v61, v42, v43
  v_cvt_pk_bf16_f32 v62, v44, v45
  v_cvt_pk_bf16_f32 v63, v46, v47
  v_mfma_f32_32x32x16_bf16 v[32:47], a[80:83], a[24:27], 0
  v_exp_f32 v16, v16
  v_exp_f32 v17, v17
  v_exp_f32 v18, v18
  v_exp_f32 v19, v19
  v_mfma_f32_32x32x16_bf16 v[80:95], a[88:91], v[56:59], v[80:95]
  v_exp_f32 v20, v20
  v_exp_f32 v21, v21
  v_exp_f32 v22, v22
  v_exp_f32 v23, v23
  v_cvt_pk_bf16_f32 v48, v16, v17
  v_cvt_pk_bf16_f32 v49, v18, v19
  v_mfma_f32_32x32x16_bf16 v[32:47], a[84:87], a[28:31], v[32:47]
  v_exp_f32 v24, v24
  v_exp_f32 v25, v25
  v_exp_f32 v26, v26
  v_exp_f32 v27, v27
  v_cvt_pk_bf16_f32 v50, v20, v21
  v_cvt_pk_bf16_f32 v51, v22, v23
  v_mfma_f32_32x32x16_bf16 v[80:95], a[92:95], v[60:63], v[80:95]
  v_exp_f32 v28, v28
  v_exp_f32 v29, v29
  v_exp_f32 v30, v30
  v_exp_f32 v31, v31
  v_cvt_pk_bf16_f32 v52, v24, v25
  v_cvt_pk_bf16_f32 v53, v26, v27
  v_cvt_pk_bf16_f32 v54, v28, v29
  v_cvt_pk_bf16_f32 v55, v30, v31
  s_waitcnt vmcnt(17)
  v_mfma_f32_32x32x16_bf16 v[16:31], a[32:35], a[0:3], 0
  v_exp_f32 v32, v32
  v_exp_f32 v33, v33
  v_exp_f32 v34, v34
  v_exp_f32 v35, v35
  v_mfma_f32_32x32x16_bf16 v[96:111], a[88:91], v[48:51], v[96:111]
  v_exp_f32 v36, v36
  v_exp_f32 v37, v37
  v_exp_f32 v38, v38
  v_exp_f32 v39, v39
  v_cvt_pk_bf16_f32 v56, v32, v33
  v_cvt_pk_bf16_f32 v57, v34, v35
  v_mfma_f32_32x32x16_bf16 v[16:31], a[36:39], a[4:7], v[16:31]
  v_exp_f32 v40, v40
  v_exp_f32 v41, v41
  v_exp_f32 v42, v42
  v_exp_f32 v43, v43
  v_cvt_pk_bf16_f32 v58, v36, v37
  v_cvt_pk_bf16_f32 v59, v38, v39
  v_mfma_f32_32x32x16_bf16 v[96:111], a[92:95], v[52:55], v[96:111]
  s_mov_b32 m0, s47
  s_add_u32 s47, s47, 4096
  buffer_load_dwordx4 v4, s[8:11], s46 offen offset:0 lds
  v_exp_f32 v44, v44
  v_exp_f32 v45, v45
  v_exp_f32 v46, v46
  v_exp_f32 v47, v47
  v_cvt_pk_bf16_f32 v60, v40, v41
  v_cvt_pk_bf16_f32 v61, v42, v43
  v_cvt_pk_bf16_f32 v62, v44, v45
  v_cvt_pk_bf16_f32 v63, v46, v47
  v_mfma_f32_32x32x16_bf16 v[32:47], a[32:35], a[8:11], 0
  v_exp_f32 v16, v16
  v_exp_f32 v17, v17
  v_exp_f32 v18, v18
  v_exp_f32 v19, v19
  v_mfma_f32_32x32x16_bf16 v[112:127], a[88:91], v[56:59], v[112:127]
  v_exp_f32 v20, v20
  v_exp_f32 v21, v21
  v_exp_f32 v22, v22
  v_exp_f32 v23, v23
  v_cvt_pk_bf16_f32 v48, v16, v17
  v_cvt_pk_bf16_f32 v49, v18, v19
  v_mfma_f32_32x32x16_bf16 v[32:47], a[36:39], a[12:15], v[32:47]
  v_exp_f32 v24, v24
  v_exp_f32 v25, v25
  v_exp_f32 v26, v26
  v_exp_f32 v27, v27
  v_cvt_pk_bf16_f32 v50, v20, v21
  v_cvt_pk_bf16_f32 v51, v22, v23
  v_mfma_f32_32x32x16_bf16 v[112:127], a[92:95], v[60:63], v[112:127]
  buffer_load_dwordx4 a[80:83], v4, s[8:11], s31 offen offset:2048 sc1
  buffer_load_dwordx4 a[84:87], v4, s[8:11], s31 offen offset:3072 sc1
  buffer_load_dwordx4 a[88:91], v4, s[8:11], s32 offen offset:2048 sc1
  buffer_load_dwordx4 a[92:95], v4, s[8:11], s32 offen offset:3072 sc1
  s_add_u32 s31, s31, 4096
  s_add_u32 s32, s32, 4096
  v_exp_f32 v28, v28
  v_exp_f32 v29, v29
  v_exp_f32 v30, v30
  v_exp_f32 v31, v31
  v_cvt_pk_bf16_f32 v52, v24, v25
  v_cvt_pk_bf16_f32 v53, v26, v27
  v_cvt_pk_bf16_f32 v54, v28, v29
  v_cvt_pk_bf16_f32 v55, v30, v31
  s_waitcnt vmcnt(20)
  v_mfma_f32_32x32x16_bf16 v[16:31], a[32:35], a[16:19], 0
  v_exp_f32 v32, v32
  v_exp_f32 v33, v33
  v_exp_f32 v34, v34
  v_exp_f32 v35, v35
  v_mfma_f32_32x32x16_bf16 v[64:79], a[40:43], v[48:51], v[64:79]
  buffer_load_dwordx4 v[228:231], v4, s[8:11], s41 offen offset:1024
  v_exp_f32 v36, v36
  v_exp_f32 v37, v37
  v_exp_f32 v38, v38
  v_exp_f32 v39, v39
  v_cvt_pk_bf16_f32 v56, v32, v33
  v_cvt_pk_bf16_f32 v57, v34, v35
  v_mfma_f32_32x32x16_bf16 v[16:31], a[36:39], a[20:23], v[16:31]
  v_exp_f32 v40, v40
  v_exp_f32 v41, v41
  v_exp_f32 v42, v42
  v_exp_f32 v43, v43
  v_cvt_pk_bf16_f32 v58, v36, v37
  v_cvt_pk_bf16_f32 v59, v38, v39
  v_mfma_f32_32x32x16_bf16 v[64:79], a[44:47], v[52:55], v[64:79]
  v_exp_f32 v44, v44
  v_exp_f32 v45, v45
  v_exp_f32 v46, v46
  v_exp_f32 v47, v47
  v_cvt_pk_bf16_f32 v60, v40, v41
  v_cvt_pk_bf16_f32 v61, v42, v43
  v_cvt_pk_bf16_f32 v62, v44, v45
  v_cvt_pk_bf16_f32 v63, v46, v47
  v_mfma_f32_32x32x16_bf16 v[32:47], a[32:35], a[24:27], 0
  v_exp_f32 v16, v16
  v_exp_f32 v17, v17
  v_exp_f32 v18, v18
  v_exp_f32 v19, v19
  v_mfma_f32_32x32x16_bf16 v[80:95], a[40:43], v[56:59], v[80:95]
  v_exp_f32 v20, v20
  v_exp_f32 v21, v21
  v_exp_f32 v22, v22
  v_exp_f32 v23, v23
  v_cvt_pk_bf16_f32 v48, v16, v17
  v_cvt_pk_bf16_f32 v49, v18, v19
  v_mfma_f32_32x32x16_bf16 v[32:47], a[36:39], a[28:31], v[32:47]
  v_exp_f32 v24, v24
  v_exp_f32 v25, v25
  v_exp_f32 v26, v26
  v_exp_f32 v27, v27
  v_cvt_pk_bf16_f32 v50, v20, v21
  v_cvt_pk_bf16_f32 v51, v22, v23
  v_mfma_f32_32x32x16_bf16 v[80:95], a[44:47], v[60:63], v[80:95]
  buffer_load_dwordx4 v4, s[8:11], s46 offen offset:1024 lds
  v_exp_f32 v28, v28
  v_exp_f32 v29, v29
  v_exp_f32 v30, v30
  v_exp_f32 v31, v31
  v_cvt_pk_bf16_f32 v52, v24, v25
  v_cvt_pk_bf16_f32 v53, v26, v27
  v_cvt_pk_bf16_f32 v54, v28, v29
  v_cvt_pk_bf16_f32 v55, v30, v31
  s_waitcnt vmcnt(17)
  v_mfma_f32_32x32x16_bf16 v[16:31], a[48:51], a[0:3], 0
  v_exp_f32 v32, v32
  v_exp_f32 v33, v33
  v_exp_f32 v34, v34
  v_exp_f32 v35, v35
  v_mfma_f32_32x32x16_bf16 v[96:111], a[40:43], v[48:51], v[96:111]
  v_exp_f32 v36, v36
  v_exp_f32 v37, v37
  v_exp_f32 v38, v38
  v_exp_f32 v39, v39
  v_cvt_pk_bf16_f32 v56, v32, v33
  v_cvt_pk_bf16_f32 v57, v34, v35
  v_mfma_f32_32x32x16_bf16 v[16:31], a[52:55], a[4:7], v[16:31]
  v_exp_f32 v40, v40
  v_exp_f32 v41, v41
  v_exp_f32 v42, v42
  v_exp_f32 v43, v43
  v_cvt_pk_bf16_f32 v58, v36, v37
  v_cvt_pk_bf16_f32 v59, v38, v39
  v_mfma_f32_32x32x16_bf16 v[96:111], a[44:47], v[52:55], v[96:111]
  v_exp_f32 v44, v44
  v_exp_f32 v45, v45
  v_exp_f32 v46, v46
  v_exp_f32 v47, v47
  v_cvt_pk_bf16_f32 v60, v40, v41
  v_cvt_pk_bf16_f32 v61, v42, v43
  v_cvt_pk_bf16_f32 v62, v44, v45
  v_cvt_pk_bf16_f32 v63, v46, v47
  v_mfma_f32_32x32x16_bf16 v[32:47], a[48:51], a[8:11], 0
  v_exp_f32 v16, v16
  v_exp_f32 v17, v17
  v_exp_f32 v18, v18
  v_exp_f32 v19, v19
  v_mfma_f32_32x32x16_bf16 v[112:127], a[40:43], v[56:59], v[112:127]
  buffer_load_dwordx4 v[200:203], v4, s[8:11], s40 offen offset:2048
  v_exp_f32 v20, v20
  v_exp_f32 v21, v21
  v_exp_f32 v22, v22
  v_exp_f32 v23, v23
  v_cvt_pk_bf16_f32 v48, v16, v17
  v_cvt_pk_bf16_f32 v49, v18, v19
  v_mfma_f32_32x32x16_bf16 v[32:47], a[52:55], a[12:15], v[32:47]
  v_exp_f32 v24, v24
  v_exp_f32 v25, v25
  v_exp_f32 v26, v26
  v_exp_f32 v27, v27
  v_cvt_pk_bf16_f32 v50, v20, v21
  v_cvt_pk_bf16_f32 v51, v22, v23
  v_mfma_f32_32x32x16_bf16 v[112:127], a[44:47], v[60:63], v[112:127]
  buffer_load_dwordx4 a[32:35], v4, s[8:11], s31 offen offset:0 sc1
  buffer_load_dwordx4 a[36:39], v4, s[8:11], s31 offen offset:1024 sc1
  buffer_load_dwordx4 a[40:43], v4, s[8:11], s32 offen offset:0 sc1
  buffer_load_dwordx4 a[44:47], v4, s[8:11], s32 offen offset:1024 sc1
  v_exp_f32 v28, v28
  v_exp_f32 v29, v29
  v_exp_f32 v30, v30
  v_exp_f32 v31, v31
  v_cvt_pk_bf16_f32 v52, v24, v25
  v_cvt_pk_bf16_f32 v53, v26, v27
  v_cvt_pk_bf16_f32 v54, v28, v29
  v_cvt_pk_bf16_f32 v55, v30, v31
  s_waitcnt vmcnt(20)
  v_mfma_f32_32x32x16_bf16 v[16:31], a[48:51], a[16:19], 0
  v_exp_f32 v32, v32
  v_exp_f32 v33, v33
  v_exp_f32 v34, v34
  v_exp_f32 v35, v35
  v_mfma_f32_32x32x16_bf16 v[64:79], a[56:59], v[48:51], v[64:79]
  v_exp_f32 v36, v36
  v_exp_f32 v37, v37
  v_exp_f32 v38, v38
  v_exp_f32 v39, v39
  v_cvt_pk_bf16_f32 v56, v32, v33
  v_cvt_pk_bf16_f32 v57, v34, v35
  v_mfma_f32_32x32x16_bf16 v[16:31], a[52:55], a[20:23], v[16:31]
  v_exp_f32 v40, v40
  v_exp_f32 v41, v41
  v_exp_f32 v42, v42
  v_exp_f32 v43, v43
  v_cvt_pk_bf16_f32 v58, v36, v37
  v_cvt_pk_bf16_f32 v59, v38, v39
  v_mfma_f32_32x32x16_bf16 v[64:79], a[60:63], v[52:55], v[64:79]
  buffer_load_dwordx4 v4, s[8:11], s46 offen offset:2048 lds
  v_exp_f32 v44, v44
  v_exp_f32 v45, v45
  v_exp_f32 v46, v46
  v_exp_f32 v47, v47
  v_cvt_pk_bf16_f32 v60, v40, v41
  v_cvt_pk_bf16_f32 v61, v42, v43
  v_cvt_pk_bf16_f32 v62, v44, v45
  v_cvt_pk_bf16_f32 v63, v46, v47
  v_mfma_f32_32x32x16_bf16 v[32:47], a[48:51], a[24:27], 0
  v_exp_f32 v16, v16
  v_exp_f32 v17, v17
  v_exp_f32 v18, v18
  v_exp_f32 v19, v19
  v_mfma_f32_32x32x16_bf16 v[80:95], a[56:59], v[56:59], v[80:95]
  v_exp_f32 v20, v20
  v_exp_f32 v21, v21
  v_exp_f32 v22, v22
  v_exp_f32 v23, v23
  v_cvt_pk_bf16_f32 v48, v16, v17
  v_cvt_pk_bf16_f32 v49, v18, v19
  v_mfma_f32_32x32x16_bf16 v[32:47], a[52:55], a[28:31], v[32:47]
  v_exp_f32 v24, v24
  v_exp_f32 v25, v25
  v_exp_f32 v26, v26
  v_exp_f32 v27, v27
  v_cvt_pk_bf16_f32 v50, v20, v21
  v_cvt_pk_bf16_f32 v51, v22, v23
  v_mfma_f32_32x32x16_bf16 v[80:95], a[60:63], v[60:63], v[80:95]
  v_exp_f32 v28, v28
  v_exp_f32 v29, v29
  v_exp_f32 v30, v30
  v_exp_f32 v31, v31
  v_cvt_pk_bf16_f32 v52, v24, v25
  v_cvt_pk_bf16_f32 v53, v26, v27
  v_cvt_pk_bf16_f32 v54, v28, v29
  v_cvt_pk_bf16_f32 v55, v30, v31
  s_waitcnt vmcnt(16)
  v_mfma_f32_32x32x16_bf16 v[16:31], a[64:67], a[0:3], 0
  v_exp_f32 v32, v32
  v_exp_f32 v33, v33
  v_exp_f32 v34, v34
  v_exp_f32 v35, v35
  v_mfma_f32_32x32x16_bf16 v[96:111], a[56:59], v[48:51], v[96:111]
  buffer_load_dwordx4 v[232:235], v4, s[8:11], s41 offen offset:2048
  v_exp_f32 v36, v36
  v_exp_f32 v37, v37
  v_exp_f32 v38, v38
  v_exp_f32 v39, v39
  v_cvt_pk_bf16_f32 v56, v32, v33
  v_cvt_pk_bf16_f32 v57, v34, v35
  v_mfma_f32_32x32x16_bf16 v[16:31], a[68:71], a[4:7], v[16:31]
  v_exp_f32 v40, v40
  v_exp_f32 v41, v41
  v_exp_f32 v42, v42
  v_exp_f32 v43, v43
  v_cvt_pk_bf16_f32 v58, v36, v37
  v_cvt_pk_bf16_f32 v59, v38, v39
  v_mfma_f32_32x32x16_bf16 v[96:111], a[60:63], v[52:55], v[96:111]
  v_exp_f32 v44, v44
  v_exp_f32 v45, v45
  v_exp_f32 v46, v46
  v_exp_f32 v47, v47
  v_cvt_pk_bf16_f32 v60, v40, v41
  v_cvt_pk_bf16_f32 v61, v42, v43
  v_cvt_pk_bf16_f32 v62, v44, v45
  v_cvt_pk_bf16_f32 v63, v46, v47
  v_mfma_f32_32x32x16_bf16 v[32:47], a[64:67], a[8:11], 0
  v_exp_f32 v16, v16
  v_exp_f32 v17, v17
  v_exp_f32 v18, v18
  v_exp_f32 v19, v19
  v_mfma_f32_32x32x16_bf16 v[112:127], a[56:59], v[56:59], v[112:127]
  v_exp_f32 v20, v20
  v_exp_f32 v21, v21
  v_exp_f32 v22, v22
  v_exp_f32 v23, v23
  v_cvt_pk_bf16_f32 v48, v16, v17
  v_cvt_pk_bf16_f32 v49, v18, v19
  v_mfma_f32_32x32x16_bf16 v[32:47], a[68:71], a[12:15], v[32:47]
  v_exp_f32 v24, v24
  v_exp_f32 v25, v25
  v_exp_f32 v26, v26
  v_exp_f32 v27, v27
  v_cvt_pk_bf16_f32 v50, v20, v21
  v_cvt_pk_bf16_f32 v51, v22, v23
  v_mfma_f32_32x32x16_bf16 v[112:127], a[60:63], v[60:63], v[112:127]
  buffer_load_dwordx4 a[48:51], v4, s[8:11], s31 offen offset:2048 sc1
  buffer_load_dwordx4 a[52:55], v4, s[8:11], s31 offen offset:3072 sc1
  buffer_load_dwordx4 a[56:59], v4, s[8:11], s32 offen offset:2048 sc1
  buffer_load_dwordx4 a[60:63], v4, s[8:11], s32 offen offset:3072 sc1
  s_add_u32 s31, s31, 4096
  s_add_u32 s32, s32, 4096
  v_exp_f32 v28, v28
  v_exp_f32 v29, v29
  v_exp_f32 v30, v30
  v_exp_f32 v31, v31
  v_cvt_pk_bf16_f32 v52, v24, v25
  v_cvt_pk_bf16_f32 v53, v26, v27
  v_cvt_pk_bf16_f32 v54, v28, v29
  v_cvt_pk_bf16_f32 v55, v30, v31
  s_waitcnt vmcnt(19)
  v_mfma_f32_32x32x16_bf16 v[16:31], a[64:67], a[16:19], 0
  v_exp_f32 v32, v32
  v_exp_f32 v33, v33
  v_exp_f32 v34, v34
  v_exp_f32 v35, v35
  v_mfma_f32_32x32x16_bf16 v[64:79], a[72:75], v[48:51], v[64:79]
  buffer_load_dwordx4 v4, s[8:11], s46 offen offset:3072 lds
  s_add_u32 s46, s46, 4096
  v_exp_f32 v36, v36
  v_exp_f32 v37, v37
  v_exp_f32 v38, v38
  v_exp_f32 v39, v39
  v_cvt_pk_bf16_f32 v56, v32, v33
  v_cvt_pk_bf16_f32 v57, v34, v35
  v_mfma_f32_32x32x16_bf16 v[16:31], a[68:71], a[20:23], v[16:31]
  v_exp_f32 v40, v40
  v_exp_f32 v41, v41
  v_exp_f32 v42, v42
  v_exp_f32 v43, v43
  v_cvt_pk_bf16_f32 v58, v36, v37
  v_cvt_pk_bf16_f32 v59, v38, v39
  v_mfma_f32_32x32x16_bf16 v[64:79], a[76:79], v[52:55], v[64:79]
  v_exp_f32 v44, v44
  v_exp_f32 v45, v45
  v_exp_f32 v46, v46
  v_exp_f32 v47, v47
  v_cvt_pk_bf16_f32 v60, v40, v41
  v_cvt_pk_bf16_f32 v61, v42, v43
  v_cvt_pk_bf16_f32 v62, v44, v45
  v_cvt_pk_bf16_f32 v63, v46, v47
  v_mfma_f32_32x32x16_bf16 v[32:47], a[64:67], a[24:27], 0
  v_exp_f32 v16, v16
  v_exp_f32 v17, v17
  v_exp_f32 v18, v18
  v_exp_f32 v19, v19
  v_mfma_f32_32x32x16_bf16 v[80:95], a[72:75], v[56:59], v[80:95]
  v_exp_f32 v20, v20
  v_exp_f32 v21, v21
  v_exp_f32 v22, v22
  v_exp_f32 v23, v23
  v_cvt_pk_bf16_f32 v48, v16, v17
  v_cvt_pk_bf16_f32 v49, v18, v19
  v_mfma_f32_32x32x16_bf16 v[32:47], a[68:71], a[28:31], v[32:47]
  v_exp_f32 v24, v24
  v_exp_f32 v25, v25
  v_exp_f32 v26, v26
  v_exp_f32 v27, v27
  v_cvt_pk_bf16_f32 v50, v20, v21
  v_cvt_pk_bf16_f32 v51, v22, v23
  v_mfma_f32_32x32x16_bf16 v[80:95], a[76:79], v[60:63], v[80:95]
  s_mov_b32 m0, s47
  s_add_u32 s47, s47, 4096
  buffer_load_dwordx4 v4, s[8:11], s46 offen offset:0 lds
  v_exp_f32 v28, v28
  v_exp_f32 v29, v29
  v_exp_f32 v30, v30
  v_exp_f32 v31, v31
  v_cvt_pk_bf16_f32 v52, v24, v25
  v_cvt_pk_bf16_f32 v53, v26, v27
  v_cvt_pk_bf16_f32 v54, v28, v29
  v_cvt_pk_bf16_f32 v55, v30, v31
  s_waitcnt vmcnt(17)
  v_mfma_f32_32x32x16_bf16 v[16:31], a[80:83], a[0:3], 0
  v_exp_f32 v32, v32
  v_exp_f32 v33, v33
  v_exp_f32 v34, v34
  v_exp_f32 v35, v35
  v_mfma_f32_32x32x16_bf16 v[96:111], a[72:75], v[48:51], v[96:111]
  v_exp_f32 v36, v36
  v_exp_f32 v37, v37
  v_exp_f32 v38, v38
  v_exp_f32 v39, v39
  v_cvt_pk_bf16_f32 v56, v32, v33
  v_cvt_pk_bf16_f32 v57, v34, v35
  v_mfma_f32_32x32x16_bf16 v[16:31], a[84:87], a[4:7], v[16:31]
  v_exp_f32 v40, v40
  v_exp_f32 v41, v41
  v_exp_f32 v42, v42
  v_exp_f32 v43, v43
  v_cvt_pk_bf16_f32 v58, v36, v37
  v_cvt_pk_bf16_f32 v59, v38, v39
  v_mfma_f32_32x32x16_bf16 v[96:111], a[76:79], v[52:55], v[96:111]
  v_exp_f32 v44, v44
  v_exp_f32 v45, v45
  v_exp_f32 v46, v46
  v_exp_f32 v47, v47
  v_cvt_pk_bf16_f32 v60, v40, v41
  v_cvt_pk_bf16_f32 v61, v42, v43
  v_cvt_pk_bf16_f32 v62, v44, v45
  v_cvt_pk_bf16_f32 v63, v46, v47
  v_mfma_f32_32x32x16_bf16 v[32:47], a[80:83], a[8:11], 0
  v_exp_f32 v16, v16
  v_exp_f32 v17, v17
  v_exp_f32 v18, v18
  v_exp_f32 v19, v19
  v_mfma_f32_32x32x16_bf16 v[112:127], a[72:75], v[56:59], v[112:127]
  buffer_load_dwordx4 v[204:207], v4, s[8:11], s40 offen offset:3072
  s_add_u32 s40, s40, 4096
  v_exp_f32 v20, v20
  v_exp_f32 v21, v21
  v_exp_f32 v22, v22
  v_exp_f32 v23, v23
  v_cvt_pk_bf16_f32 v48, v16, v17
  v_cvt_pk_bf16_f32 v49, v18, v19
  v_mfma_f32_32x32x16_bf16 v[32:47], a[84:87], a[12:15], v[32:47]
  v_exp_f32 v24, v24
  v_exp_f32 v25, v25
  v_exp_f32 v26, v26
  v_exp_f32 v27, v27
  v_cvt_pk_bf16_f32 v50, v20, v21
  v_cvt_pk_bf16_f32 v51, v22, v23
  v_mfma_f32_32x32x16_bf16 v[112:127], a[76:79], v[60:63], v[112:127]
  buffer_load_dwordx4 a[64:67], v4, s[8:11], s31 offen offset:0 sc1
  buffer_load_dwordx4 a[68:71], v4, s[8:11], s31 offen offset:1024 sc1
  buffer_load_dwordx4 a[72:75], v4, s[8:11], s32 offen offset:0 sc1
  buffer_load_dwordx4 a[76:79], v4, s[8:11], s32 offen offset:1024 sc1
  v_exp_f32 v28, v28
  v_exp_f32 v29, v29
  v_exp_f32 v30, v30
  v_exp_f32 v31, v31
  v_cvt_pk_bf16_f32 v52, v24, v25
  v_cvt_pk_bf16_f32 v53, v26, v27
  v_cvt_pk_bf16_f32 v54, v28, v29
  v_cvt_pk_bf16_f32 v55, v30, v31
  s_waitcnt vmcnt(20)
  v_mfma_f32_32x32x16_bf16 v[16:31], a[80:83], a[16:19], 0
  v_exp_f32 v32, v32
  v_exp_f32 v33, v33
  v_exp_f32 v34, v34
  v_exp_f32 v35, v35
  v_mfma_f32_32x32x16_bf16 v[64:79], a[88:91], v[48:51], v[64:79]
  v_exp_f32 v36, v36
  v_exp_f32 v37, v37
  v_exp_f32 v38, v38
  v_exp_f32 v39, v39
  v_cvt_pk_bf16_f32 v56, v32, v33
  v_cvt_pk_bf16_f32 v57, v34, v35
  v_mfma_f32_32x32x16_bf16 v[16:31], a[84:87], a[20:23], v[16:31]
  v_exp_f32 v40, v40
  v_exp_f32 v41, v41
  v_exp_f32 v42, v42
  v_exp_f32 v43, v43
  v_cvt_pk_bf16_f32 v58, v36, v37
  v_cvt_pk_bf16_f32 v59, v38, v39
  v_mfma_f32_32x32x16_bf16 v[64:79], a[92:95], v[52:55], v[64:79]
  buffer_load_dwordx4 v4, s[8:11], s46 offen offset:1024 lds
  v_exp_f32 v44, v44
  v_exp_f32 v45, v45
  v_exp_f32 v46, v46
  v_exp_f32 v47, v47
  v_cvt_pk_bf16_f32 v60, v40, v41
  v_cvt_pk_bf16_f32 v61, v42, v43
  v_cvt_pk_bf16_f32 v62, v44, v45
  v_cvt_pk_bf16_f32 v63, v46, v47
  v_mfma_f32_32x32x16_bf16 v[32:47], a[80:83], a[24:27], 0
  v_exp_f32 v16, v16
  v_exp_f32 v17, v17
  v_exp_f32 v18, v18
  v_exp_f32 v19, v19
  v_mfma_f32_32x32x16_bf16 v[80:95], a[88:91], v[56:59], v[80:95]
  v_exp_f32 v20, v20
  v_exp_f32 v21, v21
  v_exp_f32 v22, v22
  v_exp_f32 v23, v23
  v_cvt_pk_bf16_f32 v48, v16, v17
  v_cvt_pk_bf16_f32 v49, v18, v19
  v_mfma_f32_32x32x16_bf16 v[32:47], a[84:87], a[28:31], v[32:47]
  v_exp_f32 v24, v24
  v_exp_f32 v25, v25
  v_exp_f32 v26, v26
  v_exp_f32 v27, v27
  v_cvt_pk_bf16_f32 v50, v20, v21
  v_cvt_pk_bf16_f32 v51, v22, v23
  v_mfma_f32_32x32x16_bf16 v[80:95], a[92:95], v[60:63], v[80:95]
  v_exp_f32 v28, v28
  v_exp_f32 v29, v29
  v_exp_f32 v30, v30
  v_exp_f32 v31, v31
  v_cvt_pk_bf16_f32 v52, v24, v25
  v_cvt_pk_bf16_f32 v53, v26, v27
  v_cvt_pk_bf16_f32 v54, v28, v29
  v_cvt_pk_bf16_f32 v55, v30, v31
  s_waitcnt vmcnt(16)
  v_mfma_f32_32x32x16_bf16 v[16:31], a[32:35], a[0:3], 0
  v_exp_f32 v32, v32
  v_exp_f32 v33, v33
  v_exp_f32 v34, v34
  v_exp_f32 v35, v35
  v_mfma_f32_32x32x16_bf16 v[96:111], a[88:91], v[48:51], v[96:111]
  buffer_load_dwordx4 v[236:239], v4, s[8:11], s41 offen offset:3072
  s_add_u32 s41, s41, 4096
  v_exp_f32 v36, v36
  v_exp_f32 v37, v37
  v_exp_f32 v38, v38
  v_exp_f32 v39, v39
  v_cvt_pk_bf16_f32 v56, v32, v33
  v_cvt_pk_bf16_f32 v57, v34, v35
  v_mfma_f32_32x32x16_bf16 v[16:31], a[36:39], a[4:7], v[16:31]
  v_exp_f32 v40, v40
  v_exp_f32 v41, v41
  v_exp_f32 v42, v42
  v_exp_f32 v43, v43
  v_cvt_pk_bf16_f32 v58, v36, v37
  v_cvt_pk_bf16_f32 v59, v38, v39
  v_mfma_f32_32x32x16_bf16 v[96:111], a[92:95], v[52:55], v[96:111]
  v_exp_f32 v44, v44
  v_exp_f32 v45, v45
  v_exp_f32 v46, v46
  v_exp_f32 v47, v47
  v_cvt_pk_bf16_f32 v60, v40, v41
  v_cvt_pk_bf16_f32 v61, v42, v43
  v_cvt_pk_bf16_f32 v62, v44, v45
  v_cvt_pk_bf16_f32 v63, v46, v47
  v_mfma_f32_32x32x16_bf16 v[32:47], a[32:35], a[8:11], 0
  v_exp_f32 v16, v16
  v_exp_f32 v17, v17
  v_exp_f32 v18, v18
  v_exp_f32 v19, v19
  v_mfma_f32_32x32x16_bf16 v[112:127], a[88:91], v[56:59], v[112:127]
  v_exp_f32 v20, v20
  v_exp_f32 v21, v21
  v_exp_f32 v22, v22
  v_exp_f32 v23, v23
  v_cvt_pk_bf16_f32 v48, v16, v17
  v_cvt_pk_bf16_f32 v49, v18, v19
  v_mfma_f32_32x32x16_bf16 v[32:47], a[36:39], a[12:15], v[32:47]
  v_exp_f32 v24, v24
  v_exp_f32 v25, v25
  v_exp_f32 v26, v26
  v_exp_f32 v27, v27
  v_cvt_pk_bf16_f32 v50, v20, v21
  v_cvt_pk_bf16_f32 v51, v22, v23
  v_mfma_f32_32x32x16_bf16 v[112:127], a[92:95], v[60:63], v[112:127]
  buffer_load_dwordx4 a[80:83], v4, s[8:11], s31 offen offset:2048 sc1
  buffer_load_dwordx4 a[84:87], v4, s[8:11], s31 offen offset:3072 sc1
  buffer_load_dwordx4 a[88:91], v4, s[8:11], s32 offen offset:2048 sc1
  buffer_load_dwordx4 a[92:95], v4, s[8:11], s32 offen offset:3072 sc1
  s_add_u32 s31, s31, 4096
  s_add_u32 s32, s32, 4096
  v_exp_f32 v28, v28
  v_exp_f32 v29, v29
  v_exp_f32 v30, v30
  v_exp_f32 v31, v31
  v_cvt_pk_bf16_f32 v52, v24, v25
  v_cvt_pk_bf16_f32 v53, v26, v27
  v_cvt_pk_bf16_f32 v54, v28, v29
  v_cvt_pk_bf16_f32 v55, v30, v31
  s_waitcnt vmcnt(19)
  v_mfma_f32_32x32x16_bf16 v[16:31], a[32:35], a[16:19], 0
  v_exp_f32 v32, v32
  v_exp_f32 v33, v33
  v_exp_f32 v34, v34
  v_exp_f32 v35, v35
  v_mfma_f32_32x32x16_bf16 v[64:79], a[40:43], v[48:51], v[64:79]
  buffer_load_dwordx4 v4, s[8:11], s46 offen offset:2048 lds
  v_exp_f32 v36, v36
  v_exp_f32 v37, v37
  v_exp_f32 v38, v38
  v_exp_f32 v39, v39
  v_cvt_pk_bf16_f32 v56, v32, v33
  v_cvt_pk_bf16_f32 v57, v34, v35
  v_mfma_f32_32x32x16_bf16 v[16:31], a[36:39], a[20:23], v[16:31]
  v_exp_f32 v40, v40
  v_exp_f32 v41, v41
  v_exp_f32 v42, v42
  v_exp_f32 v43, v43
  v_cvt_pk_bf16_f32 v58, v36, v37
  v_cvt_pk_bf16_f32 v59, v38, v39
  v_mfma_f32_32x32x16_bf16 v[64:79], a[44:47], v[52:55], v[64:79]
  v_exp_f32 v44, v44
  v_exp_f32 v45, v45
  v_exp_f32 v46, v46
  v_exp_f32 v47, v47
  v_cvt_pk_bf16_f32 v60, v40, v41
  v_cvt_pk_bf16_f32 v61, v42, v43
  v_cvt_pk_bf16_f32 v62, v44, v45
  v_cvt_pk_bf16_f32 v63, v46, v47
  v_mfma_f32_32x32x16_bf16 v[32:47], a[32:35], a[24:27], 0
  v_exp_f32 v16, v16
  v_exp_f32 v17, v17
  v_exp_f32 v18, v18
  v_exp_f32 v19, v19
  v_mfma_f32_32x32x16_bf16 v[80:95], a[40:43], v[56:59], v[80:95]
  buffer_load_dwordx4 v[208:211], v4, s[8:11], s40 offen offset:0
  v_exp_f32 v20, v20
  v_exp_f32 v21, v21
  v_exp_f32 v22, v22
  v_exp_f32 v23, v23
  v_cvt_pk_bf16_f32 v48, v16, v17
  v_cvt_pk_bf16_f32 v49, v18, v19
  v_mfma_f32_32x32x16_bf16 v[32:47], a[36:39], a[28:31], v[32:47]
  v_exp_f32 v24, v24
  v_exp_f32 v25, v25
  v_exp_f32 v26, v26
  v_exp_f32 v27, v27
  v_cvt_pk_bf16_f32 v50, v20, v21
  v_cvt_pk_bf16_f32 v51, v22, v23
  v_mfma_f32_32x32x16_bf16 v[80:95], a[44:47], v[60:63], v[80:95]
  v_exp_f32 v28, v28
  v_exp_f32 v29, v29
  v_exp_f32 v30, v30
  v_exp_f32 v31, v31
  v_cvt_pk_bf16_f32 v52, v24, v25
  v_cvt_pk_bf16_f32 v53, v26, v27
  v_cvt_pk_bf16_f32 v54, v28, v29
  v_cvt_pk_bf16_f32 v55, v30, v31
  s_waitcnt vmcnt(17)
  v_mfma_f32_32x32x16_bf16 v[16:31], a[48:51], a[0:3], 0
  v_exp_f32 v32, v32
  v_exp_f32 v33, v33
  v_exp_f32 v34, v34
  v_exp_f32 v35, v35
  v_mfma_f32_32x32x16_bf16 v[96:111], a[40:43], v[48:51], v[96:111]
  v_exp_f32 v36, v36
  v_exp_f32 v37, v37
  v_exp_f32 v38, v38
  v_exp_f32 v39, v39
  v_cvt_pk_bf16_f32 v56, v32, v33
  v_cvt_pk_bf16_f32 v57, v34, v35
  v_mfma_f32_32x32x16_bf16 v[16:31], a[52:55], a[4:7], v[16:31]
  v_exp_f32 v40, v40
  v_exp_f32 v41, v41
  v_exp_f32 v42, v42
  v_exp_f32 v43, v43
  v_cvt_pk_bf16_f32 v58, v36, v37
  v_cvt_pk_bf16_f32 v59, v38, v39
  v_mfma_f32_32x32x16_bf16 v[96:111], a[44:47], v[52:55], v[96:111]
  buffer_load_dwordx4 v4, s[8:11], s46 offen offset:3072 lds
  s_add_u32 s46, s46, 4096
  v_exp_f32 v44, v44
  v_exp_f32 v45, v45
  v_exp_f32 v46, v46
  v_exp_f32 v47, v47
  v_cvt_pk_bf16_f32 v60, v40, v41
  v_cvt_pk_bf16_f32 v61, v42, v43
  v_cvt_pk_bf16_f32 v62, v44, v45
  v_cvt_pk_bf16_f32 v63, v46, v47
  v_mfma_f32_32x32x16_bf16 v[32:47], a[48:51], a[8:11], 0
  v_exp_f32 v16, v16
  v_exp_f32 v17, v17
  v_exp_f32 v18, v18
  v_exp_f32 v19, v19
  v_mfma_f32_32x32x16_bf16 v[112:127], a[40:43], v[56:59], v[112:127]
  v_exp_f32 v20, v20
  v_exp_f32 v21, v21
  v_exp_f32 v22, v22
  v_exp_f32 v23, v23
  v_cvt_pk_bf16_f32 v48, v16, v17
  v_cvt_pk_bf16_f32 v49, v18, v19
  v_mfma_f32_32x32x16_bf16 v[32:47], a[52:55], a[12:15], v[32:47]
  v_exp_f32 v24, v24
  v_exp_f32 v25, v25
  v_exp_f32 v26, v26
  v_exp_f32 v27, v27
  v_cvt_pk_bf16_f32 v50, v20, v21
  v_cvt_pk_bf16_f32 v51, v22, v23
  v_mfma_f32_32x32x16_bf16 v[112:127], a[44:47], v[60:63], v[112:127]
  buffer_load_dwordx4 a[32:35], v4, s[8:11], s31 offen offset:0 sc1
  buffer_load_dwordx4 a[36:39], v4, s[8:11], s31 offen offset:1024 sc1
  buffer_load_dwordx4 a[40:43], v4, s[8:11], s32 offen offset:0 sc1
  buffer_load_dwordx4 a[44:47], v4, s[8:11], s32 offen offset:1024 sc1
  v_exp_f32 v28, v28
  v_exp_f32 v29, v29
  v_exp_f32 v30, v30
  v_exp_f32 v31, v31
  v_cvt_pk_bf16_f32 v52, v24, v25
  v_cvt_pk_bf16_f32 v53, v26, v27
  v_cvt_pk_bf16_f32 v54, v28, v29
  v_cvt_pk_bf16_f32 v55, v30, v31
  s_waitcnt vmcnt(20)
  v_mfma_f32_32x32x16_bf16 v[16:31], a[48:51], a[16:19], 0
  v_exp_f32 v32, v32
  v_exp_f32 v33, v33
  v_exp_f32 v34, v34
  v_exp_f32 v35, v35
  v_mfma_f32_32x32x16_bf16 v[64:79], a[56:59], v[48:51], v[64:79]
  buffer_load_dwordx4 v[240:243], v4, s[8:11], s41 offen offset:0
  v_exp_f32 v36, v36
  v_exp_f32 v37, v37
  v_exp_f32 v38, v38
  v_exp_f32 v39, v39
  v_cvt_pk_bf16_f32 v56, v32, v33
  v_cvt_pk_bf16_f32 v57, v34, v35
  v_mfma_f32_32x32x16_bf16 v[16:31], a[52:55], a[20:23], v[16:31]
  v_exp_f32 v40, v40
  v_exp_f32 v41, v41
  v_exp_f32 v42, v42
  v_exp_f32 v43, v43
  v_cvt_pk_bf16_f32 v58, v36, v37
  v_cvt_pk_bf16_f32 v59, v38, v39
  v_mfma_f32_32x32x16_bf16 v[64:79], a[60:63], v[52:55], v[64:79]
  v_exp_f32 v44, v44
  v_exp_f32 v45, v45
  v_exp_f32 v46, v46
  v_exp_f32 v47, v47
  v_cvt_pk_bf16_f32 v60, v40, v41
  v_cvt_pk_bf16_f32 v61, v42, v43
  v_cvt_pk_bf16_f32 v62, v44, v45
  v_cvt_pk_bf16_f32 v63, v46, v47
  v_mfma_f32_32x32x16_bf16 v[32:47], a[48:51], a[24:27], 0
  v_exp_f32 v16, v16
  v_exp_f32 v17, v17
  v_exp_f32 v18, v18
  v_exp_f32 v19, v19
  v_mfma_f32_32x32x16_bf16 v[80:95], a[56:59], v[56:59], v[80:95]
  v_exp_f32 v20, v20
  v_exp_f32 v21, v21
  v_exp_f32 v22, v22
  v_exp_f32 v23, v23
  v_cvt_pk_bf16_f32 v48, v16, v17
  v_cvt_pk_bf16_f32 v49, v18, v19
  v_mfma_f32_32x32x16_bf16 v[32:47], a[52:55], a[28:31], v[32:47]
  v_exp_f32 v24, v24
  v_exp_f32 v25, v25
  v_exp_f32 v26, v26
  v_exp_f32 v27, v27
  v_cvt_pk_bf16_f32 v50, v20, v21
  v_cvt_pk_bf16_f32 v51, v22, v23
  v_mfma_f32_32x32x16_bf16 v[80:95], a[60:63], v[60:63], v[80:95]
  v_exp_f32 v28, v28
  v_exp_f32 v29, v29
  v_exp_f32 v30, v30
  v_exp_f32 v31, v31
  v_cvt_pk_bf16_f32 v52, v24, v25
  v_cvt_pk_bf16_f32 v53, v26, v27
  v_cvt_pk_bf16_f32 v54, v28, v29
  v_cvt_pk_bf16_f32 v55, v30, v31
  s_waitcnt vmcnt(16)
  v_mfma_f32_32x32x16_bf16 v[16:31], a[64:67], a[0:3], 0
  v_exp_f32 v32, v32
  v_exp_f32 v33, v33
  v_exp_f32 v34, v34
  v_exp_f32 v35, v35
  v_mfma_f32_32x32x16_bf16 v[96:111], a[56:59], v[48:51], v[96:111]
  s_mov_b32 m0, s47
  s_add_u32 s47, s47, 4096
  buffer_load_dwordx4 v4, s[8:11], s46 offen offset:0 lds
  v_exp_f32 v36, v36
  v_exp_f32 v37, v37
  v_exp_f32 v38, v38
  v_exp_f32 v39, v39
  v_cvt_pk_bf16_f32 v56, v32, v33
  v_cvt_pk_bf16_f32 v57, v34, v35
  v_mfma_f32_32x32x16_bf16 v[16:31], a[68:71], a[4:7], v[16:31]
  v_exp_f32 v40, v40
  v_exp_f32 v41, v41
  v_exp_f32 v42, v42
  v_exp_f32 v43, v43
  v_cvt_pk_bf16_f32 v58, v36, v37
  v_cvt_pk_bf16_f32 v59, v38, v39
  v_mfma_f32_32x32x16_bf16 v[96:111], a[60:63], v[52:55], v[96:111]
  v_exp_f32 v44, v44
  v_exp_f32 v45, v45
  v_exp_f32 v46, v46
  v_exp_f32 v47, v47
  v_cvt_pk_bf16_f32 v60, v40, v41
  v_cvt_pk_bf16_f32 v61, v42, v43
  v_cvt_pk_bf16_f32 v62, v44, v45
  v_cvt_pk_bf16_f32 v63, v46, v47
  v_mfma_f32_32x32x16_bf16 v[32:47], a[64:67], a[8:11], 0
  v_exp_f32 v16, v16
  v_exp_f32 v17, v17
  v_exp_f32 v18, v18
  v_exp_f32 v19, v19
  v_mfma_f32_32x32x16_bf16 v[112:127], a[56:59], v[56:59], v[112:127]
  v_exp_f32 v20, v20
  v_exp_f32 v21, v21
  v_exp_f32 v22, v22
  v_exp_f32 v23, v23
  v_cvt_pk_bf16_f32 v48, v16, v17
  v_cvt_pk_bf16_f32 v49, v18, v19
  v_mfma_f32_32x32x16_bf16 v[32:47], a[68:71], a[12:15], v[32:47]
  v_exp_f32 v24, v24
  v_exp_f32 v25, v25
  v_exp_f32 v26, v26
  v_exp_f32 v27, v27
  v_cvt_pk_bf16_f32 v50, v20, v21
  v_cvt_pk_bf16_f32 v51, v22, v23
  v_mfma_f32_32x32x16_bf16 v[112:127], a[60:63], v[60:63], v[112:127]
  buffer_load_dwordx4 a[48:51], v4, s[8:11], s31 offen offset:2048 sc1
  buffer_load_dwordx4 a[52:55], v4, s[8:11], s31 offen offset:3072 sc1
  buffer_load_dwordx4 a[56:59], v4, s[8:11], s32 offen offset:2048 sc1
  buffer_load_dwordx4 a[60:63], v4, s[8:11], s32 offen offset:3072 sc1
  s_add_u32 s31, s31, 4096
  s_add_u32 s32, s32, 4096
  v_exp_f32 v28, v28
  v_exp_f32 v29, v29
  v_exp_f32 v30, v30
  v_exp_f32 v31, v31
  v_cvt_pk_bf16_f32 v52, v24, v25
  v_cvt_pk_bf16_f32 v53, v26, v27
  v_cvt_pk_bf16_f32 v54, v28, v29
  v_cvt_pk_bf16_f32 v55, v30, v31
  s_waitcnt vmcnt(19)
  v_mfma_f32_32x32x16_bf16 v[16:31], a[64:67], a[16:19], 0
  v_exp_f32 v32, v32
  v_exp_f32 v33, v33
  v_exp_f32 v34, v34
  v_exp_f32 v35, v35
  v_mfma_f32_32x32x16_bf16 v[64:79], a[72:75], v[48:51], v[64:79]
  buffer_load_dwordx4 v4, s[8:11], s46 offen offset:1024 lds
  v_exp_f32 v36, v36
  v_exp_f32 v37, v37
  v_exp_f32 v38, v38
  v_exp_f32 v39, v39
  v_cvt_pk_bf16_f32 v56, v32, v33
  v_cvt_pk_bf16_f32 v57, v34, v35
  v_mfma_f32_32x32x16_bf16 v[16:31], a[68:71], a[20:23], v[16:31]
  v_exp_f32 v40, v40
  v_exp_f32 v41, v41
  v_exp_f32 v42, v42
  v_exp_f32 v43, v43
  v_cvt_pk_bf16_f32 v58, v36, v37
  v_cvt_pk_bf16_f32 v59, v38, v39
  v_mfma_f32_32x32x16_bf16 v[64:79], a[76:79], v[52:55], v[64:79]
  v_exp_f32 v44, v44
  v_exp_f32 v45, v45
  v_exp_f32 v46, v46
  v_exp_f32 v47, v47
  v_cvt_pk_bf16_f32 v60, v40, v41
  v_cvt_pk_bf16_f32 v61, v42, v43
  v_cvt_pk_bf16_f32 v62, v44, v45
  v_cvt_pk_bf16_f32 v63, v46, v47
  v_mfma_f32_32x32x16_bf16 v[32:47], a[64:67], a[24:27], 0
  v_exp_f32 v16, v16
  v_exp_f32 v17, v17
  v_exp_f32 v18, v18
  v_exp_f32 v19, v19
  v_mfma_f32_32x32x16_bf16 v[80:95], a[72:75], v[56:59], v[80:95]
  buffer_load_dwordx4 v[212:215], v4, s[8:11], s40 offen offset:1024
  v_exp_f32 v20, v20
  v_exp_f32 v21, v21
  v_exp_f32 v22, v22
  v_exp_f32 v23, v23
  v_cvt_pk_bf16_f32 v48, v16, v17
  v_cvt_pk_bf16_f32 v49, v18, v19
  v_mfma_f32_32x32x16_bf16 v[32:47], a[68:71], a[28:31], v[32:47]
  v_exp_f32 v24, v24
  v_exp_f32 v25, v25
  v_exp_f32 v26, v26
  v_exp_f32 v27, v27
  v_cvt_pk_bf16_f32 v50, v20, v21
  v_cvt_pk_bf16_f32 v51, v22, v23
  v_mfma_f32_32x32x16_bf16 v[80:95], a[76:79], v[60:63], v[80:95]
  v_exp_f32 v28, v28
  v_exp_f32 v29, v29
  v_exp_f32 v30, v30
  v_exp_f32 v31, v31
  v_cvt_pk_bf16_f32 v52, v24, v25
  v_cvt_pk_bf16_f32 v53, v26, v27
  v_cvt_pk_bf16_f32 v54, v28, v29
  v_cvt_pk_bf16_f32 v55, v30, v31
  s_waitcnt vmcnt(17)
  v_mfma_f32_32x32x16_bf16 v[16:31], a[80:83], a[0:3], 0
  v_exp_f32 v32, v32
  v_exp_f32 v33, v33
  v_exp_f32 v34, v34
  v_exp_f32 v35, v35
  v_mfma_f32_32x32x16_bf16 v[96:111], a[72:75], v[48:51], v[96:111]
  v_exp_f32 v36, v36
  v_exp_f32 v37, v37
  v_exp_f32 v38, v38
  v_exp_f32 v39, v39
  v_cvt_pk_bf16_f32 v56, v32, v33
  v_cvt_pk_bf16_f32 v57, v34, v35
  v_mfma_f32_32x32x16_bf16 v[16:31], a[84:87], a[4:7], v[16:31]
  v_exp_f32 v40, v40
  v_exp_f32 v41, v41
  v_exp_f32 v42, v42
  v_exp_f32 v43, v43
  v_cvt_pk_bf16_f32 v58, v36, v37
  v_cvt_pk_bf16_f32 v59, v38, v39
  v_mfma_f32_32x32x16_bf16 v[96:111], a[76:79], v[52:55], v[96:111]
  buffer_load_dwordx4 v4, s[8:11], s46 offen offset:2048 lds
  v_exp_f32 v44, v44
  v_exp_f32 v45, v45
  v_exp_f32 v46, v46
  v_exp_f32 v47, v47
  v_cvt_pk_bf16_f32 v60, v40, v41
  v_cvt_pk_bf16_f32 v61, v42, v43
  v_cvt_pk_bf16_f32 v62, v44, v45
  v_cvt_pk_bf16_f32 v63, v46, v47
  v_mfma_f32_32x32x16_bf16 v[32:47], a[80:83], a[8:11], 0
  v_exp_f32 v16, v16
  v_exp_f32 v17, v17
  v_exp_f32 v18, v18
  v_exp_f32 v19, v19
  v_mfma_f32_32x32x16_bf16 v[112:127], a[72:75], v[56:59], v[112:127]
  v_exp_f32 v20, v20
  v_exp_f32 v21, v21
  v_exp_f32 v22, v22
  v_exp_f32 v23, v23
  v_cvt_pk_bf16_f32 v48, v16, v17
  v_cvt_pk_bf16_f32 v49, v18, v19
  v_mfma_f32_32x32x16_bf16 v[32:47], a[84:87], a[12:15], v[32:47]
  v_exp_f32 v24, v24
  v_exp_f32 v25, v25
  v_exp_f32 v26, v26
  v_exp_f32 v27, v27
  v_cvt_pk_bf16_f32 v50, v20, v21
  v_cvt_pk_bf16_f32 v51, v22, v23
  v_mfma_f32_32x32x16_bf16 v[112:127], a[76:79], v[60:63], v[112:127]
  buffer_load_dwordx4 a[64:67], v4, s[8:11], s31 offen offset:0 sc1
  buffer_load_dwordx4 a[68:71], v4, s[8:11], s31 offen offset:1024 sc1
  buffer_load_dwordx4 a[72:75], v4, s[8:11], s32 offen offset:0 sc1
  buffer_load_dwordx4 a[76:79], v4, s[8:11], s32 offen offset:1024 sc1
  v_exp_f32 v28, v28
  v_exp_f32 v29, v29
  v_exp_f32 v30, v30
  v_exp_f32 v31, v31
  v_cvt_pk_bf16_f32 v52, v24, v25
  v_cvt_pk_bf16_f32 v53, v26, v27
  v_cvt_pk_bf16_f32 v54, v28, v29
  v_cvt_pk_bf16_f32 v55, v30, v31
  s_waitcnt vmcnt(20)
  v_mfma_f32_32x32x16_bf16 v[16:31], a[80:83], a[16:19], 0
  v_exp_f32 v32, v32
  v_exp_f32 v33, v33
  v_exp_f32 v34, v34
  v_exp_f32 v35, v35
  v_mfma_f32_32x32x16_bf16 v[64:79], a[88:91], v[48:51], v[64:79]
  buffer_load_dwordx4 v[244:247], v4, s[8:11], s41 offen offset:1024
  v_exp_f32 v36, v36
  v_exp_f32 v37, v37
  v_exp_f32 v38, v38
  v_exp_f32 v39, v39
  v_cvt_pk_bf16_f32 v56, v32, v33
  v_cvt_pk_bf16_f32 v57, v34, v35
  v_mfma_f32_32x32x16_bf16 v[16:31], a[84:87], a[20:23], v[16:31]
  v_exp_f32 v40, v40
  v_exp_f32 v41, v41
  v_exp_f32 v42, v42
  v_exp_f32 v43, v43
  v_cvt_pk_bf16_f32 v58, v36, v37
  v_cvt_pk_bf16_f32 v59, v38, v39
  v_mfma_f32_32x32x16_bf16 v[64:79], a[92:95], v[52:55], v[64:79]
  v_exp_f32 v44, v44
  v_exp_f32 v45, v45
  v_exp_f32 v46, v46
  v_exp_f32 v47, v47
  v_cvt_pk_bf16_f32 v60, v40, v41
  v_cvt_pk_bf16_f32 v61, v42, v43
  v_cvt_pk_bf16_f32 v62, v44, v45
  v_cvt_pk_bf16_f32 v63, v46, v47
  v_mfma_f32_32x32x16_bf16 v[32:47], a[80:83], a[24:27], 0
  v_exp_f32 v16, v16
  v_exp_f32 v17, v17
  v_exp_f32 v18, v18
  v_exp_f32 v19, v19
  v_mfma_f32_32x32x16_bf16 v[80:95], a[88:91], v[56:59], v[80:95]
  v_exp_f32 v20, v20
  v_exp_f32 v21, v21
  v_exp_f32 v22, v22
  v_exp_f32 v23, v23
  v_cvt_pk_bf16_f32 v48, v16, v17
  v_cvt_pk_bf16_f32 v49, v18, v19
  v_mfma_f32_32x32x16_bf16 v[32:47], a[84:87], a[28:31], v[32:47]
  v_exp_f32 v24, v24
  v_exp_f32 v25, v25
  v_exp_f32 v26, v26
  v_exp_f32 v27, v27
  v_cvt_pk_bf16_f32 v50, v20, v21
  v_cvt_pk_bf16_f32 v51, v22, v23
  v_mfma_f32_32x32x16_bf16 v[80:95], a[92:95], v[60:63], v[80:95]
  buffer_load_dwordx4 v4, s[8:11], s46 offen offset:3072 lds
  s_add_u32 s46, s46, 4096
  v_exp_f32 v28, v28
  v_exp_f32 v29, v29
  v_exp_f32 v30, v30
  v_exp_f32 v31, v31
  v_cvt_pk_bf16_f32 v52, v24, v25
  v_cvt_pk_bf16_f32 v53, v26, v27
  v_cvt_pk_bf16_f32 v54, v28, v29
  v_cvt_pk_bf16_f32 v55, v30, v31
  s_waitcnt vmcnt(17)
  v_mfma_f32_32x32x16_bf16 v[16:31], a[32:35], a[0:3], 0
  v_exp_f32 v32, v32
  v_exp_f32 v33, v33
  v_exp_f32 v34, v34
  v_exp_f32 v35, v35
  v_mfma_f32_32x32x16_bf16 v[96:111], a[88:91], v[48:51], v[96:111]
  v_exp_f32 v36, v36
  v_exp_f32 v37, v37
  v_exp_f32 v38, v38
  v_exp_f32 v39, v39
  v_cvt_pk_bf16_f32 v56, v32, v33
  v_cvt_pk_bf16_f32 v57, v34, v35
  v_mfma_f32_32x32x16_bf16 v[16:31], a[36:39], a[4:7], v[16:31]
  v_exp_f32 v40, v40
  v_exp_f32 v41, v41
  v_exp_f32 v42, v42
  v_exp_f32 v43, v43
  v_cvt_pk_bf16_f32 v58, v36, v37
  v_cvt_pk_bf16_f32 v59, v38, v39
  v_mfma_f32_32x32x16_bf16 v[96:111], a[92:95], v[52:55], v[96:111]
  v_exp_f32 v44, v44
  v_exp_f32 v45, v45
  v_exp_f32 v46, v46
  v_exp_f32 v47, v47
  v_cvt_pk_bf16_f32 v60, v40, v41
  v_cvt_pk_bf16_f32 v61, v42, v43
  v_cvt_pk_bf16_f32 v62, v44, v45
  v_cvt_pk_bf16_f32 v63, v46, v47
  v_mfma_f32_32x32x16_bf16 v[32:47], a[32:35], a[8:11], 0
  v_exp_f32 v16, v16
  v_exp_f32 v17, v17
  v_exp_f32 v18, v18
  v_exp_f32 v19, v19
  v_mfma_f32_32x32x16_bf16 v[112:127], a[88:91], v[56:59], v[112:127]
  buffer_load_dwordx4 v[216:219], v4, s[8:11], s40 offen offset:2048
  v_exp_f32 v20, v20
  v_exp_f32 v21, v21
  v_exp_f32 v22, v22
  v_exp_f32 v23, v23
  v_cvt_pk_bf16_f32 v48, v16, v17
  v_cvt_pk_bf16_f32 v49, v18, v19
  v_mfma_f32_32x32x16_bf16 v[32:47], a[36:39], a[12:15], v[32:47]
  v_exp_f32 v24, v24
  v_exp_f32 v25, v25
  v_exp_f32 v26, v26
  v_exp_f32 v27, v27
  v_cvt_pk_bf16_f32 v50, v20, v21
  v_cvt_pk_bf16_f32 v51, v22, v23
  v_mfma_f32_32x32x16_bf16 v[112:127], a[92:95], v[60:63], v[112:127]
  buffer_load_dwordx4 a[80:83], v4, s[8:11], s31 offen offset:2048 sc1
  buffer_load_dwordx4 a[84:87], v4, s[8:11], s31 offen offset:3072 sc1
  buffer_load_dwordx4 a[88:91], v4, s[8:11], s32 offen offset:2048 sc1
  buffer_load_dwordx4 a[92:95], v4, s[8:11], s32 offen offset:3072 sc1
  s_add_u32 s31, s31, 4096
  s_add_u32 s32, s32, 4096
  v_exp_f32 v28, v28
  v_exp_f32 v29, v29
  v_exp_f32 v30, v30
  v_exp_f32 v31, v31
  v_cvt_pk_bf16_f32 v52, v24, v25
  v_cvt_pk_bf16_f32 v53, v26, v27
  v_cvt_pk_bf16_f32 v54, v28, v29
  v_cvt_pk_bf16_f32 v55, v30, v31
  s_waitcnt vmcnt(20)
  v_mfma_f32_32x32x16_bf16 v[16:31], a[32:35], a[16:19], 0
  v_exp_f32 v32, v32
  v_exp_f32 v33, v33
  v_exp_f32 v34, v34
  v_exp_f32 v35, v35
  v_mfma_f32_32x32x16_bf16 v[64:79], a[40:43], v[48:51], v[64:79]
  v_exp_f32 v36, v36
  v_exp_f32 v37, v37
  v_exp_f32 v38, v38
  v_exp_f32 v39, v39
  v_cvt_pk_bf16_f32 v56, v32, v33
  v_cvt_pk_bf16_f32 v57, v34, v35
  v_mfma_f32_32x32x16_bf16 v[16:31], a[36:39], a[20:23], v[16:31]
  v_exp_f32 v40, v40
  v_exp_f32 v41, v41
  v_exp_f32 v42, v42
  v_exp_f32 v43, v43
  v_cvt_pk_bf16_f32 v58, v36, v37
  v_cvt_pk_bf16_f32 v59, v38, v39
  v_mfma_f32_32x32x16_bf16 v[64:79], a[44:47], v[52:55], v[64:79]
  v_exp_f32 v44, v44
  v_exp_f32 v45, v45
  v_exp_f32 v46, v46
  v_exp_f32 v47, v47
  v_cvt_pk_bf16_f32 v60, v40, v41
  v_cvt_pk_bf16_f32 v61, v42, v43
  v_cvt_pk_bf16_f32 v62, v44, v45
  v_cvt_pk_bf16_f32 v63, v46, v47
  v_mfma_f32_32x32x16_bf16 v[32:47], a[32:35], a[24:27], 0
  v_exp_f32 v16, v16
  v_exp_f32 v17, v17
  v_exp_f32 v18, v18
  v_exp_f32 v19, v19
  v_mfma_f32_32x32x16_bf16 v[80:95], a[40:43], v[56:59], v[80:95]
  s_mov_b32 m0, s47
  s_add_u32 s47, s47, 4096
  buffer_load_dwordx4 v4, s[8:11], s46 offen offset:0 lds
  v_exp_f32 v20, v20
  v_exp_f32 v21, v21
  v_exp_f32 v22, v22
  v_exp_f32 v23, v23
  v_cvt_pk_bf16_f32 v48, v16, v17
  v_cvt_pk_bf16_f32 v49, v18, v19
  v_mfma_f32_32x32x16_bf16 v[32:47], a[36:39], a[28:31], v[32:47]
  v_exp_f32 v24, v24
  v_exp_f32 v25, v25
  v_exp_f32 v26, v26
  v_exp_f32 v27, v27
  v_cvt_pk_bf16_f32 v50, v20, v21
  v_cvt_pk_bf16_f32 v51, v22, v23
  v_mfma_f32_32x32x16_bf16 v[80:95], a[44:47], v[60:63], v[80:95]
  v_exp_f32 v28, v28
  v_exp_f32 v29, v29
  v_exp_f32 v30, v30
  v_exp_f32 v31, v31
  v_cvt_pk_bf16_f32 v52, v24, v25
  v_cvt_pk_bf16_f32 v53, v26, v27
  v_cvt_pk_bf16_f32 v54, v28, v29
  v_cvt_pk_bf16_f32 v55, v30, v31
  s_waitcnt vmcnt(17)
  v_mfma_f32_32x32x16_bf16 v[16:31], a[48:51], a[0:3], 0
  v_exp_f32 v32, v32
  v_exp_f32 v33, v33
  v_exp_f32 v34, v34
  v_exp_f32 v35, v35
  v_mfma_f32_32x32x16_bf16 v[96:111], a[40:43], v[48:51], v[96:111]
  v_exp_f32 v36, v36
  v_exp_f32 v37, v37
  v_exp_f32 v38, v38
  v_exp_f32 v39, v39
  v_cvt_pk_bf16_f32 v56, v32, v33
  v_cvt_pk_bf16_f32 v57, v34, v35
  v_mfma_f32_32x32x16_bf16 v[16:31], a[52:55], a[4:7], v[16:31]
  v_exp_f32 v40, v40
  v_exp_f32 v41, v41
  v_exp_f32 v42, v42
  v_exp_f32 v43, v43
  v_cvt_pk_bf16_f32 v58, v36, v37
  v_cvt_pk_bf16_f32 v59, v38, v39
  v_mfma_f32_32x32x16_bf16 v[96:111], a[44:47], v[52:55], v[96:111]
  buffer_load_dwordx4 v4, s[8:11], s46 offen offset:1024 lds
  v_exp_f32 v44, v44
  v_exp_f32 v45, v45
  v_exp_f32 v46, v46
  v_exp_f32 v47, v47
  v_cvt_pk_bf16_f32 v60, v40, v41
  v_cvt_pk_bf16_f32 v61, v42, v43
  v_cvt_pk_bf16_f32 v62, v44, v45
  v_cvt_pk_bf16_f32 v63, v46, v47
  v_mfma_f32_32x32x16_bf16 v[32:47], a[48:51], a[8:11], 0
  v_exp_f32 v16, v16
  v_exp_f32 v17, v17
  v_exp_f32 v18, v18
  v_exp_f32 v19, v19
  v_mfma_f32_32x32x16_bf16 v[112:127], a[40:43], v[56:59], v[112:127]
  v_exp_f32 v20, v20
  v_exp_f32 v21, v21
  v_exp_f32 v22, v22
  v_exp_f32 v23, v23
  v_cvt_pk_bf16_f32 v48, v16, v17
  v_cvt_pk_bf16_f32 v49, v18, v19
  v_mfma_f32_32x32x16_bf16 v[32:47], a[52:55], a[12:15], v[32:47]
  v_exp_f32 v24, v24
  v_exp_f32 v25, v25
  v_exp_f32 v26, v26
  v_exp_f32 v27, v27
  v_cvt_pk_bf16_f32 v50, v20, v21
  v_cvt_pk_bf16_f32 v51, v22, v23
  v_mfma_f32_32x32x16_bf16 v[112:127], a[44:47], v[60:63], v[112:127]
  v_exp_f32 v28, v28
  v_exp_f32 v29, v29
  v_exp_f32 v30, v30
  v_exp_f32 v31, v31
  v_cvt_pk_bf16_f32 v52, v24, v25
  v_cvt_pk_bf16_f32 v53, v26, v27
  v_cvt_pk_bf16_f32 v54, v28, v29
  v_cvt_pk_bf16_f32 v55, v30, v31
  s_waitcnt vmcnt(16)
  v_mfma_f32_32x32x16_bf16 v[16:31], a[48:51], a[16:19], 0
  v_exp_f32 v32, v32
  v_exp_f32 v33, v33
  v_exp_f32 v34, v34
  v_exp_f32 v35, v35
  v_mfma_f32_32x32x16_bf16 v[64:79], a[56:59], v[48:51], v[64:79]
  buffer_load_dwordx4 v[248:251], v4, s[8:11], s41 offen offset:2048
  v_exp_f32 v36, v36
  v_exp_f32 v37, v37
  v_exp_f32 v38, v38
  v_exp_f32 v39, v39
  v_cvt_pk_bf16_f32 v56, v32, v33
  v_cvt_pk_bf16_f32 v57, v34, v35
  v_mfma_f32_32x32x16_bf16 v[16:31], a[52:55], a[20:23], v[16:31]
  v_exp_f32 v40, v40
  v_exp_f32 v41, v41
  v_exp_f32 v42, v42
  v_exp_f32 v43, v43
  v_cvt_pk_bf16_f32 v58, v36, v37
  v_cvt_pk_bf16_f32 v59, v38, v39
  v_mfma_f32_32x32x16_bf16 v[64:79], a[60:63], v[52:55], v[64:79]
  v_exp_f32 v44, v44
  v_exp_f32 v45, v45
  v_exp_f32 v46, v46
  v_exp_f32 v47, v47
  v_cvt_pk_bf16_f32 v60, v40, v41
  v_cvt_pk_bf16_f32 v61, v42, v43
  v_cvt_pk_bf16_f32 v62, v44, v45
  v_cvt_pk_bf16_f32 v63, v46, v47
  v_mfma_f32_32x32x16_bf16 v[32:47], a[48:51], a[24:27], 0
  v_exp_f32 v16, v16
  v_exp_f32 v17, v17
  v_exp_f32 v18, v18
  v_exp_f32 v19, v19
  v_mfma_f32_32x32x16_bf16 v[80:95], a[56:59], v[56:59], v[80:95]
  v_exp_f32 v20, v20
  v_exp_f32 v21, v21
  v_exp_f32 v22, v22
  v_exp_f32 v23, v23
  v_cvt_pk_bf16_f32 v48, v16, v17
  v_cvt_pk_bf16_f32 v49, v18, v19
  v_mfma_f32_32x32x16_bf16 v[32:47], a[52:55], a[28:31], v[32:47]
  v_exp_f32 v24, v24
  v_exp_f32 v25, v25
  v_exp_f32 v26, v26
  v_exp_f32 v27, v27
  v_cvt_pk_bf16_f32 v50, v20, v21
  v_cvt_pk_bf16_f32 v51, v22, v23
  v_mfma_f32_32x32x16_bf16 v[80:95], a[60:63], v[60:63], v[80:95]
  buffer_load_dwordx4 v4, s[8:11], s46 offen offset:2048 lds
  v_exp_f32 v28, v28
  v_exp_f32 v29, v29
  v_exp_f32 v30, v30
  v_exp_f32 v31, v31
  v_cvt_pk_bf16_f32 v52, v24, v25
  v_cvt_pk_bf16_f32 v53, v26, v27
  v_cvt_pk_bf16_f32 v54, v28, v29
  v_cvt_pk_bf16_f32 v55, v30, v31
  s_waitcnt vmcnt(13)
  v_mfma_f32_32x32x16_bf16 v[16:31], a[64:67], a[0:3], 0
  v_exp_f32 v32, v32
  v_exp_f32 v33, v33
  v_exp_f32 v34, v34
  v_exp_f32 v35, v35
  v_mfma_f32_32x32x16_bf16 v[96:111], a[56:59], v[48:51], v[96:111]
  v_exp_f32 v36, v36
  v_exp_f32 v37, v37
  v_exp_f32 v38, v38
  v_exp_f32 v39, v39
  v_cvt_pk_bf16_f32 v56, v32, v33
  v_cvt_pk_bf16_f32 v57, v34, v35
  v_mfma_f32_32x32x16_bf16 v[16:31], a[68:71], a[4:7], v[16:31]
  v_exp_f32 v40, v40
  v_exp_f32 v41, v41
  v_exp_f32 v42, v42
  v_exp_f32 v43, v43
  v_cvt_pk_bf16_f32 v58, v36, v37
  v_cvt_pk_bf16_f32 v59, v38, v39
  v_mfma_f32_32x32x16_bf16 v[96:111], a[60:63], v[52:55], v[96:111]
  v_exp_f32 v44, v44
  v_exp_f32 v45, v45
  v_exp_f32 v46, v46
  v_exp_f32 v47, v47
  v_cvt_pk_bf16_f32 v60, v40, v41
  v_cvt_pk_bf16_f32 v61, v42, v43
  v_cvt_pk_bf16_f32 v62, v44, v45
  v_cvt_pk_bf16_f32 v63, v46, v47
  v_mfma_f32_32x32x16_bf16 v[32:47], a[64:67], a[8:11], 0
  v_exp_f32 v16, v16
  v_exp_f32 v17, v17
  v_exp_f32 v18, v18
  v_exp_f32 v19, v19
  v_mfma_f32_32x32x16_bf16 v[112:127], a[56:59], v[56:59], v[112:127]
  buffer_load_dwordx4 v[220:223], v4, s[8:11], s40 offen offset:3072
  s_add_u32 s40, s40, 4096
  v_exp_f32 v20, v20
  v_exp_f32 v21, v21
  v_exp_f32 v22, v22
  v_exp_f32 v23, v23
  v_cvt_pk_bf16_f32 v48, v16, v17
  v_cvt_pk_bf16_f32 v49, v18, v19
  v_mfma_f32_32x32x16_bf16 v[32:47], a[68:71], a[12:15], v[32:47]
  v_exp_f32 v24, v24
  v_exp_f32 v25, v25
  v_exp_f32 v26, v26
  v_exp_f32 v27, v27
  v_cvt_pk_bf16_f32 v50, v20, v21
  v_cvt_pk_bf16_f32 v51, v22, v23
  v_mfma_f32_32x32x16_bf16 v[112:127], a[60:63], v[60:63], v[112:127]
  v_exp_f32 v28, v28
  v_exp_f32 v29, v29
  v_exp_f32 v30, v30
  v_exp_f32 v31, v31
  v_cvt_pk_bf16_f32 v52, v24, v25
  v_cvt_pk_bf16_f32 v53, v26, v27
  v_cvt_pk_bf16_f32 v54, v28, v29
  v_cvt_pk_bf16_f32 v55, v30, v31
  s_waitcnt vmcnt(12)
  v_mfma_f32_32x32x16_bf16 v[16:31], a[64:67], a[16:19], 0
  v_exp_f32 v32, v32
  v_exp_f32 v33, v33
  v_exp_f32 v34, v34
  v_exp_f32 v35, v35
  v_mfma_f32_32x32x16_bf16 v[64:79], a[72:75], v[48:51], v[64:79]
  v_exp_f32 v36, v36
  v_exp_f32 v37, v37
  v_exp_f32 v38, v38
  v_exp_f32 v39, v39
  v_cvt_pk_bf16_f32 v56, v32, v33
  v_cvt_pk_bf16_f32 v57, v34, v35
  v_mfma_f32_32x32x16_bf16 v[16:31], a[68:71], a[20:23], v[16:31]
  v_exp_f32 v40, v40
  v_exp_f32 v41, v41
  v_exp_f32 v42, v42
  v_exp_f32 v43, v43
  v_cvt_pk_bf16_f32 v58, v36, v37
  v_cvt_pk_bf16_f32 v59, v38, v39
  v_mfma_f32_32x32x16_bf16 v[64:79], a[76:79], v[52:55], v[64:79]
  buffer_load_dwordx4 v4, s[8:11], s46 offen offset:3072 lds
  s_add_u32 s46, s46, 4096
  v_exp_f32 v44, v44
  v_exp_f32 v45, v45
  v_exp_f32 v46, v46
  v_exp_f32 v47, v47
  v_cvt_pk_bf16_f32 v60, v40, v41
  v_cvt_pk_bf16_f32 v61, v42, v43
  v_cvt_pk_bf16_f32 v62, v44, v45
  v_cvt_pk_bf16_f32 v63, v46, v47
  v_mfma_f32_32x32x16_bf16 v[32:47], a[64:67], a[24:27], 0
  v_exp_f32 v16, v16
  v_exp_f32 v17, v17
  v_exp_f32 v18, v18
  v_exp_f32 v19, v19
  v_mfma_f32_32x32x16_bf16 v[80:95], a[72:75], v[56:59], v[80:95]
  v_exp_f32 v20, v20
  v_exp_f32 v21, v21
  v_exp_f32 v22, v22
  v_exp_f32 v23, v23
  v_cvt_pk_bf16_f32 v48, v16, v17
  v_cvt_pk_bf16_f32 v49, v18, v19
  v_mfma_f32_32x32x16_bf16 v[32:47], a[68:71], a[28:31], v[32:47]
  v_exp_f32 v24, v24
  v_exp_f32 v25, v25
  v_exp_f32 v26, v26
  v_exp_f32 v27, v27
  v_cvt_pk_bf16_f32 v50, v20, v21
  v_cvt_pk_bf16_f32 v51, v22, v23
  v_mfma_f32_32x32x16_bf16 v[80:95], a[76:79], v[60:63], v[80:95]
  v_exp_f32 v28, v28
  v_exp_f32 v29, v29
  v_exp_f32 v30, v30
  v_exp_f32 v31, v31
  v_cvt_pk_bf16_f32 v52, v24, v25
  v_cvt_pk_bf16_f32 v53, v26, v27
  v_cvt_pk_bf16_f32 v54, v28, v29
  v_cvt_pk_bf16_f32 v55, v30, v31
  s_waitcnt vmcnt(8)
  v_mfma_f32_32x32x16_bf16 v[16:31], a[80:83], a[8:11], 0
  v_exp_f32 v32, v32
  v_exp_f32 v33, v33
  v_exp_f32 v34, v34
  v_exp_f32 v35, v35
  v_mfma_f32_32x32x16_bf16 v[96:111], a[72:75], v[48:51], v[96:111]
  buffer_load_dwordx4 v[252:255], v4, s[8:11], s41 offen offset:3072
  s_add_u32 s41, s41, 4096
  v_exp_f32 v36, v36
  v_exp_f32 v37, v37
  v_exp_f32 v38, v38
  v_exp_f32 v39, v39
  v_cvt_pk_bf16_f32 v56, v32, v33
  v_cvt_pk_bf16_f32 v57, v34, v35
  v_mfma_f32_32x32x16_bf16 v[16:31], a[84:87], a[12:15], v[16:31]
  v_exp_f32 v40, v40
  v_exp_f32 v41, v41
  v_exp_f32 v42, v42
  v_exp_f32 v43, v43
  v_cvt_pk_bf16_f32 v58, v36, v37
  v_cvt_pk_bf16_f32 v59, v38, v39
  v_mfma_f32_32x32x16_bf16 v[96:111], a[76:79], v[52:55], v[96:111]
  v_exp_f32 v44, v44
  v_exp_f32 v45, v45
  v_exp_f32 v46, v46
  v_exp_f32 v47, v47
  v_cvt_pk_bf16_f32 v60, v40, v41
  v_cvt_pk_bf16_f32 v61, v42, v43
  v_cvt_pk_bf16_f32 v62, v44, v45
  v_cvt_pk_bf16_f32 v63, v46, v47
  v_mfma_f32_32x32x16_bf16 v[32:47], a[80:83], a[16:19], 0
  v_exp_f32 v16, v16
  v_exp_f32 v17, v17
  v_exp_f32 v18, v18
  v_exp_f32 v19, v19
  v_mfma_f32_32x32x16_bf16 v[112:127], a[72:75], v[56:59], v[112:127]
  v_exp_f32 v20, v20
  v_exp_f32 v21, v21
  v_exp_f32 v22, v22
  v_exp_f32 v23, v23
  v_cvt_pk_bf16_f32 v48, v16, v17
  v_cvt_pk_bf16_f32 v49, v18, v19
  v_mfma_f32_32x32x16_bf16 v[32:47], a[84:87], a[20:23], v[32:47]
  v_exp_f32 v24, v24
  v_exp_f32 v25, v25
  v_exp_f32 v26, v26
  v_exp_f32 v27, v27
  v_cvt_pk_bf16_f32 v50, v20, v21
  v_cvt_pk_bf16_f32 v51, v22, v23
  v_mfma_f32_32x32x16_bf16 v[112:127], a[76:79], v[60:63], v[112:127]
  s_mov_b32 m0, s47
  s_add_u32 s47, s47, 4096
  buffer_load_dwordx4 v4, s[8:11], s46 offen offset:0 lds
  v_exp_f32 v28, v28
  v_exp_f32 v29, v29
  v_exp_f32 v30, v30
  v_exp_f32 v31, v31
  v_cvt_pk_bf16_f32 v52, v24, v25
  v_cvt_pk_bf16_f32 v53, v26, v27
  v_cvt_pk_bf16_f32 v54, v28, v29
  v_cvt_pk_bf16_f32 v55, v30, v31
  s_waitcnt vmcnt(8)
  v_mfma_f32_32x32x16_bf16 v[16:31], a[80:83], a[24:27], 0
  v_exp_f32 v32, v32
  v_exp_f32 v33, v33
  v_exp_f32 v34, v34
  v_exp_f32 v35, v35
  v_mfma_f32_32x32x16_bf16 v[80:95], a[88:91], v[48:51], v[80:95]
  v_exp_f32 v36, v36
  v_exp_f32 v37, v37
  v_exp_f32 v38, v38
  v_exp_f32 v39, v39
  v_cvt_pk_bf16_f32 v56, v32, v33
  v_cvt_pk_bf16_f32 v57, v34, v35
  v_mfma_f32_32x32x16_bf16 v[16:31], a[84:87], a[28:31], v[16:31]
  v_exp_f32 v40, v40
  v_exp_f32 v41, v41
  v_exp_f32 v42, v42
  v_exp_f32 v43, v43
  v_cvt_pk_bf16_f32 v58, v36, v37
  v_cvt_pk_bf16_f32 v59, v38, v39
  v_mfma_f32_32x32x16_bf16 v[80:95], a[92:95], v[52:55], v[80:95]
  v_exp_f32 v44, v44
  v_exp_f32 v45, v45
  v_exp_f32 v46, v46
  v_exp_f32 v47, v47
  v_cvt_pk_bf16_f32 v60, v40, v41
  v_cvt_pk_bf16_f32 v61, v42, v43
  v_cvt_pk_bf16_f32 v62, v44, v45
  v_cvt_pk_bf16_f32 v63, v46, v47
  v_mfma_f32_32x32x16_bf16 v[32:47], a[80:83], a[0:3], 0
  v_exp_f32 v16, v16
  v_exp_f32 v17, v17
  v_exp_f32 v18, v18
  v_exp_f32 v19, v19
  v_mfma_f32_32x32x16_bf16 v[96:111], a[88:91], v[56:59], v[96:111]
  ds_write_b128 v9, v[80:83] offset:0
  ds_write_b128 v9, v[84:87] offset:1024
  ds_write_b128 v9, v[88:91] offset:2048
  ds_write_b128 v9, v[92:95] offset:3072
  v_exp_f32 v20, v20
  v_exp_f32 v21, v21
  v_exp_f32 v22, v22
  v_exp_f32 v23, v23
  v_cvt_pk_bf16_f32 v48, v16, v17
  v_cvt_pk_bf16_f32 v49, v18, v19
  v_mfma_f32_32x32x16_bf16 v[32:47], a[84:87], a[4:7], v[32:47]
  v_exp_f32 v24, v24
  v_exp_f32 v25, v25
  v_exp_f32 v26, v26
  v_exp_f32 v27, v27
  v_cvt_pk_bf16_f32 v50, v20, v21
  v_cvt_pk_bf16_f32 v51, v22, v23
  v_mfma_f32_32x32x16_bf16 v[96:111], a[92:95], v[60:63], v[96:111]
  v_exp_f32 v28, v28
  v_exp_f32 v29, v29
  v_exp_f32 v30, v30
  v_exp_f32 v31, v31
  v_cvt_pk_bf16_f32 v52, v24, v25
  v_cvt_pk_bf16_f32 v53, v26, v27
  v_cvt_pk_bf16_f32 v54, v28, v29
  v_cvt_pk_bf16_f32 v55, v30, v31
  v_exp_f32 v32, v32
  v_exp_f32 v33, v33
  v_exp_f32 v34, v34
  v_exp_f32 v35, v35
  v_mfma_f32_32x32x16_bf16 v[112:127], a[88:91], v[48:51], v[112:127]
  ds_write_b128 v10, v[96:99] offset:0
  ds_write_b128 v10, v[100:103] offset:1024
  ds_write_b128 v10, v[104:107] offset:2048
  ds_write_b128 v10, v[108:111] offset:3072
  v_exp_f32 v36, v36
  v_exp_f32 v37, v37
  v_exp_f32 v38, v38
  v_exp_f32 v39, v39
  v_cvt_pk_bf16_f32 v56, v32, v33
  v_cvt_pk_bf16_f32 v57, v34, v35
  v_exp_f32 v40, v40
  v_exp_f32 v41, v41
  v_exp_f32 v42, v42
  v_exp_f32 v43, v43
  v_cvt_pk_bf16_f32 v58, v36, v37
  v_cvt_pk_bf16_f32 v59, v38, v39
  v_mfma_f32_32x32x16_bf16 v[112:127], a[92:95], v[52:55], v[112:127]
  v_exp_f32 v44, v44
  v_exp_f32 v45, v45
  v_exp_f32 v46, v46
  v_exp_f32 v47, v47
  v_cvt_pk_bf16_f32 v60, v40, v41
  v_cvt_pk_bf16_f32 v61, v42, v43
  v_cvt_pk_bf16_f32 v62, v44, v45
  v_cvt_pk_bf16_f32 v63, v46, v47
  s_nop 0
  v_mfma_f32_32x32x16_bf16 v[64:79], a[88:91], v[56:59], v[64:79]
  v_mfma_f32_32x32x16_bf16 v[64:79], a[92:95], v[60:63], v[64:79]
  s_nop 4
  ds_write_b128 v11, v[112:115] offset:0
  ds_write_b128 v11, v[116:119] offset:1024
  ds_write_b128 v11, v[120:123] offset:2048
  ds_write_b128 v11, v[124:127] offset:3072
Lb_reduce:
  s_waitcnt lgkmcnt(0)
  s_barrier
  ds_read_b128 v[80:83], v12 offset:0
  ds_read_b128 v[84:87], v12 offset:1024
  ds_read_b128 v[88:91], v12 offset:2048
  ds_read_b128 v[92:95], v12 offset:3072
  ds_read_b128 v[96:99], v12 offset:4096
  ds_read_b128 v[100:103], v12 offset:5120
  ds_read_b128 v[104:107], v12 offset:6144
  ds_read_b128 v[108:111], v12 offset:7168
  ds_read_b128 v[112:115], v12 offset:8192
  ds_read_b128 v[116:119], v12 offset:9216
  ds_read_b128 v[120:123], v12 offset:10240
  ds_read_b128 v[124:127], v12 offset:11264
  s_mul_i32 s42, s3, 0x200000
  s_add_u32 s42, s42, 0x1a00000
  s_lshl_b32 s43, s26, 2
  s_add_u32 s43, s43, s16
  s_lshl_b32 s43, s43, 5
  s_lshl_b32 s44, s25, 1
  s_add_u32 s43, s43, s44
  s_lshl_b32 s43, s43, 10
  s_add_u32 s42, s42, s43
  s_waitcnt lgkmcnt(8)
  v_pk_add_f32 v[64:65], v[64:65], v[80:81]
  v_pk_add_f32 v[66:67], v[66:67], v[82:83]
  v_pk_add_f32 v[68:69], v[68:69], v[84:85]
  v_pk_add_f32 v[70:71], v[70:71], v[86:87]
  v_pk_add_f32 v[72:73], v[72:73], v[88:89]
  v_pk_add_f32 v[74:75], v[74:75], v[90:91]
  v_pk_add_f32 v[76:77], v[76:77], v[92:93]
  v_pk_add_f32 v[78:79], v[78:79], v[94:95]
  s_waitcnt lgkmcnt(4)
  v_pk_add_f32 v[64:65], v[64:65], v[96:97]
  v_pk_add_f32 v[66:67], v[66:67], v[98:99]
  v_pk_add_f32 v[68:69], v[68:69], v[100:101]
  v_pk_add_f32 v[70:71], v[70:71], v[102:103]
  v_pk_add_f32 v[72:73], v[72:73], v[104:105]
  v_pk_add_f32 v[74:75], v[74:75], v[106:107]
  v_pk_add_f32 v[76:77], v[76:77], v[108:109]
  v_pk_add_f32 v[78:79], v[78:79], v[110:111]
  s_waitcnt lgkmcnt(0)
  v_pk_add_f32 v[64:65], v[64:65], v[112:113]
  v_pk_add_f32 v[66:67], v[66:67], v[114:115]
  v_pk_add_f32 v[68:69], v[68:69], v[116:117]
  v_pk_add_f32 v[70:71], v[70:71], v[118:119]
  v_pk_add_f32 v[72:73], v[72:73], v[120:121]
  v_pk_add_f32 v[74:75], v[74:75], v[122:123]
  v_pk_add_f32 v[76:77], v[76:77], v[124:125]
  v_pk_add_f32 v[78:79], v[78:79], v[126:127]
  v_mov_b32 v6, v76
  v_mov_b32 v7, v76
  s_nop 1
  v_permlane32_swap_b32 v6, v7
  s_nop 1
  v_rcp_f32 v6, v7
  s_nop 0
  v_pk_mul_f32 v[64:65], v[64:65], v[6:7] op_sel_hi:[1,0]
  v_pk_mul_f32 v[66:67], v[66:67], v[6:7] op_sel_hi:[1,0]
  v_pk_mul_f32 v[68:69], v[68:69], v[6:7] op_sel_hi:[1,0]
  v_pk_mul_f32 v[70:71], v[70:71], v[6:7] op_sel_hi:[1,0]
  v_pk_mul_f32 v[72:73], v[72:73], v[6:7] op_sel_hi:[1,0]
  v_pk_mul_f32 v[74:75], v[74:75], v[6:7] op_sel_hi:[1,0]
  v_pk_mul_f32 v[76:77], v[76:77], v[6:7] op_sel_hi:[1,0]
  v_pk_mul_f32 v[78:79], v[78:79], v[6:7] op_sel_hi:[1,0]
  v_cvt_pk_bf16_f32 v16, v64, v65
  v_cvt_pk_bf16_f32 v17, v66, v67
  v_cvt_pk_bf16_f32 v18, v68, v69
  v_cvt_pk_bf16_f32 v19, v70, v71
  v_cvt_pk_bf16_f32 v20, v72, v73
  v_cvt_pk_bf16_f32 v21, v74, v75
  v_cvt_pk_bf16_f32 v22, v76, v77
  v_cvt_pk_bf16_f32 v23, v78, v79
  buffer_store_dwordx4 v[16:19], v4, s[8:11], s42 offen sc1
  buffer_store_dwordx4 v[20:23], v4, s[8:11], s42 offen offset:1024 sc1
  s_mul_i32 s30, s3, 10240
  s_add_u32 s30, s30, 0xd10800
  s_lshl_b32 s63, s26, 7
  s_add_u32 s30, s30, s63
  s_lshl_b32 s63, s25, 2
  s_add_u32 s30, s30, s63
  v_mov_b32 v6, 0
  v_mov_b32 v7, s66
  s_cmp_lg_u32 s16, 0
  s_waitcnt vmcnt(0)
  s_barrier
  s_cbranch_scc1 Lb_fa_nf
  s_mov_b64 exec, 1
  buffer_store_dword v7, v6, s[8:11], s30 offen sc1
  s_mov_b64 exec, -1
Lb_fa_nf:
  s_branch Lb_done
Lb_slow:
  v_mov_b32 v56, 0xff61b1e6
  v_mov_b32 v57, 0xff61b1e6
  v_mov_b32 v58, 0xff61b1e6
  v_mov_b32 v59, 0xff61b1e6
  v_mov_b32 v64, 0
  v_mov_b32 v65, 0
  v_mov_b32 v66, 0
  v_mov_b32 v67, 0
  v_mov_b32 v68, 0
  v_mov_b32 v69, 0
  v_mov_b32 v70, 0
  v_mov_b32 v71, 0
  v_mov_b32 v72, 0
  v_mov_b32 v73, 0
  v_mov_b32 v74, 0
  v_mov_b32 v75, 0
  v_mov_b32 v76, 0
  v_mov_b32 v77, 0
  v_mov_b32 v78, 0
  v_mov_b32 v79, 0
  v_mov_b32 v80, 0
  v_mov_b32 v81, 0
  v_mov_b32 v82, 0
  v_mov_b32 v83, 0
  v_mov_b32 v84, 0
  v_mov_b32 v85, 0
  v_mov_b32 v86, 0
  v_mov_b32 v87, 0
  v_mov_b32 v88, 0
  v_mov_b32 v89, 0
  v_mov_b32 v90, 0
  v_mov_b32 v91, 0
  v_mov_b32 v92, 0
  v_mov_b32 v93, 0
  v_mov_b32 v94, 0
  v_mov_b32 v95, 0
  v_mov_b32 v96, 0
  v_mov_b32 v97, 0
  v_mov_b32 v98, 0
  v_mov_b32 v99, 0
  v_mov_b32 v100, 0
  v_mov_b32 v101, 0
  v_mov_b32 v102, 0
  v_mov_b32 v103, 0
  v_mov_b32 v104, 0
  v_mov_b32 v105, 0
  v_mov_b32 v106, 0
  v_mov_b32 v107, 0
  v_mov_b32 v108, 0
  v_mov_b32 v109, 0
  v_mov_b32 v110, 0
  v_mov_b32 v111, 0
  v_mov_b32 v112, 0
  v_mov_b32 v113, 0
  v_mov_b32 v114, 0
  v_mov_b32 v115, 0
  v_mov_b32 v116, 0
  v_mov_b32 v117, 0
  v_mov_b32 v118, 0
  v_mov_b32 v119, 0
  v_mov_b32 v120, 0
  v_mov_b32 v121, 0
  v_mov_b32 v122, 0
  v_mov_b32 v123, 0
  v_mov_b32 v124, 0
  v_mov_b32 v125, 0
  v_mov_b32 v126, 0
  v_mov_b32 v127, 0
  s_waitcnt vmcnt(0)
  buffer_load_dwordx4 a[16:19], v4, s[8:11], s35 offen sc1
  buffer_load_dwordx4 a[20:23], v4, s[8:11], s35 offen offset:1024 sc1
  buffer_load_dwordx4 a[24:27], v4, s[8:11], s36 offen sc1
  buffer_load_dwordx4 a[28:31], v4, s[8:11], s36 offen offset:1024 sc1
  s_mov_b32 m0, s47
  s_add_u32 s47, s47, 4096
  buffer_load_dwordx4 v4, s[8:11], s46 offen offset:0 lds
  buffer_load_dwordx4 v[192:195], v4, s[8:11], s40 offen offset:0
  buffer_load_dwordx4 v4, s[8:11], s46 offen offset:1024 lds
  buffer_load_dwordx4 v[224:227], v4, s[8:11], s41 offen offset:0
  buffer_load_dwordx4 v4, s[8:11], s46 offen offset:2048 lds
  buffer_load_dwordx4 v[196:199], v4, s[8:11], s40 offen offset:1024
  buffer_load_dwordx4 v4, s[8:11], s46 offen offset:3072 lds
  s_add_u32 s46, s46, 4096
  s_mov_b32 m0, s47
  s_add_u32 s47, s47, 4096
  buffer_load_dwordx4 v4, s[8:11], s46 offen offset:0 lds
  buffer_load_dwordx4 v[228:231], v4, s[8:11], s41 offen offset:1024
  buffer_load_dwordx4 v4, s[8:11], s46 offen offset:1024 lds
  buffer_load_dwordx4 v[200:203], v4, s[8:11], s40 offen offset:2048
  buffer_load_dwordx4 v4, s[8:11], s46 offen offset:2048 lds
  buffer_load_dwordx4 v[232:235], v4, s[8:11], s41 offen offset:2048
  buffer_load_dwordx4 v4, s[8:11], s46 offen offset:3072 lds
  s_add_u32 s46, s46, 4096
  s_mov_b32 m0, s47
  s_add_u32 s47, s47, 4096
  buffer_load_dwordx4 v4, s[8:11], s46 offen offset:0 lds
  buffer_load_dwordx4 v[204:207], v4, s[8:11], s40 offen offset:3072
  s_add_u32 s40, s40, 4096
  buffer_load_dwordx4 v4, s[8:11], s46 offen offset:1024 lds
  buffer_load_dwordx4 v[236:239], v4, s[8:11], s41 offen offset:3072
  s_add_u32 s41, s41, 4096
  buffer_load_dwordx4 v4, s[8:11], s46 offen offset:2048 lds
  buffer_load_dwordx4 v[208:211], v4, s[8:11], s40 offen offset:0
  buffer_load_dwordx4 v4, s[8:11], s46 offen offset:3072 lds
  s_add_u32 s46, s46, 4096
  buffer_load_dwordx4 v[240:243], v4, s[8:11], s41 offen offset:0
  s_mov_b32 m0, s47
  s_add_u32 s47, s47, 4096
  buffer_load_dwordx4 v4, s[8:11], s46 offen offset:0 lds
  buffer_load_dwordx4 v4, s[8:11], s46 offen offset:1024 lds
  buffer_load_dwordx4 v[212:215], v4, s[8:11], s40 offen offset:1024
  buffer_load_dwordx4 v4, s[8:11], s46 offen offset:2048 lds
  buffer_load_dwordx4 v[244:247], v4, s[8:11], s41 offen offset:1024
  buffer_load_dwordx4 v4, s[8:11], s46 offen offset:3072 lds
  s_add_u32 s46, s46, 4096
  buffer_load_dwordx4 v[216:219], v4, s[8:11], s40 offen offset:2048
  s_mov_b32 m0, s47
  s_add_u32 s47, s47, 4096
  buffer_load_dwordx4 v4, s[8:11], s46 offen offset:0 lds
  buffer_load_dwordx4 v4, s[8:11], s46 offen offset:1024 lds
  buffer_load_dwordx4 v[248:251], v4, s[8:11], s41 offen offset:2048
  buffer_load_dwordx4 v4, s[8:11], s46 offen offset:2048 lds
  buffer_load_dwordx4 v[220:223], v4, s[8:11], s40 offen offset:3072
  s_add_u32 s40, s40, 4096
  buffer_load_dwordx4 v4, s[8:11], s46 offen offset:3072 lds
  s_add_u32 s46, s46, 4096
  buffer_load_dwordx4 v[252:255], v4, s[8:11], s41 offen offset:3072
  s_add_u32 s41, s41, 4096
  s_mov_b32 m0, s47
  s_add_u32 s47, s47, 4096
  buffer_load_dwordx4 v4, s[8:11], s46 offen offset:0 lds
  s_mov_b32 s49, 16
Lb_sloop:
  buffer_load_dwordx4 a[32:35], v4, s[8:11], s31 offen sc1
  buffer_load_dwordx4 a[36:39], v4, s[8:11], s31 offen offset:1024 sc1
  buffer_load_dwordx4 a[40:43], v4, s[8:11], s32 offen sc1
  buffer_load_dwordx4 a[44:47], v4, s[8:11], s32 offen offset:1024 sc1
  s_add_u32 s31, s31, 2048
  s_add_u32 s32, s32, 2048
  s_waitcnt vmcnt(0)
  v_mfma_f32_32x32x16_bf16 v[16:31], a[32:35], a[0:3], 0
  v_mfma_f32_32x32x16_bf16 v[16:31], a[36:39], a[4:7], v[16:31]
  s_nop 7
  s_nop 7
  v_max_f32 v6, v16, v17
  v_max_f32 v6, v6, v18
  v_max_f32 v6, v6, v19
  v_max_f32 v6, v6, v20
  v_max_f32 v6, v6, v21
  v_max_f32 v6, v6, v22
  v_max_f32 v6, v6, v23
  v_max_f32 v6, v6, v24
  v_max_f32 v6, v6, v25
  v_max_f32 v6, v6, v26
  v_max_f32 v6, v6, v27
  v_max_f32 v6, v6, v28
  v_max_f32 v6, v6, v29
  v_max_f32 v6, v6, v30
  v_max_f32 v6, v6, v31
  v_mov_b32 v7, v6
  s_nop 1
  v_permlane32_swap_b32 v6, v7
  s_nop 1
  v_max_f32 v6, v6, v7
  v_max_f32 v6, v6, v56
  v_sub_f32 v7, v56, v6
  v_exp_f32 v7, v7
  v_mov_b32 v56, v6
  v_sub_f32 v16, v16, v6
  v_sub_f32 v17, v17, v6
  v_sub_f32 v18, v18, v6
  v_sub_f32 v19, v19, v6
  v_sub_f32 v20, v20, v6
  v_sub_f32 v21, v21, v6
  v_sub_f32 v22, v22, v6
  v_sub_f32 v23, v23, v6
  v_sub_f32 v24, v24, v6
  v_sub_f32 v25, v25, v6
  v_sub_f32 v26, v26, v6
  v_sub_f32 v27, v27, v6
  v_sub_f32 v28, v28, v6
  v_sub_f32 v29, v29, v6
  v_sub_f32 v30, v30, v6
  v_sub_f32 v31, v31, v6
  v_exp_f32 v16, v16
  v_exp_f32 v17, v17
  v_exp_f32 v18, v18
  v_exp_f32 v19, v19
  v_exp_f32 v20, v20
  v_exp_f32 v21, v21
  v_exp_f32 v22, v22
  v_exp_f32 v23, v23
  v_exp_f32 v24, v24
  v_exp_f32 v25, v25
  v_exp_f32 v26, v26
  v_exp_f32 v27, v27
  v_exp_f32 v28, v28
  v_exp_f32 v29, v29
  v_exp_f32 v30, v30
  v_exp_f32 v31, v31
  v_mul_f32 v64, v64, v7
  v_mul_f32 v65, v65, v7
  v_mul_f32 v66, v66, v7
  v_mul_f32 v67, v67, v7
  v_mul_f32 v68, v68, v7
  v_mul_f32 v69, v69, v7
  v_mul_f32 v70, v70, v7
  v_mul_f32 v71, v71, v7
  v_mul_f32 v72, v72, v7
  v_mul_f32 v73, v73, v7
  v_mul_f32 v74, v74, v7
  v_mul_f32 v75, v75, v7
  v_mul_f32 v76, v76, v7
  v_mul_f32 v77, v77, v7
  v_mul_f32 v78, v78, v7
  v_mul_f32 v79, v79, v7
  v_cvt_pk_bf16_f32 v48, v16, v17
  v_cvt_pk_bf16_f32 v49, v18, v19
  v_cvt_pk_bf16_f32 v50, v20, v21
  v_cvt_pk_bf16_f32 v51, v22, v23
  v_cvt_pk_bf16_f32 v52, v24, v25
  v_cvt_pk_bf16_f32 v53, v26, v27
  v_cvt_pk_bf16_f32 v54, v28, v29
  v_cvt_pk_bf16_f32 v55, v30, v31
  s_nop 1
  v_mfma_f32_32x32x16_bf16 v[64:79], a[40:43], v[48:51], v[64:79]
  v_mfma_f32_32x32x16_bf16 v[64:79], a[44:47], v[52:55], v[64:79]
  s_nop 7
  s_nop 7
  v_mfma_f32_32x32x16_bf16 v[16:31], a[32:35], a[8:11], 0
  v_mfma_f32_32x32x16_bf16 v[16:31], a[36:39], a[12:15], v[16:31]
  s_nop 7
  s_nop 7
  v_max_f32 v6, v16, v17
  v_max_f32 v6, v6, v18
  v_max_f32 v6, v6, v19
  v_max_f32 v6, v6, v20
  v_max_f32 v6, v6, v21
  v_max_f32 v6, v6, v22
  v_max_f32 v6, v6, v23
  v_max_f32 v6, v6, v24
  v_max_f32 v6, v6, v25
  v_max_f32 v6, v6, v26
  v_max_f32 v6, v6, v27
  v_max_f32 v6, v6, v28
  v_max_f32 v6, v6, v29
  v_max_f32 v6, v6, v30
  v_max_f32 v6, v6, v31
  v_mov_b32 v7, v6
  s_nop 1
  v_permlane32_swap_b32 v6, v7
  s_nop 1
  v_max_f32 v6, v6, v7
  v_max_f32 v6, v6, v57
  v_sub_f32 v7, v57, v6
  v_exp_f32 v7, v7
  v_mov_b32 v57, v6
  v_sub_f32 v16, v16, v6
  v_sub_f32 v17, v17, v6
  v_sub_f32 v18, v18, v6
  v_sub_f32 v19, v19, v6
  v_sub_f32 v20, v20, v6
  v_sub_f32 v21, v21, v6
  v_sub_f32 v22, v22, v6
  v_sub_f32 v23, v23, v6
  v_sub_f32 v24, v24, v6
  v_sub_f32 v25, v25, v6
  v_sub_f32 v26, v26, v6
  v_sub_f32 v27, v27, v6
  v_sub_f32 v28, v28, v6
  v_sub_f32 v29, v29, v6
  v_sub_f32 v30, v30, v6
  v_sub_f32 v31, v31, v6
  v_exp_f32 v16, v16
  v_exp_f32 v17, v17
  v_exp_f32 v18, v18
  v_exp_f32 v19, v19
  v_exp_f32 v20, v20
  v_exp_f32 v21, v21
  v_exp_f32 v22, v22
  v_exp_f32 v23, v23
  v_exp_f32 v24, v24
  v_exp_f32 v25, v25
  v_exp_f32 v26, v26
  v_exp_f32 v27, v27
  v_exp_f32 v28, v28
  v_exp_f32 v29, v29
  v_exp_f32 v30, v30
  v_exp_f32 v31, v31
  v_mul_f32 v80, v80, v7
  v_mul_f32 v81, v81, v7
  v_mul_f32 v82, v82, v7
  v_mul_f32 v83, v83, v7
  v_mul_f32 v84, v84, v7
  v_mul_f32 v85, v85, v7
  v_mul_f32 v86, v86, v7
  v_mul_f32 v87, v87, v7
  v_mul_f32 v88, v88, v7
  v_mul_f32 v89, v89, v7
  v_mul_f32 v90, v90, v7
  v_mul_f32 v91, v91, v7
  v_mul_f32 v92, v92, v7
  v_mul_f32 v93, v93, v7
  v_mul_f32 v94, v94, v7
  v_mul_f32 v95, v95, v7
  v_cvt_pk_bf16_f32 v48, v16, v17
  v_cvt_pk_bf16_f32 v49, v18, v19
  v_cvt_pk_bf16_f32 v50, v20, v21
  v_cvt_pk_bf16_f32 v51, v22, v23
  v_cvt_pk_bf16_f32 v52, v24, v25
  v_cvt_pk_bf16_f32 v53, v26, v27
  v_cvt_pk_bf16_f32 v54, v28, v29
  v_cvt_pk_bf16_f32 v55, v30, v31
  s_nop 1
  v_mfma_f32_32x32x16_bf16 v[80:95], a[40:43], v[48:51], v[80:95]
  v_mfma_f32_32x32x16_bf16 v[80:95], a[44:47], v[52:55], v[80:95]
  s_nop 7
  s_nop 7
  v_mfma_f32_32x32x16_bf16 v[16:31], a[32:35], a[16:19], 0
  v_mfma_f32_32x32x16_bf16 v[16:31], a[36:39], a[20:23], v[16:31]
  s_nop 7
  s_nop 7
  v_max_f32 v6, v16, v17
  v_max_f32 v6, v6, v18
  v_max_f32 v6, v6, v19
  v_max_f32 v6, v6, v20
  v_max_f32 v6, v6, v21
  v_max_f32 v6, v6, v22
  v_max_f32 v6, v6, v23
  v_max_f32 v6, v6, v24
  v_max_f32 v6, v6, v25
  v_max_f32 v6, v6, v26
  v_max_f32 v6, v6, v27
  v_max_f32 v6, v6, v28
  v_max_f32 v6, v6, v29
  v_max_f32 v6, v6, v30
  v_max_f32 v6, v6, v31
  v_mov_b32 v7, v6
  s_nop 1
  v_permlane32_swap_b32 v6, v7
  s_nop 1
  v_max_f32 v6, v6, v7
  v_max_f32 v6, v6, v58
  v_sub_f32 v7, v58, v6
  v_exp_f32 v7, v7
  v_mov_b32 v58, v6
  v_sub_f32 v16, v16, v6
  v_sub_f32 v17, v17, v6
  v_sub_f32 v18, v18, v6
  v_sub_f32 v19, v19, v6
  v_sub_f32 v20, v20, v6
  v_sub_f32 v21, v21, v6
  v_sub_f32 v22, v22, v6
  v_sub_f32 v23, v23, v6
  v_sub_f32 v24, v24, v6
  v_sub_f32 v25, v25, v6
  v_sub_f32 v26, v26, v6
  v_sub_f32 v27, v27, v6
  v_sub_f32 v28, v28, v6
  v_sub_f32 v29, v29, v6
  v_sub_f32 v30, v30, v6
  v_sub_f32 v31, v31, v6
  v_exp_f32 v16, v16
  v_exp_f32 v17, v17
  v_exp_f32 v18, v18
  v_exp_f32 v19, v19
  v_exp_f32 v20, v20
  v_exp_f32 v21, v21
  v_exp_f32 v22, v22
  v_exp_f32 v23, v23
  v_exp_f32 v24, v24
  v_exp_f32 v25, v25
  v_exp_f32 v26, v26
  v_exp_f32 v27, v27
  v_exp_f32 v28, v28
  v_exp_f32 v29, v29
  v_exp_f32 v30, v30
  v_exp_f32 v31, v31
  v_mul_f32 v96, v96, v7
  v_mul_f32 v97, v97, v7
  v_mul_f32 v98, v98, v7
  v_mul_f32 v99, v99, v7
  v_mul_f32 v100, v100, v7
  v_mul_f32 v101, v101, v7
  v_mul_f32 v102, v102, v7
  v_mul_f32 v103, v103, v7
  v_mul_f32 v104, v104, v7
  v_mul_f32 v105, v105, v7
  v_mul_f32 v106, v106, v7
  v_mul_f32 v107, v107, v7
  v_mul_f32 v108, v108, v7
  v_mul_f32 v109, v109, v7
  v_mul_f32 v110, v110, v7
  v_mul_f32 v111, v111, v7
  v_cvt_pk_bf16_f32 v48, v16, v17
  v_cvt_pk_bf16_f32 v49, v18, v19
  v_cvt_pk_bf16_f32 v50, v20, v21
  v_cvt_pk_bf16_f32 v51, v22, v23
  v_cvt_pk_bf16_f32 v52, v24, v25
  v_cvt_pk_bf16_f32 v53, v26, v27
  v_cvt_pk_bf16_f32 v54, v28, v29
  v_cvt_pk_bf16_f32 v55, v30, v31
  s_nop 1
  v_mfma_f32_32x32x16_bf16 v[96:111], a[40:43], v[48:51], v[96:111]
  v_mfma_f32_32x32x16_bf16 v[96:111], a[44:47], v[52:55], v[96:111]
  s_nop 7
  s_nop 7
  v_mfma_f32_32x32x16_bf16 v[16:31], a[32:35], a[24:27], 0
  v_mfma_f32_32x32x16_bf16 v[16:31], a[36:39], a[28:31], v[16:31]
  s_nop 7
  s_nop 7
  v_max_f32 v6, v16, v17
  v_max_f32 v6, v6, v18
  v_max_f32 v6, v6, v19
  v_max_f32 v6, v6, v20
  v_max_f32 v6, v6, v21
  v_max_f32 v6, v6, v22
  v_max_f32 v6, v6, v23
  v_max_f32 v6, v6, v24
  v_max_f32 v6, v6, v25
  v_max_f32 v6, v6, v26
  v_max_f32 v6, v6, v27
  v_max_f32 v6, v6, v28
  v_max_f32 v6, v6, v29
  v_max_f32 v6, v6, v30
  v_max_f32 v6, v6, v31
  v_mov_b32 v7, v6
  s_nop 1
  v_permlane32_swap_b32 v6, v7
  s_nop 1
  v_max_f32 v6, v6, v7
  v_max_f32 v6, v6, v59
  v_sub_f32 v7, v59, v6
  v_exp_f32 v7, v7
  v_mov_b32 v59, v6
  v_sub_f32 v16, v16, v6
  v_sub_f32 v17, v17, v6
  v_sub_f32 v18, v18, v6
  v_sub_f32 v19, v19, v6
  v_sub_f32 v20, v20, v6
  v_sub_f32 v21, v21, v6
  v_sub_f32 v22, v22, v6
  v_sub_f32 v23, v23, v6
  v_sub_f32 v24, v24, v6
  v_sub_f32 v25, v25, v6
  v_sub_f32 v26, v26, v6
  v_sub_f32 v27, v27, v6
  v_sub_f32 v28, v28, v6
  v_sub_f32 v29, v29, v6
  v_sub_f32 v30, v30, v6
  v_sub_f32 v31, v31, v6
  v_exp_f32 v16, v16
  v_exp_f32 v17, v17
  v_exp_f32 v18, v18
  v_exp_f32 v19, v19
  v_exp_f32 v20, v20
  v_exp_f32 v21, v21
  v_exp_f32 v22, v22
  v_exp_f32 v23, v23
  v_exp_f32 v24, v24
  v_exp_f32 v25, v25
  v_exp_f32 v26, v26
  v_exp_f32 v27, v27
  v_exp_f32 v28, v28
  v_exp_f32 v29, v29
  v_exp_f32 v30, v30
  v_exp_f32 v31, v31
  v_mul_f32 v112, v112, v7
  v_mul_f32 v113, v113, v7
  v_mul_f32 v114, v114, v7
  v_mul_f32 v115, v115, v7
  v_mul_f32 v116, v116, v7
  v_mul_f32 v117, v117, v7
  v_mul_f32 v118, v118, v7
  v_mul_f32 v119, v119, v7
  v_mul_f32 v120, v120, v7
  v_mul_f32 v121, v121, v7
  v_mul_f32 v122, v122, v7
  v_mul_f32 v123, v123, v7
  v_mul_f32 v124, v124, v7
  v_mul_f32 v125, v125, v7
  v_mul_f32 v126, v126, v7
  v_mul_f32 v127, v127, v7
  v_cvt_pk_bf16_f32 v48, v16, v17
  v_cvt_pk_bf16_f32 v49, v18, v19
  v_cvt_pk_bf16_f32 v50, v20, v21
  v_cvt_pk_bf16_f32 v51, v22, v23
  v_cvt_pk_bf16_f32 v52, v24, v25
  v_cvt_pk_bf16_f32 v53, v26, v27
  v_cvt_pk_bf16_f32 v54, v28, v29
  v_cvt_pk_bf16_f32 v55, v30, v31
  s_nop 1
  v_mfma_f32_32x32x16_bf16 v[112:127], a[40:43], v[48:51], v[112:127]
  v_mfma_f32_32x32x16_bf16 v[112:127], a[44:47], v[52:55], v[112:127]
  s_nop 7
  s_nop 7
  s_sub_u32 s49, s49, 1
  s_cmp_lg_u32 s49, 0
  s_cbranch_scc1 Lb_sloop
  s_xor_b32 s42, s16, 0
  s_lshl_b32 s42, s42, 7
  s_lshl_b32 s43, s16, 9
  s_add_u32 s42, s42, s43
  s_add_u32 s42, s42, 114688
  v_lshl_add_u32 v13, v2, 2, s42
  ds_write_b32 v13, v56
  s_xor_b32 s42, s16, 1
  s_lshl_b32 s42, s42, 7
  s_lshl_b32 s43, s16, 9
  s_add_u32 s42, s42, s43
  s_add_u32 s42, s42, 114688
  v_lshl_add_u32 v13, v2, 2, s42
  ds_write_b32 v13, v57
  s_xor_b32 s42, s16, 2
  s_lshl_b32 s42, s42, 7
  s_lshl_b32 s43, s16, 9
  s_add_u32 s42, s42, s43
  s_add_u32 s42, s42, 114688
  v_lshl_add_u32 v13, v2, 2, s42
  ds_write_b32 v13, v58
  s_xor_b32 s42, s16, 3
  s_lshl_b32 s42, s42, 7
  s_lshl_b32 s43, s16, 9
  s_add_u32 s42, s42, s43
  s_add_u32 s42, s42, 114688
  v_lshl_add_u32 v13, v2, 2, s42
  ds_write_b32 v13, v59
  s_waitcnt lgkmcnt(0)
  s_barrier
  s_xor_b32 s42, s16, 0
  s_lshl_b32 s42, s42, 7
  s_add_u32 s42, s42, 114688
  v_lshl_add_u32 v13, v2, 2, s42
  ds_read_b32 v16, v13 offset:0
  ds_read_b32 v17, v13 offset:512
  ds_read_b32 v18, v13 offset:1024
  ds_read_b32 v19, v13 offset:1536
  s_xor_b32 s42, s16, 1
  s_lshl_b32 s42, s42, 7
  s_add_u32 s42, s42, 114688
  v_lshl_add_u32 v13, v2, 2, s42
  ds_read_b32 v20, v13 offset:0
  ds_read_b32 v21, v13 offset:512
  ds_read_b32 v22, v13 offset:1024
  ds_read_b32 v23, v13 offset:1536
  s_xor_b32 s42, s16, 2
  s_lshl_b32 s42, s42, 7
  s_add_u32 s42, s42, 114688
  v_lshl_add_u32 v13, v2, 2, s42
  ds_read_b32 v24, v13 offset:0
  ds_read_b32 v25, v13 offset:512
  ds_read_b32 v26, v13 offset:1024
  ds_read_b32 v27, v13 offset:1536
  s_xor_b32 s42, s16, 3
  s_lshl_b32 s42, s42, 7
  s_add_u32 s42, s42, 114688
  v_lshl_add_u32 v13, v2, 2, s42
  ds_read_b32 v28, v13 offset:0
  ds_read_b32 v29, v13 offset:512
  ds_read_b32 v30, v13 offset:1024
  ds_read_b32 v31, v13 offset:1536
  s_waitcnt lgkmcnt(0)
  s_barrier
  v_max_f32 v6, v16, v17
  v_max_f32 v7, v18, v19
  v_max_f32 v6, v6, v7
  v_sub_f32 v7, v56, v6
  v_exp_f32 v7, v7
  s_nop 0
  v_mul_f32 v64, v64, v7
  v_mul_f32 v65, v65, v7
  v_mul_f32 v66, v66, v7
  v_mul_f32 v67, v67, v7
  v_mul_f32 v68, v68, v7
  v_mul_f32 v69, v69, v7
  v_mul_f32 v70, v70, v7
  v_mul_f32 v71, v71, v7
  v_mul_f32 v72, v72, v7
  v_mul_f32 v73, v73, v7
  v_mul_f32 v74, v74, v7
  v_mul_f32 v75, v75, v7
  v_mul_f32 v76, v76, v7
  v_mul_f32 v77, v77, v7
  v_mul_f32 v78, v78, v7
  v_mul_f32 v79, v79, v7
  v_max_f32 v6, v20, v21
  v_max_f32 v7, v22, v23
  v_max_f32 v6, v6, v7
  v_sub_f32 v7, v57, v6
  v_exp_f32 v7, v7
  s_nop 0
  v_mul_f32 v80, v80, v7
  v_mul_f32 v81, v81, v7
  v_mul_f32 v82, v82, v7
  v_mul_f32 v83, v83, v7
  v_mul_f32 v84, v84, v7
  v_mul_f32 v85, v85, v7
  v_mul_f32 v86, v86, v7
  v_mul_f32 v87, v87, v7
  v_mul_f32 v88, v88, v7
  v_mul_f32 v89, v89, v7
  v_mul_f32 v90, v90, v7
  v_mul_f32 v91, v91, v7
  v_mul_f32 v92, v92, v7
  v_mul_f32 v93, v93, v7
  v_mul_f32 v94, v94, v7
  v_mul_f32 v95, v95, v7
  v_max_f32 v6, v24, v25
  v_max_f32 v7, v26, v27
  v_max_f32 v6, v6, v7
  v_sub_f32 v7, v58, v6
  v_exp_f32 v7, v7
  s_nop 0
  v_mul_f32 v96, v96, v7
  v_mul_f32 v97, v97, v7
  v_mul_f32 v98, v98, v7
  v_mul_f32 v99, v99, v7
  v_mul_f32 v100, v100, v7
  v_mul_f32 v101, v101, v7
  v_mul_f32 v102, v102, v7
  v_mul_f32 v103, v103, v7
  v_mul_f32 v104, v104, v7
  v_mul_f32 v105, v105, v7
  v_mul_f32 v106, v106, v7
  v_mul_f32 v107, v107, v7
  v_mul_f32 v108, v108, v7
  v_mul_f32 v109, v109, v7
  v_mul_f32 v110, v110, v7
  v_mul_f32 v111, v111, v7
  v_max_f32 v6, v28, v29
  v_max_f32 v7, v30, v31
  v_max_f32 v6, v6, v7
  v_sub_f32 v7, v59, v6
  v_exp_f32 v7, v7
  s_nop 0
  v_mul_f32 v112, v112, v7
  v_mul_f32 v113, v113, v7
  v_mul_f32 v114, v114, v7
  v_mul_f32 v115, v115, v7
  v_mul_f32 v116, v116, v7
  v_mul_f32 v117, v117, v7
  v_mul_f32 v118, v118, v7
  v_mul_f32 v119, v119, v7
  v_mul_f32 v120, v120, v7
  v_mul_f32 v121, v121, v7
  v_mul_f32 v122, v122, v7
  v_mul_f32 v123, v123, v7
  v_mul_f32 v124, v124, v7
  v_mul_f32 v125, v125, v7
  v_mul_f32 v126, v126, v7
  v_mul_f32 v127, v127, v7
  ds_write_b128 v9, v[80:83] offset:0
  ds_write_b128 v9, v[84:87] offset:1024
  ds_write_b128 v9, v[88:91] offset:2048
  ds_write_b128 v9, v[92:95] offset:3072
  ds_write_b128 v10, v[96:99] offset:0
  ds_write_b128 v10, v[100:103] offset:1024
  ds_write_b128 v10, v[104:107] offset:2048
  ds_write_b128 v10, v[108:111] offset:3072
  ds_write_b128 v11, v[112:115] offset:0
  ds_write_b128 v11, v[116:119] offset:1024
  ds_write_b128 v11, v[120:123] offset:2048
  ds_write_b128 v11, v[124:127] offset:3072
  s_branch Lb_reduce
Lb_done:
Lmain_attnx:
  s_cmp_ge_u32 s2, 224
  s_cbranch_scc1 Lmain_idle
  s_and_b32 s25, s2, 7
  s_lshl_b32 s25, s25, 2
  s_bfe_u32 s26, s2, 0x20003
  s_add_u32 s25, s25, s26
  s_lshr_b32 s26, s2, 5
  s_min_u32 s26, s26, 6
  s_lshr_b32 s32, s16, 1
  s_and_b32 s33, s16, 1
  s_lshl_b32 s34, s25, 1
  s_add_u32 s34, s34, s33
  s_lshl_b32 s35, s26, 1
  s_add_u32 s35, s35, s32
  s_lshl_b32 s36, s3, 1
  s_mul_i32 s36, s36, s19
  s_add_u32 s36, s36, 0x500000
  s_mul_i32 s37, s34, 28
  s_lshl_b32 s38, s35, 1
  s_add_u32 s37, s37, s38
  s_lshl_b32 s37, s37, 10
  s_add_u32 s36, s36, s37
  s_and_b32 s27, s16, 1
  s_xor_b32 s27, s27, 0
  s_lshl_b32 s28, s25, 1
  s_add_u32 s27, s27, s28
  s_lshl_b32 s27, s27, 15
  s_lshl_b32 s28, s16, 13
  s_add_u32 s27, s27, s28
  s_mul_i32 s28, s3, 0x200000
  s_add_u32 s27, s27, s28
  s_add_u32 s40, s27, 0x1a00000
  s_and_b32 s27, s16, 1
  s_xor_b32 s27, s27, 1
  s_lshl_b32 s28, s25, 1
  s_add_u32 s27, s27, s28
  s_lshl_b32 s27, s27, 15
  s_lshl_b32 s28, s16, 13
  s_add_u32 s27, s27, s28
  s_mul_i32 s28, s3, 0x200000
  s_add_u32 s27, s27, s28
  s_add_u32 s41, s27, 0x1a00000
  s_lshr_b32 s29, s25, 1
  s_mul_i32 s30, s3, 10240
  s_add_u32 s30, s30, 0xd10800
  s_lshl_b32 s31, s29, 7
  s_add_u32 s30, s30, s31
  s_add_u32 s44, s36, s19
  s_mul_i32 s45, s3, 0x80000
  s_add_u32 s45, s45, 0xc40000
  s_lshl_b32 s39, s35, 14
  s_add_u32 s45, s45, s39
  s_lshl_b32 s39, s34, 8
  s_add_u32 s45, s45, s39
  v_lshlrev_b32 v116, 3, v2
  s_xor_b32 s60, s16, 1
  s_mul_i32 s60, s60, 12288
  s_add_u32 s60, s60, 114688
  v_add_u32 v112, s60, v4
  s_xor_b32 s60, s16, 2
  s_mul_i32 s60, s60, 12288
  s_add_u32 s60, s60, 118784
  v_add_u32 v113, s60, v4
  s_xor_b32 s60, s16, 3
  s_mul_i32 s60, s60, 12288
  s_add_u32 s60, s60, 122880
  v_add_u32 v114, s60, v4
  s_mul_i32 s60, s16, 12288
  s_add_u32 s60, s60, 114688
  v_add_u32 v115, s60, v4
  s_and_b32 s31, s25, 1
  s_mul_i32 s31, s31, 7
  s_add_u32 s31, s31, s26
  s_mul_i32 s46, s3, 10240
  s_add_u32 s46, s46, 0xd11000
  s_lshl_b32 s63, s29, 7
  s_add_u32 s46, s46, s63
  s_lshl_b32 s63, s31, 2
  s_add_u32 s46, s46, s63
  s_cmp_lg_u32 s16, 0
  s_cbranch_scc1 Lo_fa_oth
  v_min_u32 v6, 15, v1
  v_lshlrev_b32 v6, 2, v6
  s_mov_b32 s62, 0
Lo_fa_poll:
  buffer_load_dword v7, v6, s[8:11], s30 offen sc1
  s_add_u32 s62, s62, 1
  s_cmp_gt_u32 s62, 300000
  s_cbranch_scc1 Lo_fa_to
  s_waitcnt vmcnt(0)
  v_cmp_ne_u32 vcc, s66, v7
  s_cbranch_vccnz Lo_fa_poll
Lo_fa_to:
  s_waitcnt vmcnt(0)
  s_branch Lo_fa_go
Lo_fa_oth:
  s_waitcnt vmcnt(0)
Lo_fa_go:
  s_barrier
  buffer_load_dwordx4 a[0:3], v4, s[8:11], s40 offen offset:0 sc1
  buffer_load_dwordx4 a[32:35], v4, s[8:11], s41 offen offset:0 sc1
  buffer_load_dwordx4 a[4:7], v4, s[8:11], s40 offen offset:1024 sc1
  buffer_load_dwordx4 a[36:39], v4, s[8:11], s41 offen offset:1024 sc1
  buffer_load_dwordx4 a[8:11], v4, s[8:11], s40 offen offset:2048 sc1
  buffer_load_dwordx4 a[40:43], v4, s[8:11], s41 offen offset:2048 sc1
  buffer_load_dwordx4 a[12:15], v4, s[8:11], s40 offen offset:3072 sc1
  buffer_load_dwordx4 a[44:47], v4, s[8:11], s41 offen offset:3072 sc1
  s_waitcnt vmcnt(6)
  v_mfma_f32_32x32x16_bf16 v[16:31], v[192:195], a[0:3], 0
  v_mfma_f32_32x32x16_bf16 v[32:47], v[192:195], a[32:35], 0
  s_add_u32 s40, s40, 4096
  buffer_load_dwordx4 a[16:19], v4, s[8:11], s40 offen offset:0 sc1
  s_add_u32 s41, s41, 4096
  buffer_load_dwordx4 a[48:51], v4, s[8:11], s41 offen offset:0 sc1
  v_mfma_f32_32x32x16_bf16 v[48:63], v[224:227], a[0:3], 0
  v_mfma_f32_32x32x16_bf16 v[64:79], v[224:227], a[32:35], 0
  buffer_load_dwordx4 a[20:23], v4, s[8:11], s40 offen offset:1024 sc1
  buffer_load_dwordx4 a[52:55], v4, s[8:11], s41 offen offset:1024 sc1
  s_waitcnt vmcnt(8)
  v_mfma_f32_32x32x16_bf16 v[16:31], v[196:199], a[4:7], v[16:31]
  v_mfma_f32_32x32x16_bf16 v[32:47], v[196:199], a[36:39], v[32:47]
  buffer_load_dwordx4 a[24:27], v4, s[8:11], s40 offen offset:2048 sc1
  buffer_load_dwordx4 a[56:59], v4, s[8:11], s41 offen offset:2048 sc1
  v_mfma_f32_32x32x16_bf16 v[48:63], v[228:231], a[4:7], v[48:63]
  v_mfma_f32_32x32x16_bf16 v[64:79], v[228:231], a[36:39], v[64:79]
  buffer_load_dwordx4 a[28:31], v4, s[8:11], s40 offen offset:3072 sc1
  buffer_load_dwordx4 a[60:63], v4, s[8:11], s41 offen offset:3072 sc1
  buffer_load_dwordx4 v[80:83], v4, s[8:11], s36 offen sc1
  buffer_load_dwordx4 v[84:87], v4, s[8:11], s36 offen offset:1024 sc1
  s_waitcnt vmcnt(12)
  v_mfma_f32_32x32x16_bf16 v[16:31], v[200:203], a[8:11], v[16:31]
  v_mfma_f32_32x32x16_bf16 v[32:47], v[200:203], a[40:43], v[32:47]
  v_mfma_f32_32x32x16_bf16 v[48:63], v[232:235], a[8:11], v[48:63]
  v_mfma_f32_32x32x16_bf16 v[64:79], v[232:235], a[40:43], v[64:79]
  s_waitcnt vmcnt(10)
  v_mfma_f32_32x32x16_bf16 v[16:31], v[204:207], a[12:15], v[16:31]
  v_mfma_f32_32x32x16_bf16 v[32:47], v[204:207], a[44:47], v[32:47]
  v_mfma_f32_32x32x16_bf16 v[48:63], v[236:239], a[12:15], v[48:63]
  v_mfma_f32_32x32x16_bf16 v[64:79], v[236:239], a[44:47], v[64:79]
  s_waitcnt vmcnt(2)
  v_mfma_f32_32x32x16_bf16 v[32:47], v[208:211], a[48:51], v[32:47]
  v_mfma_f32_32x32x16_bf16 v[32:47], v[212:215], a[52:55], v[32:47]
  v_mfma_f32_32x32x16_bf16 v[32:47], v[216:219], a[56:59], v[32:47]
  v_mfma_f32_32x32x16_bf16 v[32:47], v[220:223], a[60:63], v[32:47]
  v_mfma_f32_32x32x16_bf16 v[48:63], v[240:243], a[16:19], v[48:63]
  v_mfma_f32_32x32x16_bf16 v[48:63], v[244:247], a[20:23], v[48:63]
  v_mfma_f32_32x32x16_bf16 v[48:63], v[248:251], a[24:27], v[48:63]
  v_mfma_f32_32x32x16_bf16 v[48:63], v[252:255], a[28:31], v[48:63]
  s_nop 7
  ds_write_b128 v112, v[32:35] offset:0
  ds_write_b128 v112, v[36:39] offset:1024
  ds_write_b128 v112, v[40:43] offset:2048
  ds_write_b128 v112, v[44:47] offset:3072
  v_mfma_f32_32x32x16_bf16 v[64:79], v[240:243], a[48:51], v[64:79]
  v_mfma_f32_32x32x16_bf16 v[64:79], v[244:247], a[52:55], v[64:79]
  v_mfma_f32_32x32x16_bf16 v[64:79], v[248:251], a[56:59], v[64:79]
  v_mfma_f32_32x32x16_bf16 v[64:79], v[252:255], a[60:63], v[64:79]
  s_nop 7
  ds_write_b128 v113, v[48:51] offset:0
  ds_write_b128 v113, v[52:55] offset:1024
  ds_write_b128 v113, v[56:59] offset:2048
  ds_write_b128 v113, v[60:63] offset:3072
  v_mfma_f32_32x32x16_bf16 v[16:31], v[208:211], a[16:19], v[16:31]
  v_mfma_f32_32x32x16_bf16 v[16:31], v[212:215], a[20:23], v[16:31]
  v_mfma_f32_32x32x16_bf16 v[16:31], v[216:219], a[24:27], v[16:31]
  v_mfma_f32_32x32x16_bf16 v[16:31], v[220:223], a[28:31], v[16:31]
  s_nop 7
  ds_write_b128 v114, v[64:67] offset:0
  ds_write_b128 v114, v[68:71] offset:1024
  ds_write_b128 v114, v[72:75] offset:2048
  ds_write_b128 v114, v[76:79] offset:3072
  s_waitcnt lgkmcnt(0)
  s_barrier
  ds_read_b128 v[32:35], v115 offset:0
  ds_read_b128 v[36:39], v115 offset:1024
  ds_read_b128 v[40:43], v115 offset:2048
  ds_read_b128 v[44:47], v115 offset:3072
  ds_read_b128 v[48:51], v115 offset:4096
  ds_read_b128 v[52:55], v115 offset:5120
  ds_read_b128 v[56:59], v115 offset:6144
  ds_read_b128 v[60:63], v115 offset:7168
  ds_read_b128 v[64:67], v115 offset:8192
  ds_read_b128 v[68:71], v115 offset:9216
  ds_read_b128 v[72:75], v115 offset:10240
  ds_read_b128 v[76:79], v115 offset:11264
  s_waitcnt lgkmcnt(8)
  v_pk_add_f32 v[16:17], v[16:17], v[32:33]
  v_pk_add_f32 v[18:19], v[18:19], v[34:35]
  v_pk_add_f32 v[20:21], v[20:21], v[36:37]
  v_pk_add_f32 v[22:23], v[22:23], v[38:39]
  v_pk_add_f32 v[24:25], v[24:25], v[40:41]
  v_pk_add_f32 v[26:27], v[26:27], v[42:43]
  v_pk_add_f32 v[28:29], v[28:29], v[44:45]
  v_pk_add_f32 v[30:31], v[30:31], v[46:47]
  s_waitcnt lgkmcnt(4)
  v_pk_add_f32 v[16:17], v[16:17], v[48:49]
  v_pk_add_f32 v[18:19], v[18:19], v[50:51]
  v_pk_add_f32 v[20:21], v[20:21], v[52:53]
  v_pk_add_f32 v[22:23], v[22:23], v[54:55]
  v_pk_add_f32 v[24:25], v[24:25], v[56:57]
  v_pk_add_f32 v[26:27], v[26:27], v[58:59]
  v_pk_add_f32 v[28:29], v[28:29], v[60:61]
  v_pk_add_f32 v[30:31], v[30:31], v[62:63]
  s_waitcnt lgkmcnt(0)
  v_pk_add_f32 v[16:17], v[16:17], v[64:65]
  v_pk_add_f32 v[18:19], v[18:19], v[66:67]
  v_pk_add_f32 v[20:21], v[20:21], v[68:69]
  v_pk_add_f32 v[22:23], v[22:23], v[70:71]
  v_pk_add_f32 v[24:25], v[24:25], v[72:73]
  v_pk_add_f32 v[26:27], v[26:27], v[74:75]
  v_pk_add_f32 v[28:29], v[28:29], v[76:77]
  v_pk_add_f32 v[30:31], v[30:31], v[78:79]
  s_waitcnt vmcnt(0)
  v_lshlrev_b32 v32, 16, v80
  v_and_b32 v33, 0xffff0000, v80
  v_lshlrev_b32 v34, 16, v81
  v_and_b32 v35, 0xffff0000, v81
  v_lshlrev_b32 v36, 16, v82
  v_and_b32 v37, 0xffff0000, v82
  v_lshlrev_b32 v38, 16, v83
  v_and_b32 v39, 0xffff0000, v83
  v_lshlrev_b32 v40, 16, v84
  v_and_b32 v41, 0xffff0000, v84
  v_lshlrev_b32 v42, 16, v85
  v_and_b32 v43, 0xffff0000, v85
  v_lshlrev_b32 v44, 16, v86
  v_and_b32 v45, 0xffff0000, v86
  v_lshlrev_b32 v46, 16, v87
  v_and_b32 v47, 0xffff0000, v87
  v_pk_add_f32 v[16:17], v[16:17], v[32:33]
  v_pk_add_f32 v[18:19], v[18:19], v[34:35]
  v_pk_add_f32 v[20:21], v[20:21], v[36:37]
  v_pk_add_f32 v[22:23], v[22:23], v[38:39]
  v_pk_add_f32 v[24:25], v[24:25], v[40:41]
  v_pk_add_f32 v[26:27], v[26:27], v[42:43]
  v_pk_add_f32 v[28:29], v[28:29], v[44:45]
  v_pk_add_f32 v[30:31], v[30:31], v[46:47]
  v_cvt_pk_bf16_f32 v80, v16, v17
  v_cvt_pk_bf16_f32 v81, v18, v19
  v_cvt_pk_bf16_f32 v82, v20, v21
  v_cvt_pk_bf16_f32 v83, v22, v23
  v_cvt_pk_bf16_f32 v84, v24, v25
  v_cvt_pk_bf16_f32 v85, v26, v27
  v_cvt_pk_bf16_f32 v86, v28, v29
  v_cvt_pk_bf16_f32 v87, v30, v31
  buffer_store_dwordx4 v[80:83], v4, s[8:11], s44 offen
  buffer_store_dwordx4 v[84:87], v4, s[8:11], s44 offen offset:1024
  v_pk_add_f32 v[32:33], v[16:17], v[18:19]
  v_pk_mul_f32 v[34:35], v[16:17], v[16:17]
  v_pk_fma_f32 v[34:35], v[18:19], v[18:19], v[34:35]
  v_pk_add_f32 v[32:33], v[32:33], v[20:21]
  v_pk_fma_f32 v[34:35], v[20:21], v[20:21], v[34:35]
  v_pk_add_f32 v[32:33], v[32:33], v[22:23]
  v_pk_fma_f32 v[34:35], v[22:23], v[22:23], v[34:35]
  v_pk_add_f32 v[32:33], v[32:33], v[24:25]
  v_pk_fma_f32 v[34:35], v[24:25], v[24:25], v[34:35]
  v_pk_add_f32 v[32:33], v[32:33], v[26:27]
  v_pk_fma_f32 v[34:35], v[26:27], v[26:27], v[34:35]
  v_pk_add_f32 v[32:33], v[32:33], v[28:29]
  v_pk_fma_f32 v[34:35], v[28:29], v[28:29], v[34:35]
  v_pk_add_f32 v[32:33], v[32:33], v[30:31]
  v_pk_fma_f32 v[34:35], v[30:31], v[30:31], v[34:35]
  v_add_f32 v36, v32, v33
  v_add_f32 v37, v34, v35
  v_mov_b32 v38, v36
  v_mov_b32 v39, v37
  s_nop 1
  v_permlane32_swap_b32 v36, v38
  v_permlane32_swap_b32 v37, v39
  s_nop 1
  v_pk_add_f32 v[36:37], v[36:37], v[38:39]
  s_mov_b32 exec_hi, 0
  buffer_store_dwordx2 v[36:37], v116, s[8:11], s45 offen
  s_mov_b64 exec, -1
  v_mov_b32 v6, 0
  v_mov_b32 v7, s66
  s_lshl_b32 s61, s16, 1
  s_or_b32 s61, s61, s18
  s_cmp_eq_u32 s61, 0
  s_waitcnt vmcnt(0)
  s_barrier
  s_cbranch_scc0 Lo_fo_oth
  s_mov_b64 exec, 1
  buffer_store_dword v7, v6, s[8:11], s46 offen
  s_mov_b64 exec, -1
  s_branch Lo_fo_nf
Lo_fo_oth:
  s_cmp_lg_u32 s16, 0
  s_cbranch_scc1 Lo_fo_nf
  buffer_wbl2 sc1
  s_waitcnt vmcnt(0)
  s_mov_b64 exec, 1
  buffer_store_dword v7, v6, s[8:11], s46 offen sc1
  s_mov_b64 exec, -1
Lo_fo_nf:
  s_and_b32 s25, s2, 7
  s_lshl_b32 s25, s25, 1
  s_bfe_u32 s26, s2, 0x10003
  s_add_u32 s25, s25, s26
  s_lshr_b32 s26, s2, 4
  s_lshl_b32 s27, s25, 2
  s_add_u32 s27, s27, s16
  s_mul_i32 s28, s3, 0x80000
  s_add_u32 s28, s28, 0xc40000
  s_lshl_b32 s29, s27, 8
  s_add_u32 s28, s28, s29
  s_lshl_b32 s32, s3, 1
  s_add_u32 s32, s32, 1
  s_mul_i32 s32, s32, s19
  s_add_u32 s32, s32, 0x500000
  s_mul_i32 s33, s27, 28672
  s_add_u32 s32, s32, s33
  s_and_b32 s49, s2, 7
  s_mul_i32 s47, s49, 917504
  s_lshl_b32 s48, s19, 2
  s_mul_i32 s48, s48, s3
  s_add_u32 s47, s47, s48
  s_add_u32 s47, s47, 0x1e00000
  s_mov_b32 s48, s47
  s_and_b32 s36, s27, 7
  s_mul_i32 s36, s36, 112
  s_lshl_b32 s37, s26, 3
  s_add_u32 s36, s36, s37
  s_cmp_lt_u32 s36, 768
  s_cselect_b32 s35, s47, s48
  s_lshl_b32 s36, s36, 10
  s_add_u32 s35, s35, s36
  s_mul_i32 s30, s3, 10240
  s_add_u32 s30, s30, 0xd11000
  s_lshl_b32 s63, s25, 7
  s_add_u32 s30, s30, s63
  s_cmp_lg_u32 s16, 0
  s_cbranch_scc1 L1_fo_oth
  v_min_u32 v6, 13, v1
  v_lshlrev_b32 v6, 2, v6
  s_mov_b32 s62, 0
L1_fo_poll:
  buffer_load_dword v7, v6, s[8:11], s30 offen sc1
  s_add_u32 s62, s62, 1
  s_cmp_gt_u32 s62, 300000
  s_cbranch_scc1 L1_fo_to
  s_waitcnt vmcnt(0)
  v_cmp_ne_u32 vcc, s66, v7
  s_cbranch_vccnz L1_fo_poll
L1_fo_to:
  s_waitcnt vmcnt(0)
  s_branch L1_fo_go
L1_fo_oth:
  s_waitcnt vmcnt(0)
L1_fo_go:
  s_barrier
  buffer_load_dwordx4 a[0:3], v4, s[8:11], s32 offen offset:0 sc1
  buffer_load_dwordx4 a[4:7], v4, s[8:11], s32 offen offset:1024 sc1
  buffer_load_dwordx4 a[8:11], v4, s[8:11], s32 offen offset:2048 sc1
  buffer_load_dwordx4 a[12:15], v4, s[8:11], s32 offen offset:3072 sc1
  s_add_u32 s32, s32, 4096
  buffer_load_dwordx4 a[16:19], v4, s[8:11], s32 offen offset:0 sc1
  buffer_load_dwordx4 a[20:23], v4, s[8:11], s32 offen offset:1024 sc1
  buffer_load_dwordx4 a[24:27], v4, s[8:11], s32 offen offset:2048 sc1
  buffer_load_dwordx4 a[28:31], v4, s[8:11], s32 offen offset:3072 sc1
  s_add_u32 s32, s32, 4096
  v_add_u32 v11, 57344, v4
  ds_read_b128 v[80:83], v4 offset:0
  ds_read_b128 v[84:87], v4 offset:28672
  ds_read_b128 v[88:91], v4 offset:1024
  ds_read_b128 v[92:95], v4 offset:29696
  s_waitcnt vmcnt(7)
  s_waitcnt lgkmcnt(2)
  v_mfma_f32_32x32x16_bf16 v[16:31], v[80:83], a[0:3], 0
  v_mfma_f32_32x32x16_bf16 v[32:47], v[84:87], a[0:3], 0
  buffer_load_dwordx4 a[32:35], v4, s[8:11], s32 offen offset:0 sc1
  buffer_load_dwordx4 a[36:39], v4, s[8:11], s32 offen offset:1024 sc1
  ds_read_b128 v[80:83], v4 offset:2048
  ds_read_b128 v[84:87], v4 offset:30720
  s_waitcnt vmcnt(8)
  s_waitcnt lgkmcnt(2)
  v_mfma_f32_32x32x16_bf16 v[16:31], v[88:91], a[4:7], v[16:31]
  v_mfma_f32_32x32x16_bf16 v[32:47], v[92:95], a[4:7], v[32:47]
  buffer_load_dwordx4 a[40:43], v4, s[8:11], s32 offen offset:2048 sc1
  buffer_load_dwordx4 a[44:47], v4, s[8:11], s32 offen offset:3072 sc1
  s_add_u32 s32, s32, 4096
  ds_read_b128 v[88:91], v4 offset:3072
  ds_read_b128 v[92:95], v4 offset:31744
  s_waitcnt vmcnt(9)
  s_waitcnt lgkmcnt(2)
  v_mfma_f32_32x32x16_bf16 v[16:31], v[80:83], a[8:11], v[16:31]
  v_mfma_f32_32x32x16_bf16 v[32:47], v[84:87], a[8:11], v[32:47]
  buffer_load_dwordx4 a[48:51], v4, s[8:11], s32 offen offset:0 sc1
  buffer_load_dwordx4 a[52:55], v4, s[8:11], s32 offen offset:1024 sc1
  ds_read_b128 v[80:83], v4 offset:4096
  ds_read_b128 v[84:87], v4 offset:32768
  s_waitcnt vmcnt(10)
  s_waitcnt lgkmcnt(2)
  v_mfma_f32_32x32x16_bf16 v[16:31], v[88:91], a[12:15], v[16:31]
  v_mfma_f32_32x32x16_bf16 v[32:47], v[92:95], a[12:15], v[32:47]
  buffer_load_dwordx4 a[56:59], v4, s[8:11], s32 offen offset:2048 sc1
  buffer_load_dwordx4 a[60:63], v4, s[8:11], s32 offen offset:3072 sc1
  s_add_u32 s32, s32, 4096
  ds_read_b128 v[88:91], v4 offset:5120
  ds_read_b128 v[92:95], v4 offset:33792
  s_waitcnt vmcnt(11)
  s_waitcnt lgkmcnt(2)
  v_mfma_f32_32x32x16_bf16 v[16:31], v[80:83], a[16:19], v[16:31]
  v_mfma_f32_32x32x16_bf16 v[32:47], v[84:87], a[16:19], v[32:47]
  buffer_load_dwordx4 a[64:67], v4, s[8:11], s32 offen offset:0 sc1
  ds_read_b128 v[80:83], v4 offset:6144
  ds_read_b128 v[84:87], v4 offset:34816
  s_waitcnt vmcnt(11)
  s_waitcnt lgkmcnt(2)
  v_mfma_f32_32x32x16_bf16 v[16:31], v[88:91], a[20:23], v[16:31]
  v_mfma_f32_32x32x16_bf16 v[32:47], v[92:95], a[20:23], v[32:47]
  buffer_load_dwordx4 a[68:71], v4, s[8:11], s32 offen offset:1024 sc1
  ds_read_b128 v[88:91], v4 offset:7168
  ds_read_b128 v[92:95], v4 offset:35840
  s_waitcnt vmcnt(11)
  s_waitcnt lgkmcnt(2)
  v_mfma_f32_32x32x16_bf16 v[16:31], v[80:83], a[24:27], v[16:31]
  v_mfma_f32_32x32x16_bf16 v[32:47], v[84:87], a[24:27], v[32:47]
  buffer_load_dwordx4 a[72:75], v4, s[8:11], s32 offen offset:2048 sc1
  ds_read_b128 v[80:83], v4 offset:8192
  ds_read_b128 v[84:87], v4 offset:36864
  s_waitcnt vmcnt(11)
  s_waitcnt lgkmcnt(2)
  v_mfma_f32_32x32x16_bf16 v[16:31], v[88:91], a[28:31], v[16:31]
  v_mfma_f32_32x32x16_bf16 v[32:47], v[92:95], a[28:31], v[32:47]
  buffer_load_dwordx4 a[76:79], v4, s[8:11], s32 offen offset:3072 sc1
  s_add_u32 s32, s32, 4096
  ds_read_b128 v[88:91], v4 offset:9216
  ds_read_b128 v[92:95], v4 offset:37888
  s_waitcnt vmcnt(11)
  s_waitcnt lgkmcnt(2)
  v_mfma_f32_32x32x16_bf16 v[16:31], v[80:83], a[32:35], v[16:31]
  v_mfma_f32_32x32x16_bf16 v[32:47], v[84:87], a[32:35], v[32:47]
  buffer_load_dwordx4 a[80:83], v4, s[8:11], s32 offen offset:0 sc1
  ds_read_b128 v[80:83], v4 offset:10240
  ds_read_b128 v[84:87], v4 offset:38912
  s_waitcnt vmcnt(11)
  s_waitcnt lgkmcnt(2)
  v_mfma_f32_32x32x16_bf16 v[16:31], v[88:91], a[36:39], v[16:31]
  v_mfma_f32_32x32x16_bf16 v[32:47], v[92:95], a[36:39], v[32:47]
  buffer_load_dwordx4 a[84:87], v4, s[8:11], s32 offen offset:1024 sc1
  ds_read_b128 v[88:91], v4 offset:11264
  ds_read_b128 v[92:95], v4 offset:39936
  s_waitcnt vmcnt(11)
  s_waitcnt lgkmcnt(2)
  v_mfma_f32_32x32x16_bf16 v[16:31], v[80:83], a[40:43], v[16:31]
  v_mfma_f32_32x32x16_bf16 v[32:47], v[84:87], a[40:43], v[32:47]
  buffer_load_dwordx4 a[88:91], v4, s[8:11], s32 offen offset:2048 sc1
  ds_read_b128 v[80:83], v4 offset:12288
  ds_read_b128 v[84:87], v4 offset:40960
  s_waitcnt vmcnt(11)
  s_waitcnt lgkmcnt(2)
  v_mfma_f32_32x32x16_bf16 v[16:31], v[88:91], a[44:47], v[16:31]
  v_mfma_f32_32x32x16_bf16 v[32:47], v[92:95], a[44:47], v[32:47]
  buffer_load_dwordx4 a[92:95], v4, s[8:11], s32 offen offset:3072 sc1
  s_add_u32 s32, s32, 4096
  ds_read_b128 v[88:91], v4 offset:13312
  ds_read_b128 v[92:95], v4 offset:41984
  s_waitcnt vmcnt(11)
  s_waitcnt lgkmcnt(2)
  v_mfma_f32_32x32x16_bf16 v[16:31], v[80:83], a[48:51], v[16:31]
  v_mfma_f32_32x32x16_bf16 v[32:47], v[84:87], a[48:51], v[32:47]
  buffer_load_dwordx4 v[192:195], v4, s[8:11], s32 offen offset:0 sc1
  ds_read_b128 v[80:83], v4 offset:14336
  ds_read_b128 v[84:87], v4 offset:43008
  s_waitcnt vmcnt(11)
  s_waitcnt lgkmcnt(2)
  v_mfma_f32_32x32x16_bf16 v[16:31], v[88:91], a[52:55], v[16:31]
  v_mfma_f32_32x32x16_bf16 v[32:47], v[92:95], a[52:55], v[32:47]
  buffer_load_dwordx4 v[196:199], v4, s[8:11], s32 offen offset:1024 sc1
  ds_read_b128 v[88:91], v4 offset:15360
  ds_read_b128 v[92:95], v4 offset:44032
  s_waitcnt vmcnt(11)
  s_waitcnt lgkmcnt(2)
  v_mfma_f32_32x32x16_bf16 v[16:31], v[80:83], a[56:59], v[16:31]
  v_mfma_f32_32x32x16_bf16 v[32:47], v[84:87], a[56:59], v[32:47]
  buffer_load_dwordx4 v[200:203], v4, s[8:11], s32 offen offset:2048 sc1
  ds_read_b128 v[80:83], v4 offset:16384
  ds_read_b128 v[84:87], v4 offset:45056
  s_waitcnt vmcnt(11)
  s_waitcnt lgkmcnt(2)
  v_mfma_f32_32x32x16_bf16 v[16:31], v[88:91], a[60:63], v[16:31]
  v_mfma_f32_32x32x16_bf16 v[32:47], v[92:95], a[60:63], v[32:47]
  buffer_load_dwordx4 v[204:207], v4, s[8:11], s32 offen offset:3072 sc1
  s_add_u32 s32, s32, 4096
  ds_read_b128 v[88:91], v4 offset:17408
  ds_read_b128 v[92:95], v4 offset:46080
  s_waitcnt vmcnt(11)
  s_waitcnt lgkmcnt(2)
  v_mfma_f32_32x32x16_bf16 v[16:31], v[80:83], a[64:67], v[16:31]
  v_mfma_f32_32x32x16_bf16 v[32:47], v[84:87], a[64:67], v[32:47]
  ds_read_b128 v[80:83], v4 offset:18432
  ds_read_b128 v[84:87], v4 offset:47104
  s_waitcnt vmcnt(10)
  s_waitcnt lgkmcnt(2)
  v_mfma_f32_32x32x16_bf16 v[16:31], v[88:91], a[68:71], v[16:31]
  v_mfma_f32_32x32x16_bf16 v[32:47], v[92:95], a[68:71], v[32:47]
  ds_read_b128 v[88:91], v4 offset:19456
  ds_read_b128 v[92:95], v4 offset:48128
  s_waitcnt vmcnt(9)
  s_waitcnt lgkmcnt(2)
  v_mfma_f32_32x32x16_bf16 v[16:31], v[80:83], a[72:75], v[16:31]
  v_mfma_f32_32x32x16_bf16 v[32:47], v[84:87], a[72:75], v[32:47]
  s_mov_b32 s29, s28
  buffer_load_dwordx2 v[208:209], v5, s[8:11], s29 offen sc1
  s_add_u32 s29, s29, 32768
  buffer_load_dwordx2 v[210:211], v5, s[8:11], s29 offen sc1
  s_add_u32 s29, s29, 32768
  buffer_load_dwordx2 v[212:213], v5, s[8:11], s29 offen sc1
  s_add_u32 s29, s29, 32768
  buffer_load_dwordx2 v[214:215], v5, s[8:11], s29 offen sc1
  s_add_u32 s29, s29, 32768
  buffer_load_dwordx2 v[216:217], v5, s[8:11], s29 offen sc1
  s_add_u32 s29, s29, 32768
  buffer_load_dwordx2 v[218:219], v5, s[8:11], s29 offen sc1
  s_add_u32 s29, s29, 32768
  buffer_load_dwordx2 v[220:221], v5, s[8:11], s29 offen sc1
  v_lshlrev_b32 v15, 7, v1
  buffer_load_dword v14, v15, s[8:11], s35 offen sc1
  ds_read_b128 v[80:83], v4 offset:20480
  ds_read_b128 v[84:87], v4 offset:49152
  s_waitcnt vmcnt(16)
  s_waitcnt lgkmcnt(2)
  v_mfma_f32_32x32x16_bf16 v[16:31], v[88:91], a[76:79], v[16:31]
  v_mfma_f32_32x32x16_bf16 v[32:47], v[92:95], a[76:79], v[32:47]
  ds_read_b128 v[88:91], v4 offset:21504
  ds_read_b128 v[92:95], v4 offset:50176
  s_waitcnt vmcnt(15)
  s_waitcnt lgkmcnt(2)
  v_mfma_f32_32x32x16_bf16 v[16:31], v[80:83], a[80:83], v[16:31]
  v_mfma_f32_32x32x16_bf16 v[32:47], v[84:87], a[80:83], v[32:47]
  ds_read_b128 v[80:83], v4 offset:22528
  ds_read_b128 v[84:87], v4 offset:51200
  s_waitcnt vmcnt(14)
  s_waitcnt lgkmcnt(2)
  v_mfma_f32_32x32x16_bf16 v[16:31], v[88:91], a[84:87], v[16:31]
  v_mfma_f32_32x32x16_bf16 v[32:47], v[92:95], a[84:87], v[32:47]
  ds_read_b128 v[88:91], v4 offset:23552
  ds_read_b128 v[92:95], v4 offset:52224
  s_waitcnt vmcnt(13)
  s_waitcnt lgkmcnt(2)
  v_mfma_f32_32x32x16_bf16 v[16:31], v[80:83], a[88:91], v[16:31]
  v_mfma_f32_32x32x16_bf16 v[32:47], v[84:87], a[88:91], v[32:47]
  ds_read_b128 v[80:83], v4 offset:24576
  ds_read_b128 v[84:87], v4 offset:53248
  s_waitcnt vmcnt(12)
  s_waitcnt lgkmcnt(2)
  v_mfma_f32_32x32x16_bf16 v[16:31], v[88:91], a[92:95], v[16:31]
  v_mfma_f32_32x32x16_bf16 v[32:47], v[92:95], a[92:95], v[32:47]
  ds_read_b128 v[88:91], v4 offset:25600
  ds_read_b128 v[92:95], v4 offset:54272
  s_waitcnt vmcnt(11)
  s_waitcnt lgkmcnt(2)
  v_mfma_f32_32x32x16_bf16 v[16:31], v[80:83], v[192:195], v[16:31]
  v_mfma_f32_32x32x16_bf16 v[32:47], v[84:87], v[192:195], v[32:47]
  ds_read_b128 v[80:83], v4 offset:26624
  ds_read_b128 v[84:87], v4 offset:55296
  s_waitcnt vmcnt(10)
  s_waitcnt lgkmcnt(2)
  v_mfma_f32_32x32x16_bf16 v[16:31], v[88:91], v[196:199], v[16:31]
  v_mfma_f32_32x32x16_bf16 v[32:47], v[92:95], v[196:199], v[32:47]
  ds_read_b128 v[88:91], v4 offset:27648
  ds_read_b128 v[92:95], v4 offset:56320
  s_waitcnt vmcnt(9)
  s_waitcnt lgkmcnt(2)
  v_mfma_f32_32x32x16_bf16 v[16:31], v[80:83], v[200:203], v[16:31]
  v_mfma_f32_32x32x16_bf16 v[32:47], v[84:87], v[200:203], v[32:47]
  s_waitcnt vmcnt(8)
  s_waitcnt lgkmcnt(0)
  v_mfma_f32_32x32x16_bf16 v[16:31], v[88:91], v[204:207], v[16:31]
  v_mfma_f32_32x32x16_bf16 v[32:47], v[92:95], v[204:207], v[32:47]
  s_add_u32 s37, s35, 4096
  ds_read_b128 v[80:83], v11 offset:0
  ds_read_b128 v[84:87], v11 offset:1024
  ds_read_b128 v[88:91], v11 offset:2048
  ds_read_b128 v[92:95], v11 offset:3072
  s_waitcnt lgkmcnt(3)
  v_mfma_f32_32x32x16_bf16 v[48:63], v[80:83], a[0:3], 0
  ds_read_b128 v[80:83], v11 offset:4096
  s_waitcnt lgkmcnt(3)
  v_mfma_f32_32x32x16_bf16 v[48:63], v[84:87], a[4:7], v[48:63]
  ds_read_b128 v[84:87], v11 offset:5120
  s_waitcnt lgkmcnt(3)
  v_mfma_f32_32x32x16_bf16 v[48:63], v[88:91], a[8:11], v[48:63]
  s_waitcnt vmcnt(1)
  v_add_f32 v208, v208, v210
  v_add_f32 v209, v209, v211
  v_add_f32 v208, v208, v212
  v_add_f32 v209, v209, v213
  v_add_f32 v208, v208, v214
  v_add_f32 v209, v209, v215
  v_add_f32 v208, v208, v216
  v_add_f32 v209, v209, v217
  ds_read_b128 v[88:91], v11 offset:6144
  s_waitcnt lgkmcnt(3)
  v_mfma_f32_32x32x16_bf16 v[48:63], v[92:95], a[12:15], v[48:63]
  v_add_f32 v208, v208, v218
  v_add_f32 v209, v209, v219
  v_add_f32 v208, v208, v220
  v_add_f32 v209, v209, v221
  v_mov_b32 v210, v208
  v_mov_b32 v211, v209
  s_nop 1
  v_permlane32_swap_b32 v208, v210
  ds_read_b128 v[92:95], v11 offset:7168
  s_waitcnt lgkmcnt(3)
  v_mfma_f32_32x32x16_bf16 v[48:63], v[80:83], a[16:19], v[48:63]
  v_permlane32_swap_b32 v209, v211
  s_nop 1
  v_add_f32 v208, v208, v210
  v_add_f32 v209, v209, v211
  v_mul_f32 v208, 0x3b124925, v208
  v_mul_f32 v209, 0x3b124925, v209
  v_fma_f32 v209, -v208, v208, v209
  v_max_f32 v209, 0, v209
  ds_read_b128 v[80:83], v11 offset:8192
  s_waitcnt lgkmcnt(3)
  v_mfma_f32_32x32x16_bf16 v[48:63], v[84:87], a[20:23], v[48:63]
  v_add_f32 v209, 0x3727c5ac, v209
  v_rsq_f32 v112, v209
  s_nop 0
  v_mul_f32 v112, 0xbfb8aa3b, v112
  v_mul_f32 v96, v16, v112
  v_mul_f32 v97, v17, v112
  v_mul_f32 v98, v18, v112
  v_mul_f32 v99, v19, v112
  ds_read_b128 v[84:87], v11 offset:9216
  s_waitcnt lgkmcnt(3)
  v_mfma_f32_32x32x16_bf16 v[48:63], v[88:91], a[24:27], v[48:63]
  v_mul_f32 v100, v20, v112
  v_mul_f32 v101, v21, v112
  v_mul_f32 v102, v22, v112
  v_mul_f32 v103, v23, v112
  v_mul_f32 v104, v24, v112
  v_mul_f32 v105, v25, v112
  v_mul_f32 v106, v26, v112
  v_mul_f32 v107, v27, v112
  ds_read_b128 v[88:91], v11 offset:10240
  s_waitcnt lgkmcnt(3)
  v_mfma_f32_32x32x16_bf16 v[48:63], v[92:95], a[28:31], v[48:63]
  v_mul_f32 v108, v28, v112
  v_mul_f32 v109, v29, v112
  v_mul_f32 v110, v30, v112
  v_mul_f32 v111, v31, v112
  v_exp_f32 v96, v96
  v_exp_f32 v97, v97
  v_exp_f32 v98, v98
  v_exp_f32 v99, v99
  ds_read_b128 v[92:95], v11 offset:11264
  s_waitcnt lgkmcnt(3)
  v_mfma_f32_32x32x16_bf16 v[48:63], v[80:83], a[32:35], v[48:63]
  v_exp_f32 v100, v100
  v_exp_f32 v101, v101
  v_exp_f32 v102, v102
  v_exp_f32 v103, v103
  v_exp_f32 v104, v104
  v_exp_f32 v105, v105
  v_exp_f32 v106, v106
  v_exp_f32 v107, v107
  ds_read_b128 v[80:83], v11 offset:12288
  s_waitcnt lgkmcnt(3)
  v_mfma_f32_32x32x16_bf16 v[48:63], v[84:87], a[36:39], v[48:63]
  v_exp_f32 v108, v108
  v_exp_f32 v109, v109
  v_exp_f32 v110, v110
  v_exp_f32 v111, v111
  v_add_f32 v96, 1.0, v96
  v_add_f32 v97, 1.0, v97
  v_add_f32 v98, 1.0, v98
  v_add_f32 v99, 1.0, v99
  ds_read_b128 v[84:87], v11 offset:13312
  s_waitcnt lgkmcnt(3)
  v_mfma_f32_32x32x16_bf16 v[48:63], v[88:91], a[40:43], v[48:63]
  v_add_f32 v100, 1.0, v100
  v_add_f32 v101, 1.0, v101
  v_add_f32 v102, 1.0, v102
  v_add_f32 v103, 1.0, v103
  v_add_f32 v104, 1.0, v104
  v_add_f32 v105, 1.0, v105
  v_add_f32 v106, 1.0, v106
  v_add_f32 v107, 1.0, v107
  ds_read_b128 v[88:91], v11 offset:14336
  s_waitcnt lgkmcnt(3)
  v_mfma_f32_32x32x16_bf16 v[48:63], v[92:95], a[44:47], v[48:63]
  v_add_f32 v108, 1.0, v108
  v_add_f32 v109, 1.0, v109
  v_add_f32 v110, 1.0, v110
  v_add_f32 v111, 1.0, v111
  v_rcp_f32 v96, v96
  v_rcp_f32 v97, v97
  v_rcp_f32 v98, v98
  v_rcp_f32 v99, v99
  ds_read_b128 v[92:95], v11 offset:15360
  s_waitcnt lgkmcnt(3)
  v_mfma_f32_32x32x16_bf16 v[48:63], v[80:83], a[48:51], v[48:63]
  v_rcp_f32 v100, v100
  v_rcp_f32 v101, v101
  v_rcp_f32 v102, v102
  v_rcp_f32 v103, v103
  v_rcp_f32 v104, v104
  v_rcp_f32 v105, v105
  v_rcp_f32 v106, v106
  v_rcp_f32 v107, v107
  ds_read_b128 v[80:83], v11 offset:16384
  s_waitcnt lgkmcnt(3)
  v_mfma_f32_32x32x16_bf16 v[48:63], v[84:87], a[52:55], v[48:63]
  v_rcp_f32 v108, v108
  v_rcp_f32 v109, v109
  v_rcp_f32 v110, v110
  v_rcp_f32 v111, v111
  v_mul_f32 v16, v16, v96
  v_mul_f32 v17, v17, v97
  v_mul_f32 v18, v18, v98
  v_mul_f32 v19, v19, v99
  ds_read_b128 v[84:87], v11 offset:17408
  s_waitcnt lgkmcnt(3)
  v_mfma_f32_32x32x16_bf16 v[48:63], v[88:91], a[56:59], v[48:63]
  v_mul_f32 v20, v20, v100
  v_mul_f32 v21, v21, v101
  v_mul_f32 v22, v22, v102
  v_mul_f32 v23, v23, v103
  v_mul_f32 v24, v24, v104
  v_mul_f32 v25, v25, v105
  v_mul_f32 v26, v26, v106
  v_mul_f32 v27, v27, v107
  ds_read_b128 v[88:91], v11 offset:18432
  s_waitcnt lgkmcnt(3)
  v_mfma_f32_32x32x16_bf16 v[48:63], v[92:95], a[60:63], v[48:63]
  v_mul_f32 v28, v28, v108
  v_mul_f32 v29, v29, v109
  v_mul_f32 v30, v30, v110
  v_mul_f32 v31, v31, v111
  v_cvt_pk_bf16_f32 v116, v16, v17
  v_cvt_pk_bf16_f32 v117, v18, v19
  v_cvt_pk_bf16_f32 v118, v20, v21
  v_cvt_pk_bf16_f32 v119, v22, v23
  ds_read_b128 v[92:95], v11 offset:19456
  s_waitcnt lgkmcnt(3)
  v_mfma_f32_32x32x16_bf16 v[48:63], v[80:83], a[64:67], v[48:63]
  v_cvt_pk_bf16_f32 v120, v24, v25
  v_cvt_pk_bf16_f32 v121, v26, v27
  v_cvt_pk_bf16_f32 v122, v28, v29
  v_cvt_pk_bf16_f32 v123, v30, v31
  buffer_store_dwordx4 v[116:119], v4, s[8:11], s35 offen offset:0
  buffer_store_dwordx4 v[120:123], v4, s[8:11], s35 offen offset:1024
  v_mul_f32 v96, v32, v112
  v_mul_f32 v97, v33, v112
  ds_read_b128 v[80:83], v11 offset:20480
  s_waitcnt lgkmcnt(3)
  v_mfma_f32_32x32x16_bf16 v[48:63], v[84:87], a[68:71], v[48:63]
  v_mul_f32 v98, v34, v112
  v_mul_f32 v99, v35, v112
  v_mul_f32 v100, v36, v112
  v_mul_f32 v101, v37, v112
  v_mul_f32 v102, v38, v112
  v_mul_f32 v103, v39, v112
  v_mul_f32 v104, v40, v112
  v_mul_f32 v105, v41, v112
  ds_read_b128 v[84:87], v11 offset:21504
  s_waitcnt lgkmcnt(3)
  v_mfma_f32_32x32x16_bf16 v[48:63], v[88:91], a[72:75], v[48:63]
  v_mul_f32 v106, v42, v112
  v_mul_f32 v107, v43, v112
  v_mul_f32 v108, v44, v112
  v_mul_f32 v109, v45, v112
  v_mul_f32 v110, v46, v112
  v_mul_f32 v111, v47, v112
  v_exp_f32 v96, v96
  v_exp_f32 v97, v97
  ds_read_b128 v[88:91], v11 offset:22528
  s_waitcnt lgkmcnt(3)
  v_mfma_f32_32x32x16_bf16 v[48:63], v[92:95], a[76:79], v[48:63]
  v_exp_f32 v98, v98
  v_exp_f32 v99, v99
  v_exp_f32 v100, v100
  v_exp_f32 v101, v101
  v_exp_f32 v102, v102
  v_exp_f32 v103, v103
  v_exp_f32 v104, v104
  v_exp_f32 v105, v105
  ds_read_b128 v[92:95], v11 offset:23552
  s_waitcnt lgkmcnt(3)
  v_mfma_f32_32x32x16_bf16 v[48:63], v[80:83], a[80:83], v[48:63]
  v_exp_f32 v106, v106
  v_exp_f32 v107, v107
  v_exp_f32 v108, v108
  v_exp_f32 v109, v109
  v_exp_f32 v110, v110
  v_exp_f32 v111, v111
  v_add_f32 v96, 1.0, v96
  v_add_f32 v97, 1.0, v97
  ds_read_b128 v[80:83], v11 offset:24576
  s_waitcnt lgkmcnt(3)
  v_mfma_f32_32x32x16_bf16 v[48:63], v[84:87], a[84:87], v[48:63]
  v_add_f32 v98, 1.0, v98
  v_add_f32 v99, 1.0, v99
  v_add_f32 v100, 1.0, v100
  v_add_f32 v101, 1.0, v101
  v_add_f32 v102, 1.0, v102
  v_add_f32 v103, 1.0, v103
  v_add_f32 v104, 1.0, v104
  v_add_f32 v105, 1.0, v105
  ds_read_b128 v[84:87], v11 offset:25600
  s_waitcnt lgkmcnt(3)
  v_mfma_f32_32x32x16_bf16 v[48:63], v[88:91], a[88:91], v[48:63]
  v_add_f32 v106, 1.0, v106
  v_add_f32 v107, 1.0, v107
  v_add_f32 v108, 1.0, v108
  v_add_f32 v109, 1.0, v109
  v_add_f32 v110, 1.0, v110
  v_add_f32 v111, 1.0, v111
  v_rcp_f32 v96, v96
  v_rcp_f32 v97, v97
  ds_read_b128 v[88:91], v11 offset:26624
  s_waitcnt lgkmcnt(3)
  v_mfma_f32_32x32x16_bf16 v[48:63], v[92:95], a[92:95], v[48:63]
  v_rcp_f32 v98, v98
  v_rcp_f32 v99, v99
  v_rcp_f32 v100, v100
  v_rcp_f32 v101, v101
  v_rcp_f32 v102, v102
  v_rcp_f32 v103, v103
  v_rcp_f32 v104, v104
  v_rcp_f32 v105, v105
  ds_read_b128 v[92:95], v11 offset:27648
  s_waitcnt lgkmcnt(3)
  v_mfma_f32_32x32x16_bf16 v[48:63], v[80:83], v[192:195], v[48:63]
  v_rcp_f32 v106, v106
  v_rcp_f32 v107, v107
  v_rcp_f32 v108, v108
  v_rcp_f32 v109, v109
  v_rcp_f32 v110, v110
  v_rcp_f32 v111, v111
  v_mul_f32 v32, v32, v96
  v_mul_f32 v33, v33, v97
  s_waitcnt lgkmcnt(2)
  v_mfma_f32_32x32x16_bf16 v[48:63], v[84:87], v[196:199], v[48:63]
  v_mul_f32 v34, v34, v98
  v_mul_f32 v35, v35, v99
  v_mul_f32 v36, v36, v100
  v_mul_f32 v37, v37, v101
  v_mul_f32 v38, v38, v102
  v_mul_f32 v39, v39, v103
  v_mul_f32 v40, v40, v104
  v_mul_f32 v41, v41, v105
  s_waitcnt lgkmcnt(1)
  v_mfma_f32_32x32x16_bf16 v[48:63], v[88:91], v[200:203], v[48:63]
  v_mul_f32 v42, v42, v106
  v_mul_f32 v43, v43, v107
  v_mul_f32 v44, v44, v108
  v_mul_f32 v45, v45, v109
  v_mul_f32 v46, v46, v110
  v_mul_f32 v47, v47, v111
  v_cvt_pk_bf16_f32 v116, v32, v33
  v_cvt_pk_bf16_f32 v117, v34, v35
  s_waitcnt lgkmcnt(0)
  v_mfma_f32_32x32x16_bf16 v[48:63], v[92:95], v[204:207], v[48:63]
  v_cvt_pk_bf16_f32 v118, v36, v37
  v_cvt_pk_bf16_f32 v119, v38, v39
  v_cvt_pk_bf16_f32 v120, v40, v41
  v_cvt_pk_bf16_f32 v121, v42, v43
  v_cvt_pk_bf16_f32 v122, v44, v45
  v_cvt_pk_bf16_f32 v123, v46, v47
  buffer_store_dwordx4 v[116:119], v4, s[8:11], s35 offen offset:2048
  buffer_store_dwordx4 v[120:123], v4, s[8:11], s35 offen offset:3072
  s_barrier
  s_lshr_b32 s56, s2, 4
  s_mul_i32 s56, s56, 86016
  s_mul_i32 s57, s16, 21504
  s_add_u32 s56, s56, s57
  ds_read_b128 v[80:83], v11 offset:28672
  ds_read_b128 v[84:87], v11 offset:29696
  ds_read_b128 v[88:91], v11 offset:30720
  ds_read_b128 v[92:95], v11 offset:31744
  s_waitcnt lgkmcnt(3)
  v_mfma_f32_32x32x16_bf16 v[64:79], v[80:83], a[0:3], 0
  ds_read_b128 v[80:83], v11 offset:32768
  s_waitcnt lgkmcnt(3)
  v_mfma_f32_32x32x16_bf16 v[64:79], v[84:87], a[4:7], v[64:79]
  ds_read_b128 v[84:87], v11 offset:33792
  s_waitcnt lgkmcnt(3)
  v_mfma_f32_32x32x16_bf16 v[64:79], v[88:91], a[8:11], v[64:79]
  ds_read_b128 v[88:91], v11 offset:34816
  s_waitcnt lgkmcnt(3)
  v_mfma_f32_32x32x16_bf16 v[64:79], v[92:95], a[12:15], v[64:79]
  ds_read_b128 v[92:95], v11 offset:35840
  s_waitcnt lgkmcnt(3)
  v_mfma_f32_32x32x16_bf16 v[64:79], v[80:83], a[16:19], v[64:79]
  v_mul_f32 v96, v48, v112
  v_mul_f32 v97, v49, v112
  v_mul_f32 v98, v50, v112
  v_mul_f32 v99, v51, v112
  ds_read_b128 v[80:83], v11 offset:36864
  s_waitcnt lgkmcnt(3)
  v_mfma_f32_32x32x16_bf16 v[64:79], v[84:87], a[20:23], v[64:79]
  v_mul_f32 v100, v52, v112
  v_mul_f32 v101, v53, v112
  v_mul_f32 v102, v54, v112
  v_mul_f32 v103, v55, v112
  ds_read_b128 v[84:87], v11 offset:37888
  s_waitcnt lgkmcnt(3)
  v_mfma_f32_32x32x16_bf16 v[64:79], v[88:91], a[24:27], v[64:79]
  v_mul_f32 v104, v56, v112
  v_mul_f32 v105, v57, v112
  v_mul_f32 v106, v58, v112
  v_mul_f32 v107, v59, v112
  ds_read_b128 v[88:91], v11 offset:38912
  s_waitcnt lgkmcnt(3)
  v_mfma_f32_32x32x16_bf16 v[64:79], v[92:95], a[28:31], v[64:79]
  v_mul_f32 v108, v60, v112
  v_mul_f32 v109, v61, v112
  v_mul_f32 v110, v62, v112
  v_mul_f32 v111, v63, v112
  ds_read_b128 v[92:95], v11 offset:39936
  s_waitcnt lgkmcnt(3)
  v_mfma_f32_32x32x16_bf16 v[64:79], v[80:83], a[32:35], v[64:79]
  v_exp_f32 v96, v96
  v_exp_f32 v97, v97
  s_cmp_eq_u32 s3, 1
  s_cbranch_scc1 L1_qs0
  s_mov_b32 m0, s57
  s_add_u32 s57, s57, 4096
  buffer_load_dwordx4 v4, s[8:11], s56 offen offset:0 lds
  buffer_load_dwordx4 v4, s[8:11], s56 offen offset:1024 lds
  buffer_load_dwordx4 v4, s[8:11], s56 offen offset:2048 lds
L1_qs0:
  v_exp_f32 v98, v98
  ds_read_b128 v[80:83], v11 offset:40960
  s_waitcnt lgkmcnt(3)
  v_mfma_f32_32x32x16_bf16 v[64:79], v[84:87], a[36:39], v[64:79]
  v_exp_f32 v99, v99
  v_exp_f32 v100, v100
  v_exp_f32 v101, v101
  v_exp_f32 v102, v102
  ds_read_b128 v[84:87], v11 offset:41984
  s_waitcnt lgkmcnt(3)
  v_mfma_f32_32x32x16_bf16 v[64:79], v[88:91], a[40:43], v[64:79]
  v_exp_f32 v103, v103
  v_exp_f32 v104, v104
  v_exp_f32 v105, v105
  v_exp_f32 v106, v106
  ds_read_b128 v[88:91], v11 offset:43008
  s_waitcnt lgkmcnt(3)
  v_mfma_f32_32x32x16_bf16 v[64:79], v[92:95], a[44:47], v[64:79]
  v_exp_f32 v107, v107
  v_exp_f32 v108, v108
  v_exp_f32 v109, v109
  v_exp_f32 v110, v110
  ds_read_b128 v[92:95], v11 offset:44032
  s_waitcnt lgkmcnt(3)
  v_mfma_f32_32x32x16_bf16 v[64:79], v[80:83], a[48:51], v[64:79]
  v_exp_f32 v111, v111
  v_add_f32 v96, 1.0, v96
  v_add_f32 v97, 1.0, v97
  v_add_f32 v98, 1.0, v98
  ds_read_b128 v[80:83], v11 offset:45056
  s_waitcnt lgkmcnt(3)
  v_mfma_f32_32x32x16_bf16 v[64:79], v[84:87], a[52:55], v[64:79]
  v_add_f32 v99, 1.0, v99
  s_cmp_eq_u32 s3, 1
  s_cbranch_scc1 L1_qs3
  buffer_load_dwordx4 v4, s[8:11], s56 offen offset:3072 lds
  s_add_u32 s56, s56, 4096
  s_mov_b32 m0, s57
  s_add_u32 s57, s57, 4096
  buffer_load_dwordx4 v4, s[8:11], s56 offen offset:0 lds
  buffer_load_dwordx4 v4, s[8:11], s56 offen offset:1024 lds
L1_qs3:
  v_add_f32 v100, 1.0, v100
  v_add_f32 v101, 1.0, v101
  ds_read_b128 v[84:87], v11 offset:46080
  s_waitcnt lgkmcnt(3)
  v_mfma_f32_32x32x16_bf16 v[64:79], v[88:91], a[56:59], v[64:79]
  v_add_f32 v102, 1.0, v102
  v_add_f32 v103, 1.0, v103
  v_add_f32 v104, 1.0, v104
  v_add_f32 v105, 1.0, v105
  ds_read_b128 v[88:91], v11 offset:47104
  s_waitcnt lgkmcnt(3)
  v_mfma_f32_32x32x16_bf16 v[64:79], v[92:95], a[60:63], v[64:79]
  v_add_f32 v106, 1.0, v106
  v_add_f32 v107, 1.0, v107
  v_add_f32 v108, 1.0, v108
  v_add_f32 v109, 1.0, v109
  ds_read_b128 v[92:95], v11 offset:48128
  s_waitcnt lgkmcnt(3)
  v_mfma_f32_32x32x16_bf16 v[64:79], v[80:83], a[64:67], v[64:79]
  v_add_f32 v110, 1.0, v110
  v_add_f32 v111, 1.0, v111
  v_rcp_f32 v96, v96
  v_rcp_f32 v97, v97
  ds_read_b128 v[80:83], v11 offset:49152
  s_waitcnt lgkmcnt(3)
  v_mfma_f32_32x32x16_bf16 v[64:79], v[84:87], a[68:71], v[64:79]
  v_rcp_f32 v98, v98
  v_rcp_f32 v99, v99
  v_rcp_f32 v100, v100
  v_rcp_f32 v101, v101
  ds_read_b128 v[84:87], v11 offset:50176
  s_waitcnt lgkmcnt(3)
  v_mfma_f32_32x32x16_bf16 v[64:79], v[88:91], a[72:75], v[64:79]
  s_cmp_eq_u32 s3, 1
  s_cbranch_scc1 L1_qs6
  buffer_load_dwordx4 v4, s[8:11], s56 offen offset:2048 lds
  buffer_load_dwordx4 v4, s[8:11], s56 offen offset:3072 lds
  s_add_u32 s56, s56, 4096
  s_mov_b32 m0, s57
  s_add_u32 s57, s57, 4096
  buffer_load_dwordx4 v4, s[8:11], s56 offen offset:0 lds
L1_qs6:
  v_rcp_f32 v102, v102
  v_rcp_f32 v103, v103
  v_rcp_f32 v104, v104
  ds_read_b128 v[88:91], v11 offset:51200
  s_waitcnt lgkmcnt(3)
  v_mfma_f32_32x32x16_bf16 v[64:79], v[92:95], a[76:79], v[64:79]
  v_rcp_f32 v105, v105
  v_rcp_f32 v106, v106
  v_rcp_f32 v107, v107
  v_rcp_f32 v108, v108
  ds_read_b128 v[92:95], v11 offset:52224
  s_waitcnt lgkmcnt(3)
  v_mfma_f32_32x32x16_bf16 v[64:79], v[80:83], a[80:83], v[64:79]
  v_rcp_f32 v109, v109
  v_rcp_f32 v110, v110
  v_rcp_f32 v111, v111
  v_mul_f32 v48, v48, v96
  ds_read_b128 v[80:83], v11 offset:53248
  s_waitcnt lgkmcnt(3)
  v_mfma_f32_32x32x16_bf16 v[64:79], v[84:87], a[84:87], v[64:79]
  v_mul_f32 v49, v49, v97
  v_mul_f32 v50, v50, v98
  v_mul_f32 v51, v51, v99
  v_mul_f32 v52, v52, v100
  ds_read_b128 v[84:87], v11 offset:54272
  s_waitcnt lgkmcnt(3)
  v_mfma_f32_32x32x16_bf16 v[64:79], v[88:91], a[88:91], v[64:79]
  v_mul_f32 v53, v53, v101
  v_mul_f32 v54, v54, v102
  v_mul_f32 v55, v55, v103
  s_cmp_eq_u32 s3, 1
  s_cbranch_scc1 L1_qs9
  buffer_load_dwordx4 v4, s[8:11], s56 offen offset:1024 lds
  buffer_load_dwordx4 v4, s[8:11], s56 offen offset:2048 lds
  buffer_load_dwordx4 v4, s[8:11], s56 offen offset:3072 lds
  s_add_u32 s56, s56, 4096
L1_qs9:
  ds_read_b128 v[88:91], v11 offset:55296
  s_waitcnt lgkmcnt(3)
  v_mfma_f32_32x32x16_bf16 v[64:79], v[92:95], a[92:95], v[64:79]
  v_mul_f32 v56, v56, v104
  v_mul_f32 v57, v57, v105
  v_mul_f32 v58, v58, v106
  v_mul_f32 v59, v59, v107
  ds_read_b128 v[92:95], v11 offset:56320
  s_waitcnt lgkmcnt(3)
  v_mfma_f32_32x32x16_bf16 v[64:79], v[80:83], v[192:195], v[64:79]
  v_mul_f32 v60, v60, v108
  v_mul_f32 v61, v61, v109
  v_mul_f32 v62, v62, v110
  v_mul_f32 v63, v63, v111
  s_waitcnt lgkmcnt(2)
  v_mfma_f32_32x32x16_bf16 v[64:79], v[84:87], v[196:199], v[64:79]
  v_cvt_pk_bf16_f32 v116, v48, v49
  v_cvt_pk_bf16_f32 v117, v50, v51
  v_cvt_pk_bf16_f32 v118, v52, v53
  v_cvt_pk_bf16_f32 v119, v54, v55
  s_waitcnt lgkmcnt(1)
  v_mfma_f32_32x32x16_bf16 v[64:79], v[88:91], v[200:203], v[64:79]
  v_cvt_pk_bf16_f32 v120, v56, v57
  v_cvt_pk_bf16_f32 v121, v58, v59
  v_cvt_pk_bf16_f32 v122, v60, v61
  v_cvt_pk_bf16_f32 v123, v62, v63
  s_waitcnt lgkmcnt(0)
  v_mfma_f32_32x32x16_bf16 v[64:79], v[92:95], v[204:207], v[64:79]
  buffer_store_dwordx4 v[116:119], v4, s[8:11], s37 offen offset:0
  buffer_store_dwordx4 v[120:123], v4, s[8:11], s37 offen offset:1024
  s_cmp_eq_u32 s3, 1
  s_cbranch_scc1 L1_qs12
  s_mov_b32 m0, s57
  s_add_u32 s57, s57, 4096
  buffer_load_dwordx4 v4, s[8:11], s56 offen offset:0 lds
  buffer_load_dwordx4 v4, s[8:11], s56 offen offset:1024 lds
  buffer_load_dwordx4 v4, s[8:11], s56 offen offset:2048 lds
L1_qs12:
  s_nop 7
  s_nop 3
  v_pk_mul_f32 v[96:97], v[64:65], v[112:113] op_sel_hi:[1,0]
  v_pk_mul_f32 v[98:99], v[66:67], v[112:113] op_sel_hi:[1,0]
  v_pk_mul_f32 v[100:101], v[68:69], v[112:113] op_sel_hi:[1,0]
  v_pk_mul_f32 v[102:103], v[70:71], v[112:113] op_sel_hi:[1,0]
  v_pk_mul_f32 v[104:105], v[72:73], v[112:113] op_sel_hi:[1,0]
  v_pk_mul_f32 v[106:107], v[74:75], v[112:113] op_sel_hi:[1,0]
  v_pk_mul_f32 v[108:109], v[76:77], v[112:113] op_sel_hi:[1,0]
  v_pk_mul_f32 v[110:111], v[78:79], v[112:113] op_sel_hi:[1,0]
  v_exp_f32 v96, v96
  v_exp_f32 v97, v97
  v_exp_f32 v98, v98
  v_exp_f32 v99, v99
  v_exp_f32 v100, v100
  v_exp_f32 v101, v101
  v_exp_f32 v102, v102
  v_exp_f32 v103, v103
  v_exp_f32 v104, v104
  v_exp_f32 v105, v105
  v_exp_f32 v106, v106
  v_exp_f32 v107, v107
  v_exp_f32 v108, v108
  v_exp_f32 v109, v109
  v_exp_f32 v110, v110
  v_exp_f32 v111, v111
  v_pk_add_f32 v[96:97], v[96:97], 1.0 op_sel_hi:[1,0]
  v_pk_add_f32 v[98:99], v[98:99], 1.0 op_sel_hi:[1,0]
  v_pk_add_f32 v[100:101], v[100:101], 1.0 op_sel_hi:[1,0]
  v_pk_add_f32 v[102:103], v[102:103], 1.0 op_sel_hi:[1,0]
  v_pk_add_f32 v[104:105], v[104:105], 1.0 op_sel_hi:[1,0]
  v_pk_add_f32 v[106:107], v[106:107], 1.0 op_sel_hi:[1,0]
  v_pk_add_f32 v[108:109], v[108:109], 1.0 op_sel_hi:[1,0]
  v_pk_add_f32 v[110:111], v[110:111], 1.0 op_sel_hi:[1,0]
  v_rcp_f32 v96, v96
  s_cmp_eq_u32 s3, 1
  s_cbranch_scc1 L1_qs15
  buffer_load_dwordx4 v4, s[8:11], s56 offen offset:3072 lds
  s_add_u32 s56, s56, 4096
  s_mov_b32 m0, s57
  s_add_u32 s57, s57, 4096
  buffer_load_dwordx4 v4, s[8:11], s56 offen offset:0 lds
  buffer_load_dwordx4 v4, s[8:11], s56 offen offset:1024 lds
L1_qs15:
  v_rcp_f32 v97, v97
  v_rcp_f32 v98, v98
  v_rcp_f32 v99, v99
  v_rcp_f32 v100, v100
  v_rcp_f32 v101, v101
  v_rcp_f32 v102, v102
  v_rcp_f32 v103, v103
  v_rcp_f32 v104, v104
  v_rcp_f32 v105, v105
  v_rcp_f32 v106, v106
  v_rcp_f32 v107, v107
  v_rcp_f32 v108, v108
  v_rcp_f32 v109, v109
  v_rcp_f32 v110, v110
  v_rcp_f32 v111, v111
  v_pk_mul_f32 v[64:65], v[64:65], v[96:97]
  v_pk_mul_f32 v[66:67], v[66:67], v[98:99]
  v_pk_mul_f32 v[68:69], v[68:69], v[100:101]
  v_pk_mul_f32 v[70:71], v[70:71], v[102:103]
  v_pk_mul_f32 v[72:73], v[72:73], v[104:105]
  v_pk_mul_f32 v[74:75], v[74:75], v[106:107]
  v_pk_mul_f32 v[76:77], v[76:77], v[108:109]
  v_pk_mul_f32 v[78:79], v[78:79], v[110:111]
  v_cvt_pk_bf16_f32 v116, v64, v65
  v_cvt_pk_bf16_f32 v117, v66, v67
  v_cvt_pk_bf16_f32 v118, v68, v69
  v_cvt_pk_bf16_f32 v119, v70, v71
  v_cvt_pk_bf16_f32 v120, v72, v73
  v_cvt_pk_bf16_f32 v121, v74, v75
  v_cvt_pk_bf16_f32 v122, v76, v77
  v_cvt_pk_bf16_f32 v123, v78, v79
  buffer_store_dwordx4 v[116:119], v4, s[8:11], s37 offen offset:2048
  buffer_store_dwordx4 v[120:123], v4, s[8:11], s37 offen offset:3072
  s_cmp_eq_u32 s3, 1
  s_cbranch_scc1 L1_qs18
  buffer_load_dwordx4 v4, s[8:11], s56 offen offset:2048 lds
  buffer_load_dwordx4 v4, s[8:11], s56 offen offset:3072 lds
  s_add_u32 s56, s56, 4096
  s_mov_b32 m0, s57
  s_add_u32 s57, s57, 4096
  buffer_load_dwordx4 v4, s[8:11], s56 offen offset:0 lds
L1_qs18:
  s_mul_i32 s30, s3, 10240
  s_add_u32 s30, s30, 0xd11800
  s_lshl_b32 s63, s25, 7
  s_add_u32 s30, s30, s63
  s_lshl_b32 s63, s26, 2
  s_add_u32 s30, s30, s63
  v_mov_b32 v6, 0
  v_mov_b32 v7, s66
  s_lshl_b32 s61, s16, 1
  s_or_b32 s61, s61, s18
  s_cmp_eq_u32 s61, 0
  s_waitcnt vmcnt(0)
  s_barrier
  s_cbranch_scc0 L1_fh_oth
  s_mov_b64 exec, 1
  buffer_store_dword v7, v6, s[8:11], s30 offen
  s_mov_b64 exec, -1
  s_branch L1_fh_nf
L1_fh_oth:
  s_cmp_lg_u32 s16, 0
  s_cbranch_scc1 L1_fh_nf
  buffer_wbl2 sc1
  s_waitcnt vmcnt(0)
  s_mov_b64 exec, 1
  buffer_store_dword v7, v6, s[8:11], s30 offen sc1
  s_mov_b64 exec, -1
L1_fh_nf:
  s_and_b32 s25, s2, 7
  s_lshl_b32 s25, s25, 2
  s_bfe_u32 s26, s2, 0x20003
  s_add_u32 s25, s25, s26
  s_lshr_b32 s26, s2, 5
  s_min_u32 s26, s26, 6
  s_lshr_b32 s32, s16, 1
  s_and_b32 s33, s16, 1
  s_lshl_b32 s34, s25, 1
  s_add_u32 s34, s34, s33
  s_lshl_b32 s35, s26, 1
  s_add_u32 s35, s35, s32
  s_lshl_b32 s36, s3, 1
  s_add_u32 s36, s36, 1
  s_mul_i32 s36, s36, s19
  s_add_u32 s36, s36, 0x500000
  s_mul_i32 s37, s34, 28
  s_lshl_b32 s38, s35, 1
  s_add_u32 s37, s37, s38
  s_lshl_b32 s37, s37, 10
  s_add_u32 s36, s36, s37
  s_and_b32 s49, s2, 7
  s_mul_i32 s47, s49, 917504
  s_lshl_b32 s48, s19, 2
  s_mul_i32 s48, s48, s3
  s_add_u32 s47, s47, s48
  s_add_u32 s47, s47, 0x1e00000
  s_mov_b32 s48, s47
  s_sub_u32 s49, s48, s47
  s_and_b32 s27, s16, 1
  s_xor_b32 s27, s27, 0
  s_lshl_b32 s28, s25, 1
  s_add_u32 s27, s27, s28
  s_and_b32 s27, s27, 7
  s_mul_i32 s27, s27, 112
  s_mul_i32 s28, s16, 28
  s_add_u32 s27, s27, s28
  s_sub_u32 s50, 768, s27
  s_cmp_lt_u32 s27, 768
  s_cselect_b32 s28, s47, s48
  s_lshl_b32 s27, s27, 10
  s_add_u32 s40, s27, s28
  s_and_b32 s27, s16, 1
  s_xor_b32 s27, s27, 1
  s_lshl_b32 s28, s25, 1
  s_add_u32 s27, s27, s28
  s_and_b32 s27, s27, 7
  s_mul_i32 s27, s27, 112
  s_mul_i32 s28, s16, 28
  s_add_u32 s27, s27, s28
  s_sub_u32 s51, 768, s27
  s_cmp_lt_u32 s27, 768
  s_cselect_b32 s28, s47, s48
  s_lshl_b32 s27, s27, 10
  s_add_u32 s41, s27, s28
  s_mul_i32 s42, s3, 0x80000
  s_add_u32 s42, s42, 0xc40000
  s_lshl_b32 s43, s34, 8
  s_add_u32 s42, s42, s43
  s_lshr_b32 s29, s25, 1
  s_mul_i32 s30, s3, 10240
  s_add_u32 s30, s30, 0xd11800
  s_lshl_b32 s63, s29, 7
  s_add_u32 s30, s30, s63
  s_add_u32 s44, s36, s19
  s_mul_i32 s45, s3, 0x80000
  s_add_u32 s45, s45, 0xc80000
  s_lshl_b32 s39, s35, 14
  s_add_u32 s45, s45, s39
  s_lshl_b32 s39, s34, 8
  s_add_u32 s45, s45, s39
  v_lshlrev_b32 v116, 3, v2
  s_xor_b32 s60, s16, 1
  s_mul_i32 s60, s60, 12288
  s_add_u32 s60, s60, 114688
  v_add_u32 v112, s60, v4
  s_xor_b32 s60, s16, 2
  s_mul_i32 s60, s60, 12288
  s_add_u32 s60, s60, 118784
  v_add_u32 v113, s60, v4
  s_xor_b32 s60, s16, 3
  s_mul_i32 s60, s60, 12288
  s_add_u32 s60, s60, 122880
  v_add_u32 v114, s60, v4
  s_mul_i32 s60, s16, 12288
  s_add_u32 s60, s60, 114688
  v_add_u32 v115, s60, v4
  s_and_b32 s31, s25, 1
  s_mul_i32 s31, s31, 7
  s_add_u32 s31, s31, s26
  s_mul_i32 s46, s3, 10240
  s_add_u32 s46, s46, 0xd12000
  s_lshl_b32 s63, s29, 7
  s_add_u32 s46, s46, s63
  s_lshl_b32 s63, s31, 2
  s_add_u32 s46, s46, s63
  s_cmp_lg_u32 s16, 0
  s_cbranch_scc1 L2_fh_oth
  v_min_u32 v6, 13, v1
  v_lshlrev_b32 v6, 2, v6
  s_mov_b32 s62, 0
L2_fh_poll:
  buffer_load_dword v7, v6, s[8:11], s30 offen sc1
  s_add_u32 s62, s62, 1
  s_cmp_gt_u32 s62, 300000
  s_cbranch_scc1 L2_fh_to
  s_waitcnt vmcnt(0)
  v_cmp_ne_u32 vcc, s66, v7
  s_cbranch_vccnz L2_fh_poll
L2_fh_to:
  s_waitcnt vmcnt(0)
  s_branch L2_fh_go
L2_fh_oth:
  s_waitcnt vmcnt(0)
L2_fh_go:
  s_barrier
  buffer_load_dwordx4 a[0:3], v4, s[8:11], s40 offen offset:0 sc1
  buffer_load_dwordx4 a[4:7], v4, s[8:11], s41 offen offset:0 sc1
  buffer_load_dwordx4 a[8:11], v4, s[8:11], s40 offen offset:1024 sc1
  buffer_load_dwordx4 a[12:15], v4, s[8:11], s41 offen offset:1024 sc1
  buffer_load_dwordx4 a[16:19], v4, s[8:11], s40 offen offset:2048 sc1
  buffer_load_dwordx4 a[20:23], v4, s[8:11], s41 offen offset:2048 sc1
  buffer_load_dwordx4 a[24:27], v4, s[8:11], s40 offen offset:3072 sc1
  buffer_load_dwordx4 a[28:31], v4, s[8:11], s41 offen offset:3072 sc1
  s_add_u32 s40, s40, 4096
  s_add_u32 s41, s41, 4096
  s_waitcnt vmcnt(6)
  v_mfma_f32_32x32x16_bf16 v[16:31], a[96:99], a[0:3], 0
  v_mfma_f32_32x32x16_bf16 v[32:47], a[96:99], a[4:7], 0
  buffer_load_dwordx4 a[32:35], v4, s[8:11], s40 offen offset:0 sc1
  buffer_load_dwordx4 a[36:39], v4, s[8:11], s41 offen offset:0 sc1
  v_mfma_f32_32x32x16_bf16 v[48:63], a[100:103], a[0:3], 0
  v_mfma_f32_32x32x16_bf16 v[64:79], a[100:103], a[4:7], 0
  buffer_load_dwordx4 a[40:43], v4, s[8:11], s40 offen offset:1024 sc1
  buffer_load_dwordx4 a[44:47], v4, s[8:11], s41 offen offset:1024 sc1
  s_waitcnt vmcnt(8)
  v_mfma_f32_32x32x16_bf16 v[16:31], a[104:107], a[8:11], v[16:31]
  v_mfma_f32_32x32x16_bf16 v[32:47], a[104:107], a[12:15], v[32:47]
  buffer_load_dwordx4 a[48:51], v4, s[8:11], s40 offen offset:2048 sc1
  buffer_load_dwordx4 a[52:55], v4, s[8:11], s41 offen offset:2048 sc1
  v_mfma_f32_32x32x16_bf16 v[48:63], a[108:111], a[8:11], v[48:63]
  v_mfma_f32_32x32x16_bf16 v[64:79], a[108:111], a[12:15], v[64:79]
  buffer_load_dwordx4 a[56:59], v4, s[8:11], s40 offen offset:3072 sc1
  buffer_load_dwordx4 a[60:63], v4, s[8:11], s41 offen offset:3072 sc1
  s_add_u32 s40, s40, 4096
  s_add_u32 s41, s41, 4096
  s_waitcnt vmcnt(10)
  v_mfma_f32_32x32x16_bf16 v[16:31], a[112:115], a[16:19], v[16:31]
  v_mfma_f32_32x32x16_bf16 v[32:47], a[112:115], a[20:23], v[32:47]
  buffer_load_dwordx4 a[64:67], v4, s[8:11], s40 offen offset:0 sc1
  buffer_load_dwordx4 a[68:71], v4, s[8:11], s41 offen offset:0 sc1
  v_mfma_f32_32x32x16_bf16 v[48:63], a[116:119], a[16:19], v[48:63]
  v_mfma_f32_32x32x16_bf16 v[64:79], a[116:119], a[20:23], v[64:79]
  buffer_load_dwordx4 a[72:75], v4, s[8:11], s40 offen offset:1024 sc1
  buffer_load_dwordx4 a[76:79], v4, s[8:11], s41 offen offset:1024 sc1
  s_waitcnt vmcnt(12)
  v_mfma_f32_32x32x16_bf16 v[16:31], a[120:123], a[24:27], v[16:31]
  v_mfma_f32_32x32x16_bf16 v[32:47], a[120:123], a[28:31], v[32:47]
  buffer_load_dwordx4 a[80:83], v4, s[8:11], s40 offen offset:2048 sc1
  buffer_load_dwordx4 a[84:87], v4, s[8:11], s41 offen offset:2048 sc1
  v_mfma_f32_32x32x16_bf16 v[48:63], a[124:127], a[24:27], v[48:63]
  v_mfma_f32_32x32x16_bf16 v[64:79], a[124:127], a[28:31], v[64:79]
  buffer_load_dwordx4 a[88:91], v4, s[8:11], s40 offen offset:3072 sc1
  buffer_load_dwordx4 a[92:95], v4, s[8:11], s41 offen offset:3072 sc1
  s_add_u32 s40, s40, 4096
  s_add_u32 s41, s41, 4096
  s_waitcnt vmcnt(14)
  v_mfma_f32_32x32x16_bf16 v[16:31], a[128:131], a[32:35], v[16:31]
  v_mfma_f32_32x32x16_bf16 v[32:47], a[128:131], a[36:39], v[32:47]
  buffer_load_dwordx4 a[0:3], v4, s[8:11], s40 offen offset:0 sc1
  buffer_load_dwordx4 a[4:7], v4, s[8:11], s41 offen offset:0 sc1
  v_mfma_f32_32x32x16_bf16 v[48:63], a[132:135], a[32:35], v[48:63]
  v_mfma_f32_32x32x16_bf16 v[64:79], a[132:135], a[36:39], v[64:79]
  buffer_load_dwordx4 a[8:11], v4, s[8:11], s40 offen offset:1024 sc1
  buffer_load_dwordx4 a[12:15], v4, s[8:11], s41 offen offset:1024 sc1
  s_waitcnt vmcnt(16)
  v_mfma_f32_32x32x16_bf16 v[16:31], a[136:139], a[40:43], v[16:31]
  v_mfma_f32_32x32x16_bf16 v[32:47], a[136:139], a[44:47], v[32:47]
  buffer_load_dwordx4 a[16:19], v4, s[8:11], s40 offen offset:2048 sc1
  buffer_load_dwordx4 a[20:23], v4, s[8:11], s41 offen offset:2048 sc1
  v_mfma_f32_32x32x16_bf16 v[48:63], a[140:143], a[40:43], v[48:63]
  v_mfma_f32_32x32x16_bf16 v[64:79], a[140:143], a[44:47], v[64:79]
  buffer_load_dwordx4 a[24:27], v4, s[8:11], s40 offen offset:3072 sc1
  buffer_load_dwordx4 a[28:31], v4, s[8:11], s41 offen offset:3072 sc1
  s_add_u32 s40, s40, 4096
  s_add_u32 s41, s41, 4096
  s_waitcnt vmcnt(18)
  v_mfma_f32_32x32x16_bf16 v[16:31], a[144:147], a[48:51], v[16:31]
  v_mfma_f32_32x32x16_bf16 v[32:47], a[144:147], a[52:55], v[32:47]
  buffer_load_dwordx4 a[32:35], v4, s[8:11], s40 offen offset:0 sc1
  buffer_load_dwordx4 a[36:39], v4, s[8:11], s41 offen offset:0 sc1
  v_mfma_f32_32x32x16_bf16 v[48:63], a[148:151], a[48:51], v[48:63]
  v_mfma_f32_32x32x16_bf16 v[64:79], a[148:151], a[52:55], v[64:79]
  buffer_load_dwordx4 a[40:43], v4, s[8:11], s40 offen offset:1024 sc1
  buffer_load_dwordx4 a[44:47], v4, s[8:11], s41 offen offset:1024 sc1
  s_waitcnt vmcnt(20)
  v_mfma_f32_32x32x16_bf16 v[16:31], a[152:155], a[56:59], v[16:31]
  v_mfma_f32_32x32x16_bf16 v[32:47], a[152:155], a[60:63], v[32:47]
  buffer_load_dwordx4 a[48:51], v4, s[8:11], s40 offen offset:2048 sc1
  buffer_load_dwordx4 a[52:55], v4, s[8:11], s41 offen offset:2048 sc1
  v_mfma_f32_32x32x16_bf16 v[48:63], a[156:159], a[56:59], v[48:63]
  v_mfma_f32_32x32x16_bf16 v[64:79], a[156:159], a[60:63], v[64:79]
  s_waitcnt vmcnt(20)
  v_mfma_f32_32x32x16_bf16 v[16:31], a[160:163], a[64:67], v[16:31]
  v_mfma_f32_32x32x16_bf16 v[32:47], a[160:163], a[68:71], v[32:47]
  buffer_load_dwordx4 a[56:59], v4, s[8:11], s40 offen offset:3072 sc1
  buffer_load_dwordx4 a[60:63], v4, s[8:11], s41 offen offset:3072 sc1
  s_add_u32 s40, s40, 4096
  s_add_u32 s41, s41, 4096
  v_mfma_f32_32x32x16_bf16 v[48:63], a[164:167], a[64:67], v[48:63]
  v_mfma_f32_32x32x16_bf16 v[64:79], a[164:167], a[68:71], v[64:79]
  s_waitcnt vmcnt(20)
  v_mfma_f32_32x32x16_bf16 v[16:31], a[168:171], a[72:75], v[16:31]
  v_mfma_f32_32x32x16_bf16 v[32:47], a[168:171], a[76:79], v[32:47]
  buffer_load_dwordx4 a[64:67], v4, s[8:11], s40 offen offset:0 sc1
  buffer_load_dwordx4 a[68:71], v4, s[8:11], s41 offen offset:0 sc1
  v_mfma_f32_32x32x16_bf16 v[48:63], a[172:175], a[72:75], v[48:63]
  v_mfma_f32_32x32x16_bf16 v[64:79], a[172:175], a[76:79], v[64:79]
  s_waitcnt vmcnt(20)
  v_mfma_f32_32x32x16_bf16 v[16:31], a[176:179], a[80:83], v[16:31]
  v_mfma_f32_32x32x16_bf16 v[32:47], a[176:179], a[84:87], v[32:47]
  buffer_load_dwordx4 a[72:75], v4, s[8:11], s40 offen offset:1024 sc1
  buffer_load_dwordx4 a[76:79], v4, s[8:11], s41 offen offset:1024 sc1
  v_mfma_f32_32x32x16_bf16 v[48:63], a[180:183], a[80:83], v[48:63]
  v_mfma_f32_32x32x16_bf16 v[64:79], a[180:183], a[84:87], v[64:79]
  s_waitcnt vmcnt(20)
  v_mfma_f32_32x32x16_bf16 v[16:31], a[184:187], a[88:91], v[16:31]
  v_mfma_f32_32x32x16_bf16 v[32:47], a[184:187], a[92:95], v[32:47]
  buffer_load_dwordx4 a[80:83], v4, s[8:11], s40 offen offset:2048 sc1
  buffer_load_dwordx4 a[84:87], v4, s[8:11], s41 offen offset:2048 sc1
  v_mfma_f32_32x32x16_bf16 v[48:63], a[188:191], a[88:91], v[48:63]
  v_mfma_f32_32x32x16_bf16 v[64:79], a[188:191], a[92:95], v[64:79]
  s_waitcnt vmcnt(20)
  v_mfma_f32_32x32x16_bf16 v[16:31], a[192:195], a[0:3], v[16:31]
  v_mfma_f32_32x32x16_bf16 v[32:47], a[192:195], a[4:7], v[32:47]
  buffer_load_dwordx4 a[88:91], v4, s[8:11], s40 offen offset:3072 sc1
  buffer_load_dwordx4 a[92:95], v4, s[8:11], s41 offen offset:3072 sc1
  s_add_u32 s40, s40, 4096
  s_add_u32 s41, s41, 4096
  v_mfma_f32_32x32x16_bf16 v[48:63], a[196:199], a[0:3], v[48:63]
  v_mfma_f32_32x32x16_bf16 v[64:79], a[196:199], a[4:7], v[64:79]
  s_waitcnt vmcnt(20)
  v_mfma_f32_32x32x16_bf16 v[16:31], a[200:203], a[8:11], v[16:31]
  v_mfma_f32_32x32x16_bf16 v[32:47], a[200:203], a[12:15], v[32:47]
  buffer_load_dwordx4 a[0:3], v4, s[8:11], s40 offen offset:0 sc1
  buffer_load_dwordx4 a[4:7], v4, s[8:11], s41 offen offset:0 sc1
  v_mfma_f32_32x32x16_bf16 v[48:63], a[204:207], a[8:11], v[48:63]
  v_mfma_f32_32x32x16_bf16 v[64:79], a[204:207], a[12:15], v[64:79]
  s_waitcnt vmcnt(20)
  v_mfma_f32_32x32x16_bf16 v[16:31], a[208:211], a[16:19], v[16:31]
  v_mfma_f32_32x32x16_bf16 v[32:47], a[208:211], a[20:23], v[32:47]
  buffer_load_dwordx4 a[8:11], v4, s[8:11], s40 offen offset:1024 sc1
  buffer_load_dwordx4 a[12:15], v4, s[8:11], s41 offen offset:1024 sc1
  v_mfma_f32_32x32x16_bf16 v[48:63], a[212:215], a[16:19], v[48:63]
  v_mfma_f32_32x32x16_bf16 v[64:79], a[212:215], a[20:23], v[64:79]
  s_waitcnt vmcnt(20)
  v_mfma_f32_32x32x16_bf16 v[16:31], a[216:219], a[24:27], v[16:31]
  v_mfma_f32_32x32x16_bf16 v[32:47], a[216:219], a[28:31], v[32:47]
  buffer_load_dwordx4 a[16:19], v4, s[8:11], s40 offen offset:2048 sc1
  buffer_load_dwordx4 a[20:23], v4, s[8:11], s41 offen offset:2048 sc1
  v_mfma_f32_32x32x16_bf16 v[48:63], a[220:223], a[24:27], v[48:63]
  v_mfma_f32_32x32x16_bf16 v[64:79], a[220:223], a[28:31], v[64:79]
  s_waitcnt vmcnt(20)
  v_mfma_f32_32x32x16_bf16 v[16:31], a[224:227], a[32:35], v[16:31]
  v_mfma_f32_32x32x16_bf16 v[32:47], a[224:227], a[36:39], v[32:47]
  buffer_load_dwordx4 a[24:27], v4, s[8:11], s40 offen offset:3072 sc1
  buffer_load_dwordx4 a[28:31], v4, s[8:11], s41 offen offset:3072 sc1
  buffer_load_dwordx4 v[80:83], v4, s[8:11], s36 offen sc1
  buffer_load_dwordx4 v[84:87], v4, s[8:11], s36 offen offset:1024 sc1
  s_mov_b32 s43, s42
  buffer_load_dwordx2 v[96:97], v5, s[8:11], s43 offen sc1
  s_add_u32 s43, s43, 32768
  buffer_load_dwordx2 v[98:99], v5, s[8:11], s43 offen sc1
  s_add_u32 s43, s43, 32768
  buffer_load_dwordx2 v[100:101], v5, s[8:11], s43 offen sc1
  s_add_u32 s43, s43, 32768
  buffer_load_dwordx2 v[102:103], v5, s[8:11], s43 offen sc1
  s_add_u32 s43, s43, 32768
  buffer_load_dwordx2 v[104:105], v5, s[8:11], s43 offen sc1
  s_add_u32 s43, s43, 32768
  buffer_load_dwordx2 v[106:107], v5, s[8:11], s43 offen sc1
  s_add_u32 s43, s43, 32768
  buffer_load_dwordx2 v[108:109], v5, s[8:11], s43 offen sc1
  s_lshr_b32 s63, s2, 3
  s_or_b32 s63, s63, s16
  s_xor_b32 s62, s3, 1
  s_or_b32 s63, s63, s62
  s_or_b32 s63, s63, s18
  s_cmp_lg_u32 s63, 0
  s_cbranch_scc1 L2_nmw
  s_and_b32 s63, s2, 7
  s_lshl_b32 s63, s63, 8
  s_mul_i32 s62, s3, 10240
  s_add_u32 s63, s63, s62
  s_add_u32 s63, s63, 0xd1203c
  v_mov_b32 v110, 0
  v_mov_b32 v111, s66
  s_mov_b64 exec, 1
  buffer_store_dword v111, v110, s[8:11], s63 offen
  s_mov_b64 exec, -1
L2_nmw:
  v_mfma_f32_32x32x16_bf16 v[48:63], a[228:231], a[32:35], v[48:63]
  v_mfma_f32_32x32x16_bf16 v[64:79], a[228:231], a[36:39], v[64:79]
  s_waitcnt vmcnt(29)
  v_mfma_f32_32x32x16_bf16 v[16:31], a[232:235], a[40:43], v[16:31]
  v_mfma_f32_32x32x16_bf16 v[32:47], a[232:235], a[44:47], v[32:47]
  v_mfma_f32_32x32x16_bf16 v[48:63], a[236:239], a[40:43], v[48:63]
  v_mfma_f32_32x32x16_bf16 v[64:79], a[236:239], a[44:47], v[64:79]
  s_waitcnt vmcnt(27)
  v_mfma_f32_32x32x16_bf16 v[16:31], a[240:243], a[48:51], v[16:31]
  v_mfma_f32_32x32x16_bf16 v[32:47], a[240:243], a[52:55], v[32:47]
  v_mfma_f32_32x32x16_bf16 v[48:63], a[244:247], a[48:51], v[48:63]
  v_mfma_f32_32x32x16_bf16 v[64:79], a[244:247], a[52:55], v[64:79]
  s_waitcnt vmcnt(25)
  v_mfma_f32_32x32x16_bf16 v[16:31], a[248:251], a[56:59], v[16:31]
  v_mfma_f32_32x32x16_bf16 v[32:47], a[248:251], a[60:63], v[32:47]
  v_mfma_f32_32x32x16_bf16 v[48:63], a[252:255], a[56:59], v[48:63]
  v_mfma_f32_32x32x16_bf16 v[64:79], a[252:255], a[60:63], v[64:79]
  s_waitcnt vmcnt(23)
  v_mfma_f32_32x32x16_bf16 v[16:31], v[128:131], a[64:67], v[16:31]
  v_mfma_f32_32x32x16_bf16 v[32:47], v[128:131], a[68:71], v[32:47]
  v_mfma_f32_32x32x16_bf16 v[48:63], v[132:135], a[64:67], v[48:63]
  v_mfma_f32_32x32x16_bf16 v[64:79], v[132:135], a[68:71], v[64:79]
  s_waitcnt vmcnt(21)
  v_mfma_f32_32x32x16_bf16 v[16:31], v[136:139], a[72:75], v[16:31]
  v_mfma_f32_32x32x16_bf16 v[32:47], v[136:139], a[76:79], v[32:47]
  v_mfma_f32_32x32x16_bf16 v[48:63], v[140:143], a[72:75], v[48:63]
  v_mfma_f32_32x32x16_bf16 v[64:79], v[140:143], a[76:79], v[64:79]
  s_waitcnt vmcnt(19)
  v_mfma_f32_32x32x16_bf16 v[16:31], v[144:147], a[80:83], v[16:31]
  v_mfma_f32_32x32x16_bf16 v[32:47], v[144:147], a[84:87], v[32:47]
  v_mfma_f32_32x32x16_bf16 v[48:63], v[148:151], a[80:83], v[48:63]
  v_mfma_f32_32x32x16_bf16 v[64:79], v[148:151], a[84:87], v[64:79]
  s_waitcnt vmcnt(17)
  v_mfma_f32_32x32x16_bf16 v[16:31], v[152:155], a[88:91], v[16:31]
  v_mfma_f32_32x32x16_bf16 v[32:47], v[152:155], a[92:95], v[32:47]
  v_mfma_f32_32x32x16_bf16 v[48:63], v[156:159], a[88:91], v[48:63]
  v_mfma_f32_32x32x16_bf16 v[64:79], v[156:159], a[92:95], v[64:79]
  s_waitcnt vmcnt(0)
  v_mfma_f32_32x32x16_bf16 v[32:47], v[160:163], a[4:7], v[32:47]
  v_add_f32 v96, v96, v98
  v_add_f32 v97, v97, v99
  v_mfma_f32_32x32x16_bf16 v[32:47], v[168:171], a[12:15], v[32:47]
  v_add_f32 v96, v96, v100
  v_add_f32 v97, v97, v101
  v_mfma_f32_32x32x16_bf16 v[32:47], v[176:179], a[20:23], v[32:47]
  v_add_f32 v96, v96, v102
  v_add_f32 v97, v97, v103
  v_mfma_f32_32x32x16_bf16 v[32:47], v[184:187], a[28:31], v[32:47]
  v_add_f32 v96, v96, v104
  v_add_f32 v97, v97, v105
  v_mfma_f32_32x32x16_bf16 v[48:63], v[164:167], a[0:3], v[48:63]
  v_add_f32 v96, v96, v106
  v_add_f32 v97, v97, v107
  v_mfma_f32_32x32x16_bf16 v[48:63], v[172:175], a[8:11], v[48:63]
  v_add_f32 v96, v96, v108
  v_add_f32 v97, v97, v109
  v_mfma_f32_32x32x16_bf16 v[48:63], v[180:183], a[16:19], v[48:63]
  v_mov_b32 v98, v96
  v_mov_b32 v99, v97
  v_mfma_f32_32x32x16_bf16 v[48:63], v[188:191], a[24:27], v[48:63]
  s_nop 1
  v_permlane32_swap_b32 v96, v98
  s_nop 7
  ds_write_b128 v112, v[32:35] offset:0
  ds_write_b128 v112, v[36:39] offset:1024
  ds_write_b128 v112, v[40:43] offset:2048
  ds_write_b128 v112, v[44:47] offset:3072
  v_mfma_f32_32x32x16_bf16 v[64:79], v[164:167], a[4:7], v[64:79]
  v_permlane32_swap_b32 v97, v99
  s_nop 1
  v_mfma_f32_32x32x16_bf16 v[64:79], v[172:175], a[12:15], v[64:79]
  v_add_f32 v96, v96, v98
  v_add_f32 v97, v97, v99
  v_mfma_f32_32x32x16_bf16 v[64:79], v[180:183], a[20:23], v[64:79]
  v_mul_f32 v96, 0x3b124925, v96
  v_mul_f32 v97, 0x3b124925, v97
  v_mfma_f32_32x32x16_bf16 v[64:79], v[188:191], a[28:31], v[64:79]
  v_fma_f32 v97, -v96, v96, v97
  v_max_f32 v97, 0, v97
  s_nop 7
  ds_write_b128 v113, v[48:51] offset:0
  ds_write_b128 v113, v[52:55] offset:1024
  ds_write_b128 v113, v[56:59] offset:2048
  ds_write_b128 v113, v[60:63] offset:3072
  v_mfma_f32_32x32x16_bf16 v[16:31], v[160:163], a[0:3], v[16:31]
  v_add_f32 v97, 0x3727c5ac, v97
  v_rsq_f32 v90, v97
  v_mfma_f32_32x32x16_bf16 v[16:31], v[168:171], a[8:11], v[16:31]
  s_nop 0
  v_mfma_f32_32x32x16_bf16 v[16:31], v[176:179], a[16:19], v[16:31]
  v_mfma_f32_32x32x16_bf16 v[16:31], v[184:187], a[24:27], v[16:31]
  s_nop 7
  ds_write_b128 v114, v[64:67] offset:0
  ds_write_b128 v114, v[68:71] offset:1024
  ds_write_b128 v114, v[72:75] offset:2048
  ds_write_b128 v114, v[76:79] offset:3072
  s_waitcnt lgkmcnt(0)
  s_barrier
  ds_read_b128 v[32:35], v115 offset:0
  ds_read_b128 v[36:39], v115 offset:1024
  ds_read_b128 v[40:43], v115 offset:2048
  ds_read_b128 v[44:47], v115 offset:3072
  ds_read_b128 v[48:51], v115 offset:4096
  ds_read_b128 v[52:55], v115 offset:5120
  ds_read_b128 v[56:59], v115 offset:6144
  ds_read_b128 v[60:63], v115 offset:7168
  ds_read_b128 v[64:67], v115 offset:8192
  ds_read_b128 v[68:71], v115 offset:9216
  ds_read_b128 v[72:75], v115 offset:10240
  ds_read_b128 v[76:79], v115 offset:11264
  s_waitcnt lgkmcnt(8)
  v_pk_add_f32 v[16:17], v[16:17], v[32:33]
  v_pk_add_f32 v[18:19], v[18:19], v[34:35]
  v_pk_add_f32 v[20:21], v[20:21], v[36:37]
  v_pk_add_f32 v[22:23], v[22:23], v[38:39]
  v_pk_add_f32 v[24:25], v[24:25], v[40:41]
  v_pk_add_f32 v[26:27], v[26:27], v[42:43]
  v_pk_add_f32 v[28:29], v[28:29], v[44:45]
  v_pk_add_f32 v[30:31], v[30:31], v[46:47]
  s_waitcnt lgkmcnt(4)
  v_pk_add_f32 v[16:17], v[16:17], v[48:49]
  v_pk_add_f32 v[18:19], v[18:19], v[50:51]
  v_pk_add_f32 v[20:21], v[20:21], v[52:53]
  v_pk_add_f32 v[22:23], v[22:23], v[54:55]
  v_pk_add_f32 v[24:25], v[24:25], v[56:57]
  v_pk_add_f32 v[26:27], v[26:27], v[58:59]
  v_pk_add_f32 v[28:29], v[28:29], v[60:61]
  v_pk_add_f32 v[30:31], v[30:31], v[62:63]
  s_waitcnt lgkmcnt(0)
  v_pk_add_f32 v[16:17], v[16:17], v[64:65]
  v_pk_add_f32 v[18:19], v[18:19], v[66:67]
  v_pk_add_f32 v[20:21], v[20:21], v[68:69]
  v_pk_add_f32 v[22:23], v[22:23], v[70:71]
  v_pk_add_f32 v[24:25], v[24:25], v[72:73]
  v_pk_add_f32 v[26:27], v[26:27], v[74:75]
  v_pk_add_f32 v[28:29], v[28:29], v[76:77]
  v_pk_add_f32 v[30:31], v[30:31], v[78:79]
  v_lshlrev_b32 v32, 16, v80
  v_and_b32 v33, 0xffff0000, v80
  v_lshlrev_b32 v34, 16, v81
  v_and_b32 v35, 0xffff0000, v81
  v_lshlrev_b32 v36, 16, v82
  v_and_b32 v37, 0xffff0000, v82
  v_lshlrev_b32 v38, 16, v83
  v_and_b32 v39, 0xffff0000, v83
  v_lshlrev_b32 v40, 16, v84
  v_and_b32 v41, 0xffff0000, v84
  v_lshlrev_b32 v42, 16, v85
  v_and_b32 v43, 0xffff0000, v85
  v_lshlrev_b32 v44, 16, v86
  v_and_b32 v45, 0xffff0000, v86
  v_lshlrev_b32 v46, 16, v87
  v_and_b32 v47, 0xffff0000, v87
  v_pk_fma_f32 v[16:17], v[16:17], v[90:91], v[32:33] op_sel_hi:[1,0,1]
  v_pk_fma_f32 v[18:19], v[18:19], v[90:91], v[34:35] op_sel_hi:[1,0,1]
  v_pk_fma_f32 v[20:21], v[20:21], v[90:91], v[36:37] op_sel_hi:[1,0,1]
  v_pk_fma_f32 v[22:23], v[22:23], v[90:91], v[38:39] op_sel_hi:[1,0,1]
  v_pk_fma_f32 v[24:25], v[24:25], v[90:91], v[40:41] op_sel_hi:[1,0,1]
  v_pk_fma_f32 v[26:27], v[26:27], v[90:91], v[42:43] op_sel_hi:[1,0,1]
  v_pk_fma_f32 v[28:29], v[28:29], v[90:91], v[44:45] op_sel_hi:[1,0,1]
  v_pk_fma_f32 v[30:31], v[30:31], v[90:91], v[46:47] op_sel_hi:[1,0,1]
  v_cvt_pk_bf16_f32 v80, v16, v17
  v_cvt_pk_bf16_f32 v81, v18, v19
  v_cvt_pk_bf16_f32 v82, v20, v21
  v_cvt_pk_bf16_f32 v83, v22, v23
  v_cvt_pk_bf16_f32 v84, v24, v25
  v_cvt_pk_bf16_f32 v85, v26, v27
  v_cvt_pk_bf16_f32 v86, v28, v29
  v_cvt_pk_bf16_f32 v87, v30, v31
  s_cmp_eq_u32 s3, 1
  s_cbranch_scc1 L2_final
  buffer_store_dwordx4 v[80:83], v4, s[8:11], s44 offen
  buffer_store_dwordx4 v[84:87], v4, s[8:11], s44 offen offset:1024
  v_pk_add_f32 v[32:33], v[16:17], v[18:19]
  v_pk_mul_f32 v[34:35], v[16:17], v[16:17]
  v_pk_fma_f32 v[34:35], v[18:19], v[18:19], v[34:35]
  v_pk_add_f32 v[32:33], v[32:33], v[20:21]
  v_pk_fma_f32 v[34:35], v[20:21], v[20:21], v[34:35]
  v_pk_add_f32 v[32:33], v[32:33], v[22:23]
  v_pk_fma_f32 v[34:35], v[22:23], v[22:23], v[34:35]
  v_pk_add_f32 v[32:33], v[32:33], v[24:25]
  v_pk_fma_f32 v[34:35], v[24:25], v[24:25], v[34:35]
  v_pk_add_f32 v[32:33], v[32:33], v[26:27]
  v_pk_fma_f32 v[34:35], v[26:27], v[26:27], v[34:35]
  v_pk_add_f32 v[32:33], v[32:33], v[28:29]
  v_pk_fma_f32 v[34:35], v[28:29], v[28:29], v[34:35]
  v_pk_add_f32 v[32:33], v[32:33], v[30:31]
  v_pk_fma_f32 v[34:35], v[30:31], v[30:31], v[34:35]
  v_add_f32 v36, v32, v33
  v_add_f32 v37, v34, v35
  v_mov_b32 v38, v36
  v_mov_b32 v39, v37
  s_nop 1
  v_permlane32_swap_b32 v36, v38
  v_permlane32_swap_b32 v37, v39
  s_nop 1
  v_pk_add_f32 v[36:37], v[36:37], v[38:39]
  s_mov_b32 exec_hi, 0
  buffer_store_dwordx2 v[36:37], v116, s[8:11], s45 offen
  s_mov_b64 exec, -1
  v_mov_b32 v6, 0
  v_mov_b32 v7, s66
  s_lshl_b32 s61, s16, 1
  s_or_b32 s61, s61, s18
  s_cmp_eq_u32 s61, 0
  s_waitcnt vmcnt(0)
  s_barrier
  s_cbranch_scc0 L2_fx_oth
  s_mov_b64 exec, 1
  buffer_store_dword v7, v6, s[8:11], s46 offen
  s_mov_b64 exec, -1
  s_branch L2_fx_nf
L2_fx_oth:
  s_cmp_lg_u32 s16, 0
  s_cbranch_scc1 L2_fx_nf
  buffer_wbl2 sc1
  s_waitcnt vmcnt(0)
  s_mov_b64 exec, 1
  buffer_store_dword v7, v6, s[8:11], s46 offen sc1
  s_mov_b64 exec, -1
L2_fx_nf:
  s_branch L2_done
L2_final:
  s_nop 0
  v_permlane32_swap_b32 v80, v82
  v_permlane32_swap_b32 v81, v83
  v_permlane32_swap_b32 v84, v86
  v_permlane32_swap_b32 v85, v87
  v_mul_u32_u24 v6, 896, v2
  v_lshl_add_u32 v6, v3, 4, v6
  s_mul_i32 s38, s34, 28672
  s_lshl_b32 s39, s35, 6
  s_add_u32 s38, s38, s39
  s_nop 0
  buffer_store_dwordx4 v[80:83], v6, s[12:15], s38 offen
  buffer_store_dwordx4 v[84:87], v6, s[12:15], s38 offen offset:32
L2_done:
  s_branch Lmain_next
Lmain_idle:
  s_lshr_b32 s59, s2, 3
  s_sub_u32 s59, s59, 28
  s_lshl_b32 s59, s59, 2
  s_add_u32 s59, s59, s16
  s_cmp_eq_u32 s3, 1
  s_cbranch_scc1 Lmain_last
  s_mov_b32 s56, 0x0
  s_lshl_b32 s60, s59, 6
  v_add_u32 v6, s60, v1
  v_min_u32 v7, 10751, v6
  v_lshrrev_b32 v8, 4, v7
  v_and_b32 v7, 15, v7
  v_mul_u32_u24 v8, 2048, v8
  v_lshl_add_u32 v8, v7, 7, v8
  buffer_load_dword v14, v8, s[8:11], s56 offen sc1
  s_waitcnt vmcnt(7)
  v_add_u32 v6, 1024, v6
  v_min_u32 v7, 10751, v6
  v_lshrrev_b32 v8, 4, v7
  v_and_b32 v7, 15, v7
  v_mul_u32_u24 v8, 2048, v8
  v_lshl_add_u32 v8, v7, 7, v8
  buffer_load_dword v14, v8, s[8:11], s56 offen sc1
  s_waitcnt vmcnt(7)
  v_add_u32 v6, 1024, v6
  v_min_u32 v7, 10751, v6
  v_lshrrev_b32 v8, 4, v7
  v_and_b32 v7, 15, v7
  v_mul_u32_u24 v8, 2048, v8
  v_lshl_add_u32 v8, v7, 7, v8
  buffer_load_dword v14, v8, s[8:11], s56 offen sc1
  s_waitcnt vmcnt(7)
  v_add_u32 v6, 1024, v6
  v_min_u32 v7, 10751, v6
  v_lshrrev_b32 v8, 4, v7
  v_and_b32 v7, 15, v7
  v_mul_u32_u24 v8, 2048, v8
  v_lshl_add_u32 v8, v7, 7, v8
  buffer_load_dword v14, v8, s[8:11], s56 offen sc1
  s_waitcnt vmcnt(7)
  v_add_u32 v6, 1024, v6
  v_min_u32 v7, 10751, v6
  v_lshrrev_b32 v8, 4, v7
  v_and_b32 v7, 15, v7
  v_mul_u32_u24 v8, 2048, v8
  v_lshl_add_u32 v8, v7, 7, v8
  buffer_load_dword v14, v8, s[8:11], s56 offen sc1
  s_waitcnt vmcnt(7)
  v_add_u32 v6, 1024, v6
  v_min_u32 v7, 10751, v6
  v_lshrrev_b32 v8, 4, v7
  v_and_b32 v7, 15, v7
  v_mul_u32_u24 v8, 2048, v8
  v_lshl_add_u32 v8, v7, 7, v8
  buffer_load_dword v14, v8, s[8:11], s56 offen sc1
  s_waitcnt vmcnt(7)
  v_add_u32 v6, 1024, v6
  v_min_u32 v7, 10751, v6
  v_lshrrev_b32 v8, 4, v7
  v_and_b32 v7, 15, v7
  v_mul_u32_u24 v8, 2048, v8
  v_lshl_add_u32 v8, v7, 7, v8
  buffer_load_dword v14, v8, s[8:11], s56 offen sc1
  s_waitcnt vmcnt(7)
  v_add_u32 v6, 1024, v6
  v_min_u32 v7, 10751, v6
  v_lshrrev_b32 v8, 4, v7
  v_and_b32 v7, 15, v7
  v_mul_u32_u24 v8, 2048, v8
  v_lshl_add_u32 v8, v7, 7, v8
  buffer_load_dword v14, v8, s[8:11], s56 offen sc1
  s_waitcnt vmcnt(7)
  v_add_u32 v6, 1024, v6
  v_min_u32 v7, 10751, v6
  v_lshrrev_b32 v8, 4, v7
  v_and_b32 v7, 15, v7
  v_mul_u32_u24 v8, 2048, v8
  v_lshl_add_u32 v8, v7, 7, v8
  buffer_load_dword v14, v8, s[8:11], s56 offen sc1
  s_waitcnt vmcnt(7)
  v_add_u32 v6, 1024, v6
  v_min_u32 v7, 10751, v6
  v_lshrrev_b32 v8, 4, v7
  v_and_b32 v7, 15, v7
  v_mul_u32_u24 v8, 2048, v8
  v_lshl_add_u32 v8, v7, 7, v8
  buffer_load_dword v14, v8, s[8:11], s56 offen sc1
  s_waitcnt vmcnt(7)
  v_add_u32 v6, 1024, v6
  v_min_u32 v7, 10751, v6
  v_lshrrev_b32 v8, 4, v7
  v_and_b32 v7, 15, v7
  v_mul_u32_u24 v8, 2048, v8
  v_lshl_add_u32 v8, v7, 7, v8
  buffer_load_dword v14, v8, s[8:11], s56 offen sc1
  s_waitcnt vmcnt(7)
  s_waitcnt vmcnt(0)
  s_barrier
  s_lshr_b32 s56, s2, 4
  s_mul_i32 s56, s56, 86016
  s_mul_i32 s57, s16, 21504
  s_add_u32 s56, s56, s57
  s_mov_b32 m0, s57
  s_add_u32 s57, s57, 4096
  buffer_load_dwordx4 v4, s[8:11], s56 offen offset:0 lds
  buffer_load_dwordx4 v4, s[8:11], s56 offen offset:1024 lds
  buffer_load_dwordx4 v4, s[8:11], s56 offen offset:2048 lds
  buffer_load_dwordx4 v4, s[8:11], s56 offen offset:3072 lds
  s_add_u32 s56, s56, 4096
  s_mov_b32 m0, s57
  s_add_u32 s57, s57, 4096
  buffer_load_dwordx4 v4, s[8:11], s56 offen offset:0 lds
  buffer_load_dwordx4 v4, s[8:11], s56 offen offset:1024 lds
  buffer_load_dwordx4 v4, s[8:11], s56 offen offset:2048 lds
  buffer_load_dwordx4 v4, s[8:11], s56 offen offset:3072 lds
  s_add_u32 s56, s56, 4096
  s_mov_b32 m0, s57
  s_add_u32 s57, s57, 4096
  buffer_load_dwordx4 v4, s[8:11], s56 offen offset:0 lds
  buffer_load_dwordx4 v4, s[8:11], s56 offen offset:1024 lds
  buffer_load_dwordx4 v4, s[8:11], s56 offen offset:2048 lds
  buffer_load_dwordx4 v4, s[8:11], s56 offen offset:3072 lds
  s_add_u32 s56, s56, 4096
  s_mov_b32 m0, s57
  s_add_u32 s57, s57, 4096
  buffer_load_dwordx4 v4, s[8:11], s56 offen offset:0 lds
  buffer_load_dwordx4 v4, s[8:11], s56 offen offset:1024 lds
  buffer_load_dwordx4 v4, s[8:11], s56 offen offset:2048 lds
  buffer_load_dwordx4 v4, s[8:11], s56 offen offset:3072 lds
  s_add_u32 s56, s56, 4096
  s_mov_b32 m0, s57
  s_add_u32 s57, s57, 4096
  buffer_load_dwordx4 v4, s[8:11], s56 offen offset:0 lds
  buffer_load_dwordx4 v4, s[8:11], s56 offen offset:1024 lds
  buffer_load_dwordx4 v4, s[8:11], s56 offen offset:2048 lds
  buffer_load_dwordx4 v4, s[8:11], s56 offen offset:3072 lds
  s_add_u32 s56, s56, 4096
  s_mov_b32 m0, s57
  s_add_u32 s57, s57, 4096
  buffer_load_dwordx4 v4, s[8:11], s56 offen offset:0 lds
  s_branch Lmain_next
Lmain_last:
  s_lshr_b32 s59, s2, 3
  s_xor_b32 s59, s59, 28
  s_or_b32 s59, s59, s18
  s_cmp_lg_u32 s59, 0
  s_cbranch_scc1 Lmw1_out
  s_and_b32 s30, s2, 7
  s_lshl_b32 s30, s30, 8
  s_mul_i32 s31, s3, 10240
  s_add_u32 s30, s30, s31
  s_add_u32 s30, s30, 0xd1203c
  s_cmp_lg_u32 s16, 0
  s_cbranch_scc1 Lmw1_a_oth
  v_min_u32 v6, 0, v1
  v_lshlrev_b32 v6, 2, v6
  s_mov_b32 s62, 0
Lmw1_a_poll:
  buffer_load_dword v7, v6, s[8:11], s30 offen sc1
  s_add_u32 s62, s62, 1
  s_cmp_gt_u32 s62, 300000
  s_cbranch_scc1 Lmw1_a_to
  s_waitcnt vmcnt(0)
  v_cmp_ne_u32 vcc, s66, v7
  s_cbranch_vccnz Lmw1_a_poll
Lmw1_a_to:
  s_waitcnt vmcnt(0)
  s_branch Lmw1_a_go
Lmw1_a_oth:
  s_waitcnt vmcnt(0)
Lmw1_a_go:
  s_barrier
  s_cmp_lg_u32 s16, 0
  s_cbranch_scc1 Lmw1_out
  buffer_wbl2 sc1
  s_waitcnt vmcnt(0)
Lmw1_out:
  s_branch Lmain_end
Lmain_next:
  s_add_u32 s3, s3, 1
  s_cmp_lt_u32 s3, 2
  s_cbranch_scc1 Lmain_layer
Lmain_end:
  s_endpgm
Lmain_codeend:
.section .rodata,"a"
.p2align 6
.amdhsa_kernel prep_kernel
  .amdhsa_next_free_vgpr 128
  .amdhsa_next_free_sgpr 102
  .amdhsa_accum_offset 128
  .amdhsa_group_segment_fixed_size 0
  .amdhsa_kernarg_size 72
  .amdhsa_user_sgpr_count 2
  .amdhsa_user_sgpr_kernarg_segment_ptr 1
  .amdhsa_system_sgpr_workgroup_id_x 1
  .amdhsa_float_denorm_mode_32 3
.end_amdhsa_kernel
.p2align 6
.amdhsa_kernel main_kernel
  .amdhsa_next_free_vgpr 512
  .amdhsa_next_free_sgpr 102
  .amdhsa_accum_offset 256
  .amdhsa_group_segment_fixed_size 0
  .amdhsa_kernarg_size 72
  .amdhsa_user_sgpr_count 2
  .amdhsa_user_sgpr_kernarg_segment_ptr 1
  .amdhsa_system_sgpr_workgroup_id_x 1
  .amdhsa_float_denorm_mode_32 3
.end_amdhsa_kernel
```
